```python
import torch

def _softmax(x, axis=-1):
    return torch.softmax(x, dim=axis)
def _gelu(x):
    return torch.nn.functional.gelu(x, approximate="tanh")
def _silu(x):
    return torch.nn.functional.silu(x)
def _sigmoid(x):
    return torch.sigmoid(x)
def _layernorm(x, axis=-1, eps=1e-5):
    m = x.mean(dim=axis, keepdim=True)
    v = x.var(dim=axis, keepdim=True, unbiased=False)
    return (x - m) / torch.sqrt(v + eps)
def _scatter_add(tgt, idx, src, axis=0):
    return tgt.clone().index_add_(axis, idx, src)
def _segment_sum(src, seg, n):
    out = torch.zeros((n,) + src.shape[1:], dtype=src.dtype)
    return out.index_add_(0, seg, src)
def _pad(x, pw):
    flat = tuple(v for pair in reversed(pw) for v in pair)
    return torch.nn.functional.pad(x, flat)

kernel_name = 'interleave_layers__gqa_block_cached__dense_activation_silu__decode'

def setup_inputs():

    _w = (lambda a: (lambda t: t.to(torch.bfloat16) if t.is_floating_point() else t)(torch.as_tensor(a)))
    def _A_setup():
        B, Sq, D = 2, 1, 640
        Hq, Hkv, Sk, Dh = 32, 32, 8192, 128
        assert Hq % Hkv == 0, (Hq, Hkv)
        return {
            "x": _w((lambda *s: torch.randn(*s, dtype=torch.bfloat16) * 0.1)(B, Sq, D)),
            "k_cache": _w((lambda *s: torch.randn(*s, dtype=torch.bfloat16) * 1.6)(B, Hkv, Sk, Dh)),
            "v_cache": _w((lambda *s: torch.randn(*s, dtype=torch.bfloat16) * 3.2)(B, Hkv, Sk, Dh)),
            "wq": _w((lambda *s: torch.randn(*s, dtype=torch.bfloat16) * 1.6)(D, Hq * Dh) * (D ** -0.5)),
            "wo": _w((lambda *s: torch.randn(*s, dtype=torch.bfloat16) * 3.2)(Hq * Dh, D) * ((Hq * Dh) ** -0.5)),
        }
    _A_in = _A_setup()

    def _B_setup():
        B, S, D, F = 2, 1, 640, 1728
        return {
            "x": _w((lambda *s: torch.randn(*s, dtype=torch.bfloat16) * 0.1)(B, S, D)),
            "w1": _w((lambda *s: torch.randn(*s, dtype=torch.bfloat16) * 3.2)(D, F) * (D ** -0.5)),
            "w2": _w((lambda *s: torch.randn(*s, dtype=torch.bfloat16) * 0.8)(F, D) * (F ** -0.5)),
        }
    _B_in = _B_setup()

    return {
        "A_x": _A_in["x"],
        "A_k_cache": _A_in["k_cache"],
        "A_v_cache": _A_in["v_cache"],
        "A_wq": _A_in["wq"],
        "A_wo": _A_in["wo"],
        "B_x": _B_in["x"],
        "B_w1": _B_in["w1"],
        "B_w2": _B_in["w2"],
    }

def reference(A_x, A_k_cache, A_v_cache, A_wq, A_wo, B_x, B_w1, B_w2):
    def _A_ref(x, k_cache, v_cache, wq, wo):
        B, Sq, D = x.shape
        Hq, Dh = 32, 128
        Hkv = k_cache.shape[1]
        rep = Hq // Hkv
        q = (lambda x, *d: x.permute(*d))((x @ wq).reshape(B, Sq, Hq, Dh), 0, 2, 1, 3)
        k = (lambda x, n, axis: torch.repeat_interleave(x, n, dim=axis))(k_cache, rep, axis=1)
        v = (lambda x, n, axis: torch.repeat_interleave(x, n, dim=axis))(v_cache, rep, axis=1)
        scores = torch.einsum("bhqd,bhkd->bhqk", q, k) * (Dh ** -0.5)
        p = _softmax(scores, axis=-1)
        o = torch.einsum("bhqk,bhkd->bhqd", p, v)
        return (lambda x, *d: x.permute(*d))(o, 0, 2, 1, 3).reshape(B, Sq, Hq * Dh) @ wo

    def _B_ref(x, w1, w2):
        h = torch.einsum("bsd,df->bsf", x, w1)
        h = _silu(h)
        out = torch.einsum("bsf,fd->bsd", h, w2)
        return out

    x = A_x
    x = x + _A_ref(_layernorm(x, axis=-1), A_k_cache, A_v_cache, A_wq, A_wo)
    x = x + _B_ref(_layernorm(x, axis=-1), B_w1, B_w2)
    x = x + _A_ref(_layernorm(x, axis=-1), A_k_cache, A_v_cache, A_wq, A_wo)
    x = x + _B_ref(_layernorm(x, axis=-1), B_w1, B_w2)
    return x
```

```asm
; @launch grid=(256,1,1) block=(256,1,1) lds=163840
.amdgcn_target "amdgcn-amd-amdhsa--gfx950"
.text
.globl interleave_layers__gqa_block_cached__dense_activation_silu__decode_kernel
.p2align 8
.type interleave_layers__gqa_block_cached__dense_activation_silu__decode_kernel,@function
interleave_layers__gqa_block_cached__dense_activation_silu__decode_kernel:
    s_cmp_ge_u32 s2, 256
    s_cbranch_scc1 L_end
    s_load_dwordx8 s[40:47], s[0:1], 0
    s_load_dwordx4 s[48:51], s[0:1], 32
    s_load_dwordx8 s[52:59], s[0:1], 48
    s_load_dwordx2 s[60:61], s[0:1], 80
    v_lshrrev_b32 v1, 6, v0
    s_nop 0
    v_readfirstlane_b32 s3, v1
    v_and_b32 v0, 63, v0
    s_cmp_ge_u32 s2, 224
    s_nop 1
    s_cbranch_scc1 L_chain
L_stream:
    s_and_b32 s62, s2, 31
    s_lshr_b32 s74, s2, 5
    s_lshl_b32 s63, s74, 2
    s_add_u32 s63, s63, s3
    v_and_b32 v38, 7, v0
    v_lshlrev_b32 v1, 10, v38
    v_bfe_u32 v38, v0, 3, 1
    v_lshlrev_b32 v38, 6, v38
    v_add_u32 v1, v1, v38
    v_lshrrev_b32 v38, 4, v0
    v_lshlrev_b32 v38, 4, v38
    v_add_u32 v1, v1, v38
    s_mul_i32 s75, s2, 5
    s_add_u32 s75, s75, s3
    s_mul_i32 s76, s75, 7282
    s_lshr_b32 s76, s76, 16
    s_mul_i32 s76, s76, 9
    s_sub_u32 s75, s75, s76
    s_mul_i32 s77, s63, 9
    s_add_u32 s28, s75, s77
    s_lshl_b32 s28, s28, 13
    s_add_u32 s76, s75, 1
    s_cmp_ge_u32 s76, 9
    s_cselect_b32 s78, 9, 0
    s_sub_u32 s76, s76, s78
    s_add_u32 s76, s76, s77
    s_lshl_b32 s29, s76, 13
    s_lshl_b32 s79, s62, 21
    s_waitcnt lgkmcnt(0)
    s_add_u32 s8, s42, s79
    s_addc_u32 s9, s43, 0
    s_mov_b32 s10, 0x200000
    s_mov_b32 s11, 0x20000
    buffer_load_dwordx4 a[0:3], v1, s[8:11], s28 offen offset:0 nt
    buffer_load_dwordx4 a[4:7], v1, s[8:11], s28 offen offset:128 nt
    buffer_load_dwordx4 a[8:11], v1, s[8:11], s28 offen offset:256 nt
    buffer_load_dwordx4 a[12:15], v1, s[8:11], s28 offen offset:384 nt
    buffer_load_dwordx4 a[16:19], v1, s[8:11], s28 offen offset:512 nt
    buffer_load_dwordx4 a[20:23], v1, s[8:11], s28 offen offset:640 nt
    buffer_load_dwordx4 a[24:27], v1, s[8:11], s28 offen offset:768 nt
    buffer_load_dwordx4 a[28:31], v1, s[8:11], s28 offen offset:896 nt
    buffer_load_dwordx4 a[32:35], v1, s[8:11], s29 offen offset:0 nt
    buffer_load_dwordx4 a[36:39], v1, s[8:11], s29 offen offset:128 nt
    buffer_load_dwordx4 a[40:43], v1, s[8:11], s29 offen offset:256 nt
    buffer_load_dwordx4 a[44:47], v1, s[8:11], s29 offen offset:384 nt
    v_lshlrev_b32 v2, 4, v0
    v_add_u32 v3, 4096, v2
    s_add_u32 s76, s75, 2
    s_cmp_ge_u32 s76, 9
    s_cselect_b32 s78, 9, 0
    s_sub_u32 s76, s76, s78
    s_add_u32 s76, s76, s77
    s_lshl_b32 s30, s76, 13
    s_add_u32 s76, s75, 3
    s_cmp_ge_u32 s76, 9
    s_cselect_b32 s78, 9, 0
    s_sub_u32 s76, s76, s78
    s_add_u32 s76, s76, s77
    s_lshl_b32 s31, s76, 13
    s_add_u32 s76, s75, 4
    s_cmp_ge_u32 s76, 9
    s_cselect_b32 s78, 9, 0
    s_sub_u32 s76, s76, s78
    s_add_u32 s76, s76, s77
    s_lshl_b32 s32, s76, 13
    s_add_u32 s76, s75, 5
    s_cmp_ge_u32 s76, 9
    s_cselect_b32 s78, 9, 0
    s_sub_u32 s76, s76, s78
    s_add_u32 s76, s76, s77
    s_lshl_b32 s33, s76, 13
    s_add_u32 s76, s75, 6
    s_cmp_ge_u32 s76, 9
    s_cselect_b32 s78, 9, 0
    s_sub_u32 s76, s76, s78
    s_add_u32 s76, s76, s77
    s_lshl_b32 s34, s76, 13
    s_add_u32 s76, s75, 7
    s_cmp_ge_u32 s76, 9
    s_cselect_b32 s78, 9, 0
    s_sub_u32 s76, s76, s78
    s_add_u32 s76, s76, s77
    s_lshl_b32 s35, s76, 13
    s_add_u32 s76, s75, 8
    s_cmp_ge_u32 s76, 9
    s_cselect_b32 s78, 9, 0
    s_sub_u32 s76, s76, s78
    s_add_u32 s76, s76, s77
    s_lshl_b32 s36, s76, 13
    s_cmp_lt_u32 s74, 4
    s_cselect_b32 s75, 1, 0
    s_cmp_eq_u32 s3, 0
    s_cselect_b32 s75, s75, 0
    s_add_u32 s76, s74, 252
    s_lshl_b32 s76, s76, 13
    s_cmp_eq_u32 s75, 1
    s_cselect_b32 s37, s76, 0x200000
    s_cselect_b32 s64, 0, 0xff00ff00
    s_cselect_b32 s65, 0, 0xff00ff00
    s_cmp_ge_u32 s74, 3
    s_cselect_b32 s75, 1, 0
    s_cmp_eq_u32 s3, 1
    s_cselect_b32 s75, s75, 0
    s_add_u32 s76, s74, 249
    s_lshl_b32 s76, s76, 13
    s_cmp_eq_u32 s75, 1
    s_cselect_b32 s38, s76, 0x200000
    s_cselect_b32 s66, 0, 0xff00ff00
    s_cselect_b32 s67, 0, 0xff00ff00
    s_mul_i32 s68, s3, 40960
    s_add_u32 s12, s44, s79
    s_addc_u32 s13, s45, 0
    s_mov_b32 s14, 0x200000
    s_mov_b32 s15, 0x20000
    s_add_u32 s80, s79, 67108864
    s_add_u32 s16, s42, s80
    s_addc_u32 s17, s43, 0
    s_mov_b32 s18, 0x200000
    s_mov_b32 s19, 0x20000
    s_add_u32 s80, s79, 67108864
    s_add_u32 s20, s44, s80
    s_addc_u32 s21, s45, 0
    s_mov_b32 s22, 0x200000
    s_mov_b32 s23, 0x20000
    s_mov_b32 s24, s60
    s_mov_b32 s25, s61
    s_mov_b32 s26, 2260992
    s_mov_b32 s27, 0x20000
    s_mul_i32 s69, s62, 14336
    s_lshl_b32 s74, s63, 9
    s_add_u32 s69, s69, s74
    v_and_b32 v38, 15, v0
    v_and_b32 v39, 1, v0
    v_mov_b32 v48, 0xffff
    v_mov_b32 v49, 0xffff0000
    v_cmp_eq_u32 vcc, 1, v39
    s_nop 1
    v_cndmask_b32 v48, v48, v49, vcc
    v_bfe_u32 v38, v38, 1, 2
    v_cmp_eq_u32 vcc, 0, v38
    s_nop 1
    v_cndmask_b32 v4, 0, v48, vcc
    v_cmp_eq_u32 vcc, 1, v38
    s_nop 1
    v_cndmask_b32 v5, 0, v48, vcc
    v_cmp_eq_u32 vcc, 2, v38
    s_nop 1
    v_cndmask_b32 v6, 0, v48, vcc
    v_cmp_eq_u32 vcc, 3, v38
    s_nop 1
    v_cndmask_b32 v7, 0, v48, vcc
    v_add_u32 v0, s68, v2
    v_and_b32 v39, 0x10, v2
    v_lshlrev_b32 v39, 2, v39
    v_lshrrev_b32 v38, 8, v2
    v_lshlrev_b32 v38, 4, v38
    v_add_u32 v39, v39, v38
    s_lshl_b32 s71, s62, 8
    s_add_u32 s71, s71, 2195456
    s_waitcnt vmcnt(11)
    buffer_load_dwordx4 a[48:51], v1, s[8:11], s29 offen offset:512 nt
    s_waitcnt vmcnt(11)
    buffer_load_dwordx4 a[52:55], v1, s[8:11], s29 offen offset:640 nt
    s_waitcnt vmcnt(11)
    buffer_load_dwordx4 a[56:59], v1, s[8:11], s29 offen offset:768 nt
    s_waitcnt vmcnt(11)
    buffer_load_dwordx4 a[60:63], v1, s[8:11], s29 offen offset:896 nt
    s_waitcnt vmcnt(11)
    buffer_load_dwordx4 a[64:67], v1, s[8:11], s30 offen offset:0 nt
    s_waitcnt vmcnt(11)
    buffer_load_dwordx4 a[68:71], v1, s[8:11], s30 offen offset:128 nt
    s_waitcnt vmcnt(11)
    buffer_load_dwordx4 a[72:75], v1, s[8:11], s30 offen offset:256 nt
    s_waitcnt vmcnt(11)
    buffer_load_dwordx4 a[76:79], v1, s[8:11], s30 offen offset:384 nt
    s_waitcnt vmcnt(11)
    buffer_load_dwordx4 a[80:83], v1, s[8:11], s30 offen offset:512 nt
    s_waitcnt vmcnt(11)
    buffer_load_dwordx4 a[84:87], v1, s[8:11], s30 offen offset:640 nt
    s_waitcnt vmcnt(11)
    buffer_load_dwordx4 a[88:91], v1, s[8:11], s30 offen offset:768 nt
    s_waitcnt vmcnt(11)
    buffer_load_dwordx4 a[92:95], v1, s[8:11], s30 offen offset:896 nt
    s_waitcnt vmcnt(11)
    buffer_load_dwordx4 a[96:99], v1, s[8:11], s31 offen offset:0 nt
    s_waitcnt vmcnt(11)
    buffer_load_dwordx4 a[100:103], v1, s[8:11], s31 offen offset:128 nt
    s_waitcnt vmcnt(11)
    buffer_load_dwordx4 a[104:107], v1, s[8:11], s31 offen offset:256 nt
    s_waitcnt vmcnt(11)
    buffer_load_dwordx4 a[108:111], v1, s[8:11], s31 offen offset:384 nt
    s_waitcnt vmcnt(11)
    buffer_load_dwordx4 a[112:115], v1, s[8:11], s31 offen offset:512 nt
    s_waitcnt vmcnt(11)
    buffer_load_dwordx4 a[116:119], v1, s[8:11], s31 offen offset:640 nt
    s_waitcnt vmcnt(11)
    buffer_load_dwordx4 a[120:123], v1, s[8:11], s31 offen offset:768 nt
    s_waitcnt vmcnt(11)
    buffer_load_dwordx4 a[124:127], v1, s[8:11], s31 offen offset:896 nt
    s_waitcnt vmcnt(11)
    buffer_load_dwordx4 a[128:131], v1, s[8:11], s32 offen offset:0 nt
    s_waitcnt vmcnt(11)
    buffer_load_dwordx4 a[132:135], v1, s[8:11], s32 offen offset:128 nt
    s_waitcnt vmcnt(11)
    buffer_load_dwordx4 a[136:139], v1, s[8:11], s32 offen offset:256 nt
    s_waitcnt vmcnt(11)
    buffer_load_dwordx4 a[140:143], v1, s[8:11], s32 offen offset:384 nt
    s_waitcnt vmcnt(11)
    buffer_load_dwordx4 a[144:147], v1, s[8:11], s32 offen offset:512 nt
    s_waitcnt vmcnt(11)
    buffer_load_dwordx4 a[148:151], v1, s[8:11], s32 offen offset:640 nt
    s_waitcnt vmcnt(11)
    buffer_load_dwordx4 a[152:155], v1, s[8:11], s32 offen offset:768 nt
    s_waitcnt vmcnt(11)
    buffer_load_dwordx4 a[156:159], v1, s[8:11], s32 offen offset:896 nt
    s_waitcnt vmcnt(11)
    buffer_load_dwordx4 a[160:163], v1, s[8:11], s33 offen offset:0 nt
    s_waitcnt vmcnt(11)
    buffer_load_dwordx4 a[164:167], v1, s[8:11], s33 offen offset:128 nt
    s_waitcnt vmcnt(11)
    buffer_load_dwordx4 a[168:171], v1, s[8:11], s33 offen offset:256 nt
    s_waitcnt vmcnt(11)
    buffer_load_dwordx4 a[172:175], v1, s[8:11], s33 offen offset:384 nt
    s_waitcnt vmcnt(11)
    buffer_load_dwordx4 a[176:179], v1, s[8:11], s33 offen offset:512 nt
    s_waitcnt vmcnt(11)
    buffer_load_dwordx4 a[180:183], v1, s[8:11], s33 offen offset:640 nt
    s_waitcnt vmcnt(11)
    buffer_load_dwordx4 a[184:187], v1, s[8:11], s33 offen offset:768 nt
    s_waitcnt vmcnt(11)
    buffer_load_dwordx4 a[188:191], v1, s[8:11], s33 offen offset:896 nt
    s_waitcnt vmcnt(11)
    buffer_load_dwordx4 a[192:195], v1, s[8:11], s34 offen offset:0 nt
    s_waitcnt vmcnt(11)
    buffer_load_dwordx4 a[196:199], v1, s[8:11], s34 offen offset:128 nt
    s_waitcnt vmcnt(11)
    buffer_load_dwordx4 a[200:203], v1, s[8:11], s34 offen offset:256 nt
    s_waitcnt vmcnt(11)
    buffer_load_dwordx4 a[204:207], v1, s[8:11], s34 offen offset:384 nt
    s_waitcnt vmcnt(11)
    buffer_load_dwordx4 a[208:211], v1, s[8:11], s34 offen offset:512 nt
    s_waitcnt vmcnt(11)
    buffer_load_dwordx4 a[212:215], v1, s[8:11], s34 offen offset:640 nt
    s_waitcnt vmcnt(11)
    buffer_load_dwordx4 a[216:219], v1, s[8:11], s34 offen offset:768 nt
    s_waitcnt vmcnt(11)
    buffer_load_dwordx4 a[220:223], v1, s[8:11], s34 offen offset:896 nt
    s_waitcnt vmcnt(11)
    buffer_load_dwordx4 a[224:227], v1, s[8:11], s35 offen offset:0 nt
    s_waitcnt vmcnt(11)
    buffer_load_dwordx4 a[228:231], v1, s[8:11], s35 offen offset:128 nt
    s_waitcnt vmcnt(11)
    buffer_load_dwordx4 a[232:235], v1, s[8:11], s35 offen offset:256 nt
    s_waitcnt vmcnt(11)
    buffer_load_dwordx4 a[236:239], v1, s[8:11], s35 offen offset:384 nt
    s_waitcnt vmcnt(11)
    buffer_load_dwordx4 a[240:243], v1, s[8:11], s35 offen offset:512 nt
    s_waitcnt vmcnt(11)
    buffer_load_dwordx4 a[244:247], v1, s[8:11], s35 offen offset:640 nt
    s_waitcnt vmcnt(11)
    buffer_load_dwordx4 a[248:251], v1, s[8:11], s35 offen offset:768 nt
    s_waitcnt vmcnt(11)
    buffer_load_dwordx4 a[252:255], v1, s[8:11], s35 offen offset:896 nt
    s_waitcnt vmcnt(11)
    buffer_load_dwordx4 v[64:67], v1, s[8:11], s36 offen offset:0 nt
    s_waitcnt vmcnt(11)
    buffer_load_dwordx4 v[68:71], v1, s[8:11], s36 offen offset:128 nt
    s_waitcnt vmcnt(11)
    buffer_load_dwordx4 v[72:75], v1, s[8:11], s36 offen offset:256 nt
    s_waitcnt vmcnt(11)
    buffer_load_dwordx4 v[76:79], v1, s[8:11], s36 offen offset:384 nt
    s_waitcnt vmcnt(11)
    buffer_load_dwordx4 v[80:83], v1, s[8:11], s36 offen offset:512 nt
    s_waitcnt vmcnt(11)
    buffer_load_dwordx4 v[84:87], v1, s[8:11], s36 offen offset:640 nt
    s_waitcnt vmcnt(11)
    buffer_load_dwordx4 v[88:91], v1, s[8:11], s36 offen offset:768 nt
    s_waitcnt vmcnt(11)
    buffer_load_dwordx4 v[92:95], v1, s[8:11], s36 offen offset:896 nt
    s_waitcnt vmcnt(11)
    buffer_load_dwordx4 v[96:99], v1, s[8:11], s37 offen offset:0 nt
    s_waitcnt vmcnt(11)
    buffer_load_dwordx4 v[100:103], v1, s[8:11], s37 offen offset:128 nt
    s_waitcnt vmcnt(11)
    buffer_load_dwordx4 v[104:107], v1, s[8:11], s37 offen offset:256 nt
    s_waitcnt vmcnt(11)
    buffer_load_dwordx4 v[108:111], v1, s[8:11], s37 offen offset:384 nt
    s_waitcnt vmcnt(11)
    buffer_load_dwordx4 v[112:115], v1, s[8:11], s37 offen offset:512 nt
    s_waitcnt vmcnt(11)
    buffer_load_dwordx4 v[116:119], v1, s[8:11], s37 offen offset:640 nt
    s_waitcnt vmcnt(11)
    buffer_load_dwordx4 v[120:123], v1, s[8:11], s37 offen offset:768 nt
    s_waitcnt vmcnt(11)
    buffer_load_dwordx4 v[124:127], v1, s[8:11], s37 offen offset:896 nt
    s_waitcnt vmcnt(11)
    v_mov_b32 v38, 0
    global_load_dword v38, v38, s[58:59] sc1
    s_waitcnt vmcnt(11)
    s_add_u32 m0, s68, 0
    s_nop 0
    buffer_load_dwordx4 v2, s[12:15], s28 offen offset:0 nt lds
    s_waitcnt vmcnt(11)
    s_add_u32 m0, s68, 0
    s_nop 0
    buffer_load_dwordx4 v2, s[12:15], s28 offen offset:1024 nt lds
    s_waitcnt vmcnt(11)
    s_add_u32 m0, s68, 0
    s_nop 0
    buffer_load_dwordx4 v2, s[12:15], s28 offen offset:2048 nt lds
    s_waitcnt vmcnt(11)
    s_add_u32 m0, s68, 0
    s_nop 0
    buffer_load_dwordx4 v2, s[12:15], s28 offen offset:3072 nt lds
    s_waitcnt vmcnt(11)
    s_add_u32 m0, s68, 4096
    s_nop 0
    buffer_load_dwordx4 v3, s[12:15], s28 offen offset:0 nt lds
    s_waitcnt vmcnt(11)
    s_add_u32 m0, s68, 4096
    s_nop 0
    buffer_load_dwordx4 v3, s[12:15], s28 offen offset:1024 nt lds
    s_waitcnt vmcnt(11)
    s_add_u32 m0, s68, 4096
    s_nop 0
    buffer_load_dwordx4 v3, s[12:15], s28 offen offset:2048 nt lds
    s_waitcnt vmcnt(11)
    s_add_u32 m0, s68, 4096
    s_nop 0
    buffer_load_dwordx4 v3, s[12:15], s28 offen offset:3072 nt lds
    s_waitcnt vmcnt(11)
    s_add_u32 m0, s68, 8192
    s_nop 0
    buffer_load_dwordx4 v2, s[12:15], s29 offen offset:0 nt lds
    s_waitcnt vmcnt(11)
    s_add_u32 m0, s68, 8192
    s_nop 0
    buffer_load_dwordx4 v2, s[12:15], s29 offen offset:1024 nt lds
    s_waitcnt vmcnt(11)
    s_add_u32 m0, s68, 8192
    s_nop 0
    buffer_load_dwordx4 v2, s[12:15], s29 offen offset:2048 nt lds
    s_waitcnt vmcnt(11)
    s_add_u32 m0, s68, 8192
    s_nop 0
    buffer_load_dwordx4 v2, s[12:15], s29 offen offset:3072 nt lds
    s_waitcnt vmcnt(11)
    s_add_u32 m0, s68, 12288
    s_nop 0
    buffer_load_dwordx4 v3, s[12:15], s29 offen offset:0 nt lds
    s_waitcnt vmcnt(11)
    s_add_u32 m0, s68, 12288
    s_nop 0
    buffer_load_dwordx4 v3, s[12:15], s29 offen offset:1024 nt lds
    s_waitcnt vmcnt(11)
    s_add_u32 m0, s68, 12288
    s_nop 0
    buffer_load_dwordx4 v3, s[12:15], s29 offen offset:2048 nt lds
    s_waitcnt vmcnt(11)
    s_add_u32 m0, s68, 12288
    s_nop 0
    buffer_load_dwordx4 v3, s[12:15], s29 offen offset:3072 nt lds
    s_waitcnt vmcnt(11)
    s_add_u32 m0, s68, 16384
    s_nop 0
    buffer_load_dwordx4 v2, s[12:15], s30 offen offset:0 nt lds
    s_waitcnt vmcnt(11)
    s_add_u32 m0, s68, 16384
    s_nop 0
    buffer_load_dwordx4 v2, s[12:15], s30 offen offset:1024 nt lds
    s_waitcnt vmcnt(11)
    s_add_u32 m0, s68, 16384
    s_nop 0
    buffer_load_dwordx4 v2, s[12:15], s30 offen offset:2048 nt lds
    s_waitcnt vmcnt(11)
    s_add_u32 m0, s68, 16384
    s_nop 0
    buffer_load_dwordx4 v2, s[12:15], s30 offen offset:3072 nt lds
    s_waitcnt vmcnt(11)
    s_add_u32 m0, s68, 20480
    s_nop 0
    buffer_load_dwordx4 v3, s[12:15], s30 offen offset:0 nt lds
    s_waitcnt vmcnt(11)
    s_add_u32 m0, s68, 20480
    s_nop 0
    buffer_load_dwordx4 v3, s[12:15], s30 offen offset:1024 nt lds
    s_waitcnt vmcnt(11)
    s_add_u32 m0, s68, 20480
    s_nop 0
    buffer_load_dwordx4 v3, s[12:15], s30 offen offset:2048 nt lds
    s_waitcnt vmcnt(11)
    s_add_u32 m0, s68, 20480
    s_nop 0
    buffer_load_dwordx4 v3, s[12:15], s30 offen offset:3072 nt lds
    s_waitcnt vmcnt(11)
    s_add_u32 m0, s68, 24576
    s_nop 0
    buffer_load_dwordx4 v2, s[12:15], s31 offen offset:0 nt lds
    s_waitcnt vmcnt(11)
    s_add_u32 m0, s68, 24576
    s_nop 0
    buffer_load_dwordx4 v2, s[12:15], s31 offen offset:1024 nt lds
    s_waitcnt vmcnt(11)
    s_add_u32 m0, s68, 24576
    s_nop 0
    buffer_load_dwordx4 v2, s[12:15], s31 offen offset:2048 nt lds
    s_waitcnt vmcnt(11)
    s_add_u32 m0, s68, 24576
    s_nop 0
    buffer_load_dwordx4 v2, s[12:15], s31 offen offset:3072 nt lds
    v_cmp_gt_u32 vcc, 32, v38
    s_nop 3
    s_cbranch_vccz L_cok_1
    s_mov_b32 s73, 0
L_cw_2:
    v_mov_b32 v38, 0
    global_load_dword v38, v38, s[58:59] offset:0 sc1
    s_waitcnt vmcnt(0)
    v_cmp_gt_u32 vcc, 32, v38
    s_add_u32 s73, s73, 1
    s_cmp_gt_u32 s73, 60000
    s_nop 1
    s_cbranch_scc1 L_cwd_3
    s_cbranch_vccnz L_cw_2
L_cwd_3:
L_cok_1:
    s_waitcnt vmcnt(11)
    s_add_u32 m0, s68, 28672
    s_nop 0
    buffer_load_dwordx4 v3, s[12:15], s31 offen offset:0 nt lds
    s_waitcnt vmcnt(11)
    s_add_u32 m0, s68, 28672
    s_nop 0
    buffer_load_dwordx4 v3, s[12:15], s31 offen offset:1024 nt lds
    s_waitcnt vmcnt(10)
    s_add_u32 s74, s71, 0
    buffer_load_dwordx4 v[8:11], v39, s[24:27], s74 offen sc1
    buffer_load_dwordx4 v[12:15], v39, s[24:27], s74 offen offset:128 sc1
    s_waitcnt vmcnt(0)
    v_max3_u32 v38, v8, v9, v10
    v_max3_u32 v38, v38, v11, v12
    v_max3_u32 v38, v38, v13, v14
    v_max_u32 v38, v38, v15
    v_cmp_eq_u32 vcc, -1, v38
    s_nop 3
    s_cbranch_vccz L_qok_4
    v_mov_b32 v8, -1
    v_mov_b32 v9, -1
    v_mov_b32 v10, -1
    v_mov_b32 v11, -1
    v_mov_b32 v12, -1
    v_mov_b32 v13, -1
    v_mov_b32 v14, -1
    v_mov_b32 v15, -1
    s_mov_b32 s73, 0
    s_nop 0
L_pl_5:
    s_add_u32 s74, s71, 0
    buffer_load_dwordx4 v[8:11], v39, s[24:27], s74 offen sc1
    buffer_load_dwordx4 v[12:15], v39, s[24:27], s74 offen offset:128 sc1
    s_waitcnt vmcnt(0)
    v_max3_u32 v38, v8, v9, v10
    v_max3_u32 v38, v38, v11, v12
    v_max3_u32 v38, v38, v13, v14
    v_max_u32 v38, v38, v15
    v_cmp_eq_u32 vcc, -1, v38
    s_add_u32 s73, s73, 1
    s_cmp_gt_u32 s73, 60000
    s_nop 1
    s_cbranch_scc1 L_pd_6
    s_cbranch_vccnz L_pl_5
L_pd_6:
L_qok_4:
    v_mfma_f32_16x16x32_bf16 v[48:51], v[8:11], a[0:3], 0
    v_mfma_f32_16x16x32_bf16 v[52:55], v[8:11], a[8:11], 0
    v_mfma_f32_16x16x32_bf16 v[48:51], v[12:15], a[4:7], v[48:51]
    v_mfma_f32_16x16x32_bf16 v[52:55], v[12:15], a[12:15], v[52:55]
    s_add_u32 m0, s68, 28672
    s_nop 0
    buffer_load_dwordx4 v3, s[12:15], s31 offen offset:2048 nt lds
    s_add_u32 m0, s68, 28672
    s_nop 0
    buffer_load_dwordx4 v3, s[12:15], s31 offen offset:3072 nt lds
    s_add_u32 m0, s68, 32768
    s_nop 0
    buffer_load_dwordx4 v2, s[12:15], s32 offen offset:0 nt lds
    s_add_u32 m0, s68, 32768
    s_nop 0
    buffer_load_dwordx4 v2, s[12:15], s32 offen offset:1024 nt lds
    s_add_u32 m0, s68, 32768
    s_nop 0
    buffer_load_dwordx4 v2, s[12:15], s32 offen offset:2048 nt lds
    s_add_u32 m0, s68, 32768
    s_nop 0
    buffer_load_dwordx4 v2, s[12:15], s32 offen offset:3072 nt lds
    s_add_u32 m0, s68, 36864
    s_nop 0
    buffer_load_dwordx4 v3, s[12:15], s32 offen offset:0 nt lds
    s_add_u32 m0, s68, 36864
    s_nop 0
    buffer_load_dwordx4 v3, s[12:15], s32 offen offset:1024 nt lds
    s_add_u32 m0, s68, 36864
    s_nop 0
    buffer_load_dwordx4 v3, s[12:15], s32 offen offset:2048 nt lds
    s_add_u32 m0, s68, 36864
    s_nop 0
    buffer_load_dwordx4 v3, s[12:15], s32 offen offset:3072 nt lds
    buffer_load_dwordx4 v[128:131], v2, s[12:15], s33 offen offset:0 nt
    buffer_load_dwordx4 v[132:135], v2, s[12:15], s33 offen offset:1024 nt
    v_add_f32_dpp v24, v49, v48 row_ror:8 row_mask:0x1 bank_mask:0x3
    s_nop 1
    v_add_f32_dpp v24, v53, v52 row_ror:8 row_mask:0x2 bank_mask:0x3
    v_mfma_f32_16x16x32_bf16 v[48:51], v[8:11], a[16:19], 0
    v_mfma_f32_16x16x32_bf16 v[52:55], v[8:11], a[24:27], 0
    v_mfma_f32_16x16x32_bf16 v[48:51], v[12:15], a[20:23], v[48:51]
    v_mfma_f32_16x16x32_bf16 v[52:55], v[12:15], a[28:31], v[52:55]
    s_nop 6
    v_add_f32_dpp v24, v49, v48 row_ror:8 row_mask:0x4 bank_mask:0x3
    s_nop 1
    v_add_f32_dpp v24, v53, v52 row_ror:8 row_mask:0x8 bank_mask:0x3
    v_mfma_f32_16x16x32_bf16 v[48:51], v[8:11], a[32:35], 0
    v_mfma_f32_16x16x32_bf16 v[52:55], v[8:11], a[40:43], 0
    v_mfma_f32_16x16x32_bf16 v[48:51], v[12:15], a[36:39], v[48:51]
    v_mfma_f32_16x16x32_bf16 v[52:55], v[12:15], a[44:47], v[52:55]
    s_nop 6
    v_add_f32_dpp v24, v48, v49 row_ror:8 row_mask:0x1 bank_mask:0xc
    s_nop 1
    v_add_f32_dpp v24, v52, v53 row_ror:8 row_mask:0x2 bank_mask:0xc
    v_mfma_f32_16x16x32_bf16 v[48:51], v[8:11], a[48:51], 0
    v_mfma_f32_16x16x32_bf16 v[52:55], v[8:11], a[56:59], 0
    v_mfma_f32_16x16x32_bf16 v[48:51], v[12:15], a[52:55], v[48:51]
    v_mfma_f32_16x16x32_bf16 v[52:55], v[12:15], a[60:63], v[52:55]
    s_waitcnt vmcnt(11)
    buffer_load_dwordx4 v[136:139], v2, s[12:15], s33 offen offset:2048 nt
    s_nop 4
    v_add_f32_dpp v24, v48, v49 row_ror:8 row_mask:0x4 bank_mask:0xc
    s_nop 1
    v_add_f32_dpp v24, v52, v53 row_ror:8 row_mask:0x8 bank_mask:0xc
    v_mfma_f32_16x16x32_bf16 v[48:51], v[8:11], a[64:67], 0
    v_mfma_f32_16x16x32_bf16 v[52:55], v[8:11], a[72:75], 0
    v_mfma_f32_16x16x32_bf16 v[48:51], v[12:15], a[68:71], v[48:51]
    v_mfma_f32_16x16x32_bf16 v[52:55], v[12:15], a[76:79], v[52:55]
    s_nop 6
    v_add_f32_dpp v25, v49, v48 row_ror:8 row_mask:0x1 bank_mask:0x3
    s_nop 1
    v_add_f32_dpp v25, v53, v52 row_ror:8 row_mask:0x2 bank_mask:0x3
    v_mfma_f32_16x16x32_bf16 v[48:51], v[8:11], a[80:83], 0
    v_mfma_f32_16x16x32_bf16 v[52:55], v[8:11], a[88:91], 0
    v_mfma_f32_16x16x32_bf16 v[48:51], v[12:15], a[84:87], v[48:51]
    v_mfma_f32_16x16x32_bf16 v[52:55], v[12:15], a[92:95], v[52:55]
    s_nop 6
    v_add_f32_dpp v25, v49, v48 row_ror:8 row_mask:0x4 bank_mask:0x3
    s_nop 1
    v_add_f32_dpp v25, v53, v52 row_ror:8 row_mask:0x8 bank_mask:0x3
    v_mfma_f32_16x16x32_bf16 v[48:51], v[8:11], a[96:99], 0
    v_mfma_f32_16x16x32_bf16 v[52:55], v[8:11], a[104:107], 0
    v_mfma_f32_16x16x32_bf16 v[48:51], v[12:15], a[100:103], v[48:51]
    v_mfma_f32_16x16x32_bf16 v[52:55], v[12:15], a[108:111], v[52:55]
    s_waitcnt vmcnt(11)
    buffer_load_dwordx4 v[140:143], v2, s[12:15], s33 offen offset:3072 nt
    s_nop 4
    v_add_f32_dpp v25, v48, v49 row_ror:8 row_mask:0x1 bank_mask:0xc
    s_nop 1
    v_add_f32_dpp v25, v52, v53 row_ror:8 row_mask:0x2 bank_mask:0xc
    v_mfma_f32_16x16x32_bf16 v[48:51], v[8:11], a[112:115], 0
    v_mfma_f32_16x16x32_bf16 v[52:55], v[8:11], a[120:123], 0
    v_mfma_f32_16x16x32_bf16 v[48:51], v[12:15], a[116:119], v[48:51]
    v_mfma_f32_16x16x32_bf16 v[52:55], v[12:15], a[124:127], v[52:55]
    s_nop 6
    v_add_f32_dpp v25, v48, v49 row_ror:8 row_mask:0x4 bank_mask:0xc
    s_nop 1
    v_add_f32_dpp v25, v52, v53 row_ror:8 row_mask:0x8 bank_mask:0xc
    v_mfma_f32_16x16x32_bf16 v[48:51], v[8:11], a[128:131], 0
    v_mfma_f32_16x16x32_bf16 v[52:55], v[8:11], a[136:139], 0
    v_mfma_f32_16x16x32_bf16 v[48:51], v[12:15], a[132:135], v[48:51]
    v_mfma_f32_16x16x32_bf16 v[52:55], v[12:15], a[140:143], v[52:55]
    s_nop 6
    v_add_f32_dpp v26, v49, v48 row_ror:8 row_mask:0x1 bank_mask:0x3
    s_nop 1
    v_add_f32_dpp v26, v53, v52 row_ror:8 row_mask:0x2 bank_mask:0x3
    v_mfma_f32_16x16x32_bf16 v[48:51], v[8:11], a[144:147], 0
    v_mfma_f32_16x16x32_bf16 v[52:55], v[8:11], a[152:155], 0
    v_mfma_f32_16x16x32_bf16 v[48:51], v[12:15], a[148:151], v[48:51]
    v_mfma_f32_16x16x32_bf16 v[52:55], v[12:15], a[156:159], v[52:55]
    s_nop 6
    v_add_f32_dpp v26, v49, v48 row_ror:8 row_mask:0x4 bank_mask:0x3
    s_nop 1
    v_add_f32_dpp v26, v53, v52 row_ror:8 row_mask:0x8 bank_mask:0x3
    v_mfma_f32_16x16x32_bf16 v[48:51], v[8:11], a[160:163], 0
    v_mfma_f32_16x16x32_bf16 v[52:55], v[8:11], a[168:171], 0
    v_mfma_f32_16x16x32_bf16 v[48:51], v[12:15], a[164:167], v[48:51]
    v_mfma_f32_16x16x32_bf16 v[52:55], v[12:15], a[172:175], v[52:55]
    s_waitcnt vmcnt(11)
    buffer_load_dwordx4 v[144:147], v3, s[12:15], s33 offen offset:0 nt
    s_nop 4
    v_add_f32_dpp v26, v48, v49 row_ror:8 row_mask:0x1 bank_mask:0xc
    s_nop 1
    v_add_f32_dpp v26, v52, v53 row_ror:8 row_mask:0x2 bank_mask:0xc
    v_mfma_f32_16x16x32_bf16 v[48:51], v[8:11], a[176:179], 0
    v_mfma_f32_16x16x32_bf16 v[52:55], v[8:11], a[184:187], 0
    v_mfma_f32_16x16x32_bf16 v[48:51], v[12:15], a[180:183], v[48:51]
    v_mfma_f32_16x16x32_bf16 v[52:55], v[12:15], a[188:191], v[52:55]
    s_nop 6
    v_add_f32_dpp v26, v48, v49 row_ror:8 row_mask:0x4 bank_mask:0xc
    s_nop 1
    v_add_f32_dpp v26, v52, v53 row_ror:8 row_mask:0x8 bank_mask:0xc
    v_mfma_f32_16x16x32_bf16 v[48:51], v[8:11], a[192:195], 0
    v_mfma_f32_16x16x32_bf16 v[52:55], v[8:11], a[200:203], 0
    v_mfma_f32_16x16x32_bf16 v[48:51], v[12:15], a[196:199], v[48:51]
    v_mfma_f32_16x16x32_bf16 v[52:55], v[12:15], a[204:207], v[52:55]
    s_nop 6
    v_add_f32_dpp v27, v49, v48 row_ror:8 row_mask:0x1 bank_mask:0x3
    s_nop 1
    v_add_f32_dpp v27, v53, v52 row_ror:8 row_mask:0x2 bank_mask:0x3
    v_mfma_f32_16x16x32_bf16 v[48:51], v[8:11], a[208:211], 0
    v_mfma_f32_16x16x32_bf16 v[52:55], v[8:11], a[216:219], 0
    v_mfma_f32_16x16x32_bf16 v[48:51], v[12:15], a[212:215], v[48:51]
    v_mfma_f32_16x16x32_bf16 v[52:55], v[12:15], a[220:223], v[52:55]
    s_waitcnt vmcnt(11)
    buffer_load_dwordx4 v[148:151], v3, s[12:15], s33 offen offset:1024 nt
    s_nop 4
    v_add_f32_dpp v27, v49, v48 row_ror:8 row_mask:0x4 bank_mask:0x3
    s_nop 1
    v_add_f32_dpp v27, v53, v52 row_ror:8 row_mask:0x8 bank_mask:0x3
    v_mfma_f32_16x16x32_bf16 v[48:51], v[8:11], a[224:227], 0
    v_mfma_f32_16x16x32_bf16 v[52:55], v[8:11], a[232:235], 0
    v_mfma_f32_16x16x32_bf16 v[48:51], v[12:15], a[228:231], v[48:51]
    v_mfma_f32_16x16x32_bf16 v[52:55], v[12:15], a[236:239], v[52:55]
    s_nop 6
    v_add_f32_dpp v27, v48, v49 row_ror:8 row_mask:0x1 bank_mask:0xc
    s_nop 1
    v_add_f32_dpp v27, v52, v53 row_ror:8 row_mask:0x2 bank_mask:0xc
    v_mfma_f32_16x16x32_bf16 v[48:51], v[8:11], a[240:243], 0
    v_mfma_f32_16x16x32_bf16 v[52:55], v[8:11], a[248:251], 0
    v_mfma_f32_16x16x32_bf16 v[48:51], v[12:15], a[244:247], v[48:51]
    v_mfma_f32_16x16x32_bf16 v[52:55], v[12:15], a[252:255], v[52:55]
    s_nop 6
    v_add_f32_dpp v27, v48, v49 row_ror:8 row_mask:0x4 bank_mask:0xc
    s_nop 1
    v_add_f32_dpp v27, v52, v53 row_ror:8 row_mask:0x8 bank_mask:0xc
    v_mfma_f32_16x16x32_bf16 v[48:51], v[8:11], v[64:67], 0
    v_mfma_f32_16x16x32_bf16 v[52:55], v[8:11], v[72:75], 0
    v_mfma_f32_16x16x32_bf16 v[48:51], v[12:15], v[68:71], v[48:51]
    v_mfma_f32_16x16x32_bf16 v[52:55], v[12:15], v[76:79], v[52:55]
    s_waitcnt vmcnt(11)
    buffer_load_dwordx4 v[152:155], v3, s[12:15], s33 offen offset:2048 nt
    s_nop 4
    v_add_f32_dpp v28, v49, v48 row_ror:8 row_mask:0x1 bank_mask:0x3
    s_nop 1
    v_add_f32_dpp v28, v53, v52 row_ror:8 row_mask:0x2 bank_mask:0x3
    v_mfma_f32_16x16x32_bf16 v[48:51], v[8:11], v[80:83], 0
    v_mfma_f32_16x16x32_bf16 v[52:55], v[8:11], v[88:91], 0
    v_mfma_f32_16x16x32_bf16 v[48:51], v[12:15], v[84:87], v[48:51]
    v_mfma_f32_16x16x32_bf16 v[52:55], v[12:15], v[92:95], v[52:55]
    s_nop 6
    v_add_f32_dpp v28, v49, v48 row_ror:8 row_mask:0x4 bank_mask:0x3
    s_nop 1
    v_add_f32_dpp v28, v53, v52 row_ror:8 row_mask:0x8 bank_mask:0x3
    v_mfma_f32_16x16x32_bf16 v[48:51], v[8:11], v[96:99], 0
    v_mfma_f32_16x16x32_bf16 v[52:55], v[8:11], v[104:107], 0
    v_mfma_f32_16x16x32_bf16 v[48:51], v[12:15], v[100:103], v[48:51]
    v_mfma_f32_16x16x32_bf16 v[52:55], v[12:15], v[108:111], v[52:55]
    s_nop 6
    v_add_f32_dpp v28, v48, v49 row_ror:8 row_mask:0x1 bank_mask:0xc
    s_nop 1
    v_add_f32_dpp v28, v52, v53 row_ror:8 row_mask:0x2 bank_mask:0xc
    v_mfma_f32_16x16x32_bf16 v[48:51], v[8:11], v[112:115], 0
    v_mfma_f32_16x16x32_bf16 v[52:55], v[8:11], v[120:123], 0
    v_mfma_f32_16x16x32_bf16 v[48:51], v[12:15], v[116:119], v[48:51]
    v_mfma_f32_16x16x32_bf16 v[52:55], v[12:15], v[124:127], v[52:55]
    s_nop 6
    v_add_f32_dpp v28, v48, v49 row_ror:8 row_mask:0x4 bank_mask:0xc
    s_nop 1
    v_add_f32_dpp v28, v52, v53 row_ror:8 row_mask:0x8 bank_mask:0xc
    v_cvt_pk_bf16_f32 v48, v24, v25
    v_lshlrev_b32 v24, 16, v48
    v_and_b32 v25, 0xffff0000, v48
    v_mul_f32 v24, 0x3db504f3, v24
    v_mul_f32 v25, 0x3db504f3, v25
    v_cvt_pk_bf16_f32 v48, v24, v25
    v_lshlrev_b32 v24, 16, v48
    v_and_b32 v25, 0xffff0000, v48
    v_cvt_pk_bf16_f32 v48, v26, v27
    v_lshlrev_b32 v26, 16, v48
    v_and_b32 v27, 0xffff0000, v48
    v_mul_f32 v26, 0x3db504f3, v26
    v_mul_f32 v27, 0x3db504f3, v27
    v_cvt_pk_bf16_f32 v48, v26, v27
    v_lshlrev_b32 v26, 16, v48
    v_and_b32 v27, 0xffff0000, v48
    v_cvt_pk_bf16_f32 v48, v28, v28
    v_lshlrev_b32 v28, 16, v48
    v_mul_f32 v28, 0x3db504f3, v28
    v_cvt_pk_bf16_f32 v48, v28, v28
    v_lshlrev_b32 v28, 16, v48
    v_mov_b32 v48, 0xff800000
    v_cndmask_b32 v28, v28, v48, s[64:65]
    v_max_f32 v34, v24, v25
    v_max3_f32 v34, v34, v26, v27
    v_max_f32 v34, v34, v28
    s_nop 1
    v_max_f32_dpp v34, v34, v34 quad_perm:[1,0,3,2] row_mask:0xf bank_mask:0xf
    s_nop 1
    v_max_f32_dpp v34, v34, v34 quad_perm:[2,3,0,1] row_mask:0xf bank_mask:0xf
    s_nop 1
    v_max_f32_dpp v34, v34, v34 row_ror:4 row_mask:0xf bank_mask:0xf
    s_nop 1
    v_max_f32_dpp v34, v34, v34 row_ror:8 row_mask:0xf bank_mask:0xf
    v_mov_b32 v48, v34
    s_nop 1
    v_permlane16_swap_b32 v34, v48
    v_max_f32 v34, v34, v48
    v_mov_b32 v48, v34
    s_nop 1
    v_permlane32_swap_b32 v34, v48
    v_max_f32 v34, v34, v48
    v_sub_f32 v24, v24, v34
    v_mul_f32 v24, 0x3fb8aa3b, v24
    v_exp_f32 v24, v24
    v_sub_f32 v25, v25, v34
    v_mul_f32 v25, 0x3fb8aa3b, v25
    v_exp_f32 v25, v25
    v_sub_f32 v26, v26, v34
    v_mul_f32 v26, 0x3fb8aa3b, v26
    v_exp_f32 v26, v26
    v_sub_f32 v27, v27, v34
    v_mul_f32 v27, 0x3fb8aa3b, v27
    v_exp_f32 v27, v27
    v_sub_f32 v28, v28, v34
    v_mul_f32 v28, 0x3fb8aa3b, v28
    v_exp_f32 v28, v28
    v_add_f32 v35, v24, v25
    v_add_f32 v48, v26, v27
    v_add_f32 v35, v35, v28
    v_add_f32 v35, v35, v48
    v_cvt_pk_bf16_f32 v24, v24, v24
    v_cvt_pk_bf16_f32 v25, v25, v25
    v_cvt_pk_bf16_f32 v26, v26, v26
    v_cvt_pk_bf16_f32 v27, v27, v27
    v_cvt_pk_bf16_f32 v28, v28, v28
    s_waitcnt vmcnt(11)
    buffer_load_dwordx4 v[156:159], v3, s[12:15], s33 offen offset:3072 nt
    s_waitcnt vmcnt(11)
    buffer_load_dwordx4 v[160:163], v2, s[12:15], s34 offen offset:0 nt
    ds_read_b128 v[56:59], v0 offset:0
    v_and_b32_dpp v48, v24, v4 row_newbcast:0 row_mask:0xf bank_mask:0xf
    v_and_b32_dpp v49, v24, v5 row_newbcast:0 row_mask:0xf bank_mask:0xf
    v_and_b32_dpp v50, v24, v6 row_newbcast:0 row_mask:0xf bank_mask:0xf
    v_and_b32_dpp v51, v24, v7 row_newbcast:0 row_mask:0xf bank_mask:0xf
    ds_read_b128 v[60:63], v0 offset:1024
    v_and_b32_dpp v52, v24, v4 row_newbcast:1 row_mask:0xf bank_mask:0xf
    v_and_b32_dpp v53, v24, v5 row_newbcast:1 row_mask:0xf bank_mask:0xf
    v_and_b32_dpp v54, v24, v6 row_newbcast:1 row_mask:0xf bank_mask:0xf
    v_and_b32_dpp v55, v24, v7 row_newbcast:1 row_mask:0xf bank_mask:0xf
    s_waitcnt lgkmcnt(1)
    v_mfma_f32_16x16x32_bf16 v[44:47], v[48:51], v[56:59], 0
    ds_read_b128 v[56:59], v0 offset:2048
    v_and_b32_dpp v48, v24, v4 row_newbcast:2 row_mask:0xf bank_mask:0xf
    v_and_b32_dpp v49, v24, v5 row_newbcast:2 row_mask:0xf bank_mask:0xf
    v_and_b32_dpp v50, v24, v6 row_newbcast:2 row_mask:0xf bank_mask:0xf
    v_and_b32_dpp v51, v24, v7 row_newbcast:2 row_mask:0xf bank_mask:0xf
    s_waitcnt lgkmcnt(1)
    v_mfma_f32_16x16x32_bf16 v[44:47], v[52:55], v[60:63], v[44:47]
    ds_read_b128 v[60:63], v0 offset:3072
    v_and_b32_dpp v52, v24, v4 row_newbcast:3 row_mask:0xf bank_mask:0xf
    v_and_b32_dpp v53, v24, v5 row_newbcast:3 row_mask:0xf bank_mask:0xf
    v_and_b32_dpp v54, v24, v6 row_newbcast:3 row_mask:0xf bank_mask:0xf
    v_and_b32_dpp v55, v24, v7 row_newbcast:3 row_mask:0xf bank_mask:0xf
    s_waitcnt lgkmcnt(1)
    v_mfma_f32_16x16x32_bf16 v[44:47], v[48:51], v[56:59], v[44:47]
    ds_read_b128 v[56:59], v0 offset:4096
    v_and_b32_dpp v48, v24, v4 row_newbcast:4 row_mask:0xf bank_mask:0xf
    v_and_b32_dpp v49, v24, v5 row_newbcast:4 row_mask:0xf bank_mask:0xf
    v_and_b32_dpp v50, v24, v6 row_newbcast:4 row_mask:0xf bank_mask:0xf
    v_and_b32_dpp v51, v24, v7 row_newbcast:4 row_mask:0xf bank_mask:0xf
    s_waitcnt lgkmcnt(1)
    v_mfma_f32_16x16x32_bf16 v[44:47], v[52:55], v[60:63], v[44:47]
    ds_read_b128 v[60:63], v0 offset:5120
    v_and_b32_dpp v52, v24, v4 row_newbcast:5 row_mask:0xf bank_mask:0xf
    v_and_b32_dpp v53, v24, v5 row_newbcast:5 row_mask:0xf bank_mask:0xf
    v_and_b32_dpp v54, v24, v6 row_newbcast:5 row_mask:0xf bank_mask:0xf
    v_and_b32_dpp v55, v24, v7 row_newbcast:5 row_mask:0xf bank_mask:0xf
    s_waitcnt lgkmcnt(1)
    v_mfma_f32_16x16x32_bf16 v[44:47], v[48:51], v[56:59], v[44:47]
    ds_read_b128 v[56:59], v0 offset:6144
    v_and_b32_dpp v48, v24, v4 row_newbcast:6 row_mask:0xf bank_mask:0xf
    v_and_b32_dpp v49, v24, v5 row_newbcast:6 row_mask:0xf bank_mask:0xf
    v_and_b32_dpp v50, v24, v6 row_newbcast:6 row_mask:0xf bank_mask:0xf
    v_and_b32_dpp v51, v24, v7 row_newbcast:6 row_mask:0xf bank_mask:0xf
    s_waitcnt lgkmcnt(1)
    v_mfma_f32_16x16x32_bf16 v[44:47], v[52:55], v[60:63], v[44:47]
    ds_read_b128 v[60:63], v0 offset:7168
    v_and_b32_dpp v52, v24, v4 row_newbcast:7 row_mask:0xf bank_mask:0xf
    v_and_b32_dpp v53, v24, v5 row_newbcast:7 row_mask:0xf bank_mask:0xf
    v_and_b32_dpp v54, v24, v6 row_newbcast:7 row_mask:0xf bank_mask:0xf
    v_and_b32_dpp v55, v24, v7 row_newbcast:7 row_mask:0xf bank_mask:0xf
    s_waitcnt lgkmcnt(1)
    v_mfma_f32_16x16x32_bf16 v[44:47], v[48:51], v[56:59], v[44:47]
    ds_read_b128 v[56:59], v0 offset:8192
    v_and_b32_dpp v48, v24, v4 row_newbcast:8 row_mask:0xf bank_mask:0xf
    v_and_b32_dpp v49, v24, v5 row_newbcast:8 row_mask:0xf bank_mask:0xf
    v_and_b32_dpp v50, v24, v6 row_newbcast:8 row_mask:0xf bank_mask:0xf
    v_and_b32_dpp v51, v24, v7 row_newbcast:8 row_mask:0xf bank_mask:0xf
    s_waitcnt lgkmcnt(1)
    v_mfma_f32_16x16x32_bf16 v[44:47], v[52:55], v[60:63], v[44:47]
    ds_read_b128 v[60:63], v0 offset:9216
    v_and_b32_dpp v52, v24, v4 row_newbcast:9 row_mask:0xf bank_mask:0xf
    v_and_b32_dpp v53, v24, v5 row_newbcast:9 row_mask:0xf bank_mask:0xf
    v_and_b32_dpp v54, v24, v6 row_newbcast:9 row_mask:0xf bank_mask:0xf
    v_and_b32_dpp v55, v24, v7 row_newbcast:9 row_mask:0xf bank_mask:0xf
    s_waitcnt lgkmcnt(1)
    v_mfma_f32_16x16x32_bf16 v[44:47], v[48:51], v[56:59], v[44:47]
    ds_read_b128 v[56:59], v0 offset:10240
    v_and_b32_dpp v48, v24, v4 row_newbcast:10 row_mask:0xf bank_mask:0xf
    v_and_b32_dpp v49, v24, v5 row_newbcast:10 row_mask:0xf bank_mask:0xf
    v_and_b32_dpp v50, v24, v6 row_newbcast:10 row_mask:0xf bank_mask:0xf
    v_and_b32_dpp v51, v24, v7 row_newbcast:10 row_mask:0xf bank_mask:0xf
    s_waitcnt lgkmcnt(1)
    v_mfma_f32_16x16x32_bf16 v[44:47], v[52:55], v[60:63], v[44:47]
    ds_read_b128 v[60:63], v0 offset:11264
    v_and_b32_dpp v52, v24, v4 row_newbcast:11 row_mask:0xf bank_mask:0xf
    v_and_b32_dpp v53, v24, v5 row_newbcast:11 row_mask:0xf bank_mask:0xf
    v_and_b32_dpp v54, v24, v6 row_newbcast:11 row_mask:0xf bank_mask:0xf
    v_and_b32_dpp v55, v24, v7 row_newbcast:11 row_mask:0xf bank_mask:0xf
    s_waitcnt lgkmcnt(1)
    v_mfma_f32_16x16x32_bf16 v[44:47], v[48:51], v[56:59], v[44:47]
    s_waitcnt vmcnt(11)
    buffer_load_dwordx4 v[164:167], v2, s[12:15], s34 offen offset:1024 nt
    ds_read_b128 v[56:59], v0 offset:12288
    v_and_b32_dpp v48, v24, v4 row_newbcast:12 row_mask:0xf bank_mask:0xf
    v_and_b32_dpp v49, v24, v5 row_newbcast:12 row_mask:0xf bank_mask:0xf
    v_and_b32_dpp v50, v24, v6 row_newbcast:12 row_mask:0xf bank_mask:0xf
    v_and_b32_dpp v51, v24, v7 row_newbcast:12 row_mask:0xf bank_mask:0xf
    s_waitcnt lgkmcnt(1)
    v_mfma_f32_16x16x32_bf16 v[44:47], v[52:55], v[60:63], v[44:47]
    ds_read_b128 v[60:63], v0 offset:13312
    v_and_b32_dpp v52, v24, v4 row_newbcast:13 row_mask:0xf bank_mask:0xf
    v_and_b32_dpp v53, v24, v5 row_newbcast:13 row_mask:0xf bank_mask:0xf
    v_and_b32_dpp v54, v24, v6 row_newbcast:13 row_mask:0xf bank_mask:0xf
    v_and_b32_dpp v55, v24, v7 row_newbcast:13 row_mask:0xf bank_mask:0xf
    s_waitcnt lgkmcnt(1)
    v_mfma_f32_16x16x32_bf16 v[44:47], v[48:51], v[56:59], v[44:47]
    ds_read_b128 v[56:59], v0 offset:14336
    v_and_b32_dpp v48, v24, v4 row_newbcast:14 row_mask:0xf bank_mask:0xf
    v_and_b32_dpp v49, v24, v5 row_newbcast:14 row_mask:0xf bank_mask:0xf
    v_and_b32_dpp v50, v24, v6 row_newbcast:14 row_mask:0xf bank_mask:0xf
    v_and_b32_dpp v51, v24, v7 row_newbcast:14 row_mask:0xf bank_mask:0xf
    s_waitcnt lgkmcnt(1)
    v_mfma_f32_16x16x32_bf16 v[44:47], v[52:55], v[60:63], v[44:47]
    ds_read_b128 v[60:63], v0 offset:15360
    v_and_b32_dpp v52, v24, v4 row_newbcast:15 row_mask:0xf bank_mask:0xf
    v_and_b32_dpp v53, v24, v5 row_newbcast:15 row_mask:0xf bank_mask:0xf
    v_and_b32_dpp v54, v24, v6 row_newbcast:15 row_mask:0xf bank_mask:0xf
    v_and_b32_dpp v55, v24, v7 row_newbcast:15 row_mask:0xf bank_mask:0xf
    s_waitcnt lgkmcnt(1)
    v_mfma_f32_16x16x32_bf16 v[44:47], v[48:51], v[56:59], v[44:47]
    ds_read_b128 v[56:59], v0 offset:16384
    v_and_b32_dpp v48, v25, v4 row_newbcast:0 row_mask:0xf bank_mask:0xf
    v_and_b32_dpp v49, v25, v5 row_newbcast:0 row_mask:0xf bank_mask:0xf
    v_and_b32_dpp v50, v25, v6 row_newbcast:0 row_mask:0xf bank_mask:0xf
    v_and_b32_dpp v51, v25, v7 row_newbcast:0 row_mask:0xf bank_mask:0xf
    s_waitcnt lgkmcnt(1)
    v_mfma_f32_16x16x32_bf16 v[44:47], v[52:55], v[60:63], v[44:47]
    ds_read_b128 v[60:63], v0 offset:17408
    v_and_b32_dpp v52, v25, v4 row_newbcast:1 row_mask:0xf bank_mask:0xf
    v_and_b32_dpp v53, v25, v5 row_newbcast:1 row_mask:0xf bank_mask:0xf
    v_and_b32_dpp v54, v25, v6 row_newbcast:1 row_mask:0xf bank_mask:0xf
    v_and_b32_dpp v55, v25, v7 row_newbcast:1 row_mask:0xf bank_mask:0xf
    s_waitcnt lgkmcnt(1)
    v_mfma_f32_16x16x32_bf16 v[44:47], v[48:51], v[56:59], v[44:47]
    ds_read_b128 v[56:59], v0 offset:18432
    v_and_b32_dpp v48, v25, v4 row_newbcast:2 row_mask:0xf bank_mask:0xf
    v_and_b32_dpp v49, v25, v5 row_newbcast:2 row_mask:0xf bank_mask:0xf
    v_and_b32_dpp v50, v25, v6 row_newbcast:2 row_mask:0xf bank_mask:0xf
    v_and_b32_dpp v51, v25, v7 row_newbcast:2 row_mask:0xf bank_mask:0xf
    s_waitcnt lgkmcnt(1)
    v_mfma_f32_16x16x32_bf16 v[44:47], v[52:55], v[60:63], v[44:47]
    ds_read_b128 v[60:63], v0 offset:19456
    v_and_b32_dpp v52, v25, v4 row_newbcast:3 row_mask:0xf bank_mask:0xf
    v_and_b32_dpp v53, v25, v5 row_newbcast:3 row_mask:0xf bank_mask:0xf
    v_and_b32_dpp v54, v25, v6 row_newbcast:3 row_mask:0xf bank_mask:0xf
    v_and_b32_dpp v55, v25, v7 row_newbcast:3 row_mask:0xf bank_mask:0xf
    s_waitcnt lgkmcnt(1)
    v_mfma_f32_16x16x32_bf16 v[44:47], v[48:51], v[56:59], v[44:47]
    ds_read_b128 v[56:59], v0 offset:20480
    v_and_b32_dpp v48, v25, v4 row_newbcast:4 row_mask:0xf bank_mask:0xf
    v_and_b32_dpp v49, v25, v5 row_newbcast:4 row_mask:0xf bank_mask:0xf
    v_and_b32_dpp v50, v25, v6 row_newbcast:4 row_mask:0xf bank_mask:0xf
    v_and_b32_dpp v51, v25, v7 row_newbcast:4 row_mask:0xf bank_mask:0xf
    s_waitcnt lgkmcnt(1)
    v_mfma_f32_16x16x32_bf16 v[44:47], v[52:55], v[60:63], v[44:47]
    ds_read_b128 v[60:63], v0 offset:21504
    v_and_b32_dpp v52, v25, v4 row_newbcast:5 row_mask:0xf bank_mask:0xf
    v_and_b32_dpp v53, v25, v5 row_newbcast:5 row_mask:0xf bank_mask:0xf
    v_and_b32_dpp v54, v25, v6 row_newbcast:5 row_mask:0xf bank_mask:0xf
    v_and_b32_dpp v55, v25, v7 row_newbcast:5 row_mask:0xf bank_mask:0xf
    s_waitcnt lgkmcnt(1)
    v_mfma_f32_16x16x32_bf16 v[44:47], v[48:51], v[56:59], v[44:47]
    ds_read_b128 v[56:59], v0 offset:22528
    v_and_b32_dpp v48, v25, v4 row_newbcast:6 row_mask:0xf bank_mask:0xf
    v_and_b32_dpp v49, v25, v5 row_newbcast:6 row_mask:0xf bank_mask:0xf
    v_and_b32_dpp v50, v25, v6 row_newbcast:6 row_mask:0xf bank_mask:0xf
    v_and_b32_dpp v51, v25, v7 row_newbcast:6 row_mask:0xf bank_mask:0xf
    s_waitcnt lgkmcnt(1)
    v_mfma_f32_16x16x32_bf16 v[44:47], v[52:55], v[60:63], v[44:47]
    s_waitcnt vmcnt(11)
    buffer_load_dwordx4 v[168:171], v2, s[12:15], s34 offen offset:2048 nt
    ds_read_b128 v[60:63], v0 offset:23552
    v_and_b32_dpp v52, v25, v4 row_newbcast:7 row_mask:0xf bank_mask:0xf
    v_and_b32_dpp v53, v25, v5 row_newbcast:7 row_mask:0xf bank_mask:0xf
    v_and_b32_dpp v54, v25, v6 row_newbcast:7 row_mask:0xf bank_mask:0xf
    v_and_b32_dpp v55, v25, v7 row_newbcast:7 row_mask:0xf bank_mask:0xf
    s_waitcnt lgkmcnt(1)
    v_mfma_f32_16x16x32_bf16 v[44:47], v[48:51], v[56:59], v[44:47]
    ds_read_b128 v[56:59], v0 offset:24576
    v_and_b32_dpp v48, v25, v4 row_newbcast:8 row_mask:0xf bank_mask:0xf
    v_and_b32_dpp v49, v25, v5 row_newbcast:8 row_mask:0xf bank_mask:0xf
    v_and_b32_dpp v50, v25, v6 row_newbcast:8 row_mask:0xf bank_mask:0xf
    v_and_b32_dpp v51, v25, v7 row_newbcast:8 row_mask:0xf bank_mask:0xf
    s_waitcnt lgkmcnt(1)
    v_mfma_f32_16x16x32_bf16 v[44:47], v[52:55], v[60:63], v[44:47]
    ds_read_b128 v[60:63], v0 offset:25600
    v_and_b32_dpp v52, v25, v4 row_newbcast:9 row_mask:0xf bank_mask:0xf
    v_and_b32_dpp v53, v25, v5 row_newbcast:9 row_mask:0xf bank_mask:0xf
    v_and_b32_dpp v54, v25, v6 row_newbcast:9 row_mask:0xf bank_mask:0xf
    v_and_b32_dpp v55, v25, v7 row_newbcast:9 row_mask:0xf bank_mask:0xf
    s_waitcnt lgkmcnt(1)
    v_mfma_f32_16x16x32_bf16 v[44:47], v[48:51], v[56:59], v[44:47]
    ds_read_b128 v[56:59], v0 offset:26624
    v_and_b32_dpp v48, v25, v4 row_newbcast:10 row_mask:0xf bank_mask:0xf
    v_and_b32_dpp v49, v25, v5 row_newbcast:10 row_mask:0xf bank_mask:0xf
    v_and_b32_dpp v50, v25, v6 row_newbcast:10 row_mask:0xf bank_mask:0xf
    v_and_b32_dpp v51, v25, v7 row_newbcast:10 row_mask:0xf bank_mask:0xf
    s_waitcnt lgkmcnt(1)
    v_mfma_f32_16x16x32_bf16 v[44:47], v[52:55], v[60:63], v[44:47]
    ds_read_b128 v[60:63], v0 offset:27648
    v_and_b32_dpp v52, v25, v4 row_newbcast:11 row_mask:0xf bank_mask:0xf
    v_and_b32_dpp v53, v25, v5 row_newbcast:11 row_mask:0xf bank_mask:0xf
    v_and_b32_dpp v54, v25, v6 row_newbcast:11 row_mask:0xf bank_mask:0xf
    v_and_b32_dpp v55, v25, v7 row_newbcast:11 row_mask:0xf bank_mask:0xf
    s_waitcnt lgkmcnt(1)
    v_mfma_f32_16x16x32_bf16 v[44:47], v[48:51], v[56:59], v[44:47]
    ds_read_b128 v[56:59], v0 offset:28672
    v_and_b32_dpp v48, v25, v4 row_newbcast:12 row_mask:0xf bank_mask:0xf
    v_and_b32_dpp v49, v25, v5 row_newbcast:12 row_mask:0xf bank_mask:0xf
    v_and_b32_dpp v50, v25, v6 row_newbcast:12 row_mask:0xf bank_mask:0xf
    v_and_b32_dpp v51, v25, v7 row_newbcast:12 row_mask:0xf bank_mask:0xf
    s_waitcnt lgkmcnt(1)
    v_mfma_f32_16x16x32_bf16 v[44:47], v[52:55], v[60:63], v[44:47]
    ds_read_b128 v[60:63], v0 offset:29696
    v_and_b32_dpp v52, v25, v4 row_newbcast:13 row_mask:0xf bank_mask:0xf
    v_and_b32_dpp v53, v25, v5 row_newbcast:13 row_mask:0xf bank_mask:0xf
    v_and_b32_dpp v54, v25, v6 row_newbcast:13 row_mask:0xf bank_mask:0xf
    v_and_b32_dpp v55, v25, v7 row_newbcast:13 row_mask:0xf bank_mask:0xf
    s_waitcnt lgkmcnt(1)
    v_mfma_f32_16x16x32_bf16 v[44:47], v[48:51], v[56:59], v[44:47]
    ds_read_b128 v[56:59], v0 offset:30720
    v_and_b32_dpp v48, v25, v4 row_newbcast:14 row_mask:0xf bank_mask:0xf
    v_and_b32_dpp v49, v25, v5 row_newbcast:14 row_mask:0xf bank_mask:0xf
    v_and_b32_dpp v50, v25, v6 row_newbcast:14 row_mask:0xf bank_mask:0xf
    v_and_b32_dpp v51, v25, v7 row_newbcast:14 row_mask:0xf bank_mask:0xf
    s_waitcnt lgkmcnt(1)
    v_mfma_f32_16x16x32_bf16 v[44:47], v[52:55], v[60:63], v[44:47]
    ds_read_b128 v[60:63], v0 offset:31744
    v_and_b32_dpp v52, v25, v4 row_newbcast:15 row_mask:0xf bank_mask:0xf
    v_and_b32_dpp v53, v25, v5 row_newbcast:15 row_mask:0xf bank_mask:0xf
    v_and_b32_dpp v54, v25, v6 row_newbcast:15 row_mask:0xf bank_mask:0xf
    v_and_b32_dpp v55, v25, v7 row_newbcast:15 row_mask:0xf bank_mask:0xf
    s_waitcnt lgkmcnt(1)
    v_mfma_f32_16x16x32_bf16 v[44:47], v[48:51], v[56:59], v[44:47]
    ds_read_b128 v[56:59], v0 offset:32768
    v_and_b32_dpp v48, v26, v4 row_newbcast:0 row_mask:0xf bank_mask:0xf
    v_and_b32_dpp v49, v26, v5 row_newbcast:0 row_mask:0xf bank_mask:0xf
    v_and_b32_dpp v50, v26, v6 row_newbcast:0 row_mask:0xf bank_mask:0xf
    v_and_b32_dpp v51, v26, v7 row_newbcast:0 row_mask:0xf bank_mask:0xf
    s_waitcnt lgkmcnt(1)
    v_mfma_f32_16x16x32_bf16 v[44:47], v[52:55], v[60:63], v[44:47]
    ds_read_b128 v[60:63], v0 offset:33792
    v_and_b32_dpp v52, v26, v4 row_newbcast:1 row_mask:0xf bank_mask:0xf
    v_and_b32_dpp v53, v26, v5 row_newbcast:1 row_mask:0xf bank_mask:0xf
    v_and_b32_dpp v54, v26, v6 row_newbcast:1 row_mask:0xf bank_mask:0xf
    v_and_b32_dpp v55, v26, v7 row_newbcast:1 row_mask:0xf bank_mask:0xf
    s_waitcnt lgkmcnt(1)
    v_mfma_f32_16x16x32_bf16 v[44:47], v[48:51], v[56:59], v[44:47]
    s_waitcnt vmcnt(11)
    buffer_load_dwordx4 v[172:175], v2, s[12:15], s34 offen offset:3072 nt
    ds_read_b128 v[56:59], v0 offset:34816
    v_and_b32_dpp v48, v26, v4 row_newbcast:2 row_mask:0xf bank_mask:0xf
    v_and_b32_dpp v49, v26, v5 row_newbcast:2 row_mask:0xf bank_mask:0xf
    v_and_b32_dpp v50, v26, v6 row_newbcast:2 row_mask:0xf bank_mask:0xf
    v_and_b32_dpp v51, v26, v7 row_newbcast:2 row_mask:0xf bank_mask:0xf
    s_waitcnt lgkmcnt(1)
    v_mfma_f32_16x16x32_bf16 v[44:47], v[52:55], v[60:63], v[44:47]
    ds_read_b128 v[60:63], v0 offset:35840
    v_and_b32_dpp v52, v26, v4 row_newbcast:3 row_mask:0xf bank_mask:0xf
    v_and_b32_dpp v53, v26, v5 row_newbcast:3 row_mask:0xf bank_mask:0xf
    v_and_b32_dpp v54, v26, v6 row_newbcast:3 row_mask:0xf bank_mask:0xf
    v_and_b32_dpp v55, v26, v7 row_newbcast:3 row_mask:0xf bank_mask:0xf
    s_waitcnt lgkmcnt(1)
    v_mfma_f32_16x16x32_bf16 v[44:47], v[48:51], v[56:59], v[44:47]
    ds_read_b128 v[56:59], v0 offset:36864
    v_and_b32_dpp v48, v26, v4 row_newbcast:4 row_mask:0xf bank_mask:0xf
    v_and_b32_dpp v49, v26, v5 row_newbcast:4 row_mask:0xf bank_mask:0xf
    v_and_b32_dpp v50, v26, v6 row_newbcast:4 row_mask:0xf bank_mask:0xf
    v_and_b32_dpp v51, v26, v7 row_newbcast:4 row_mask:0xf bank_mask:0xf
    s_waitcnt lgkmcnt(1)
    v_mfma_f32_16x16x32_bf16 v[44:47], v[52:55], v[60:63], v[44:47]
    ds_read_b128 v[60:63], v0 offset:37888
    v_and_b32_dpp v52, v26, v4 row_newbcast:5 row_mask:0xf bank_mask:0xf
    v_and_b32_dpp v53, v26, v5 row_newbcast:5 row_mask:0xf bank_mask:0xf
    v_and_b32_dpp v54, v26, v6 row_newbcast:5 row_mask:0xf bank_mask:0xf
    v_and_b32_dpp v55, v26, v7 row_newbcast:5 row_mask:0xf bank_mask:0xf
    s_waitcnt lgkmcnt(1)
    v_mfma_f32_16x16x32_bf16 v[44:47], v[48:51], v[56:59], v[44:47]
    ds_read_b128 v[56:59], v0 offset:38912
    v_and_b32_dpp v48, v26, v4 row_newbcast:6 row_mask:0xf bank_mask:0xf
    v_and_b32_dpp v49, v26, v5 row_newbcast:6 row_mask:0xf bank_mask:0xf
    v_and_b32_dpp v50, v26, v6 row_newbcast:6 row_mask:0xf bank_mask:0xf
    v_and_b32_dpp v51, v26, v7 row_newbcast:6 row_mask:0xf bank_mask:0xf
    s_waitcnt lgkmcnt(1)
    v_mfma_f32_16x16x32_bf16 v[44:47], v[52:55], v[60:63], v[44:47]
    ds_read_b128 v[60:63], v0 offset:39936
    v_and_b32_dpp v52, v26, v4 row_newbcast:7 row_mask:0xf bank_mask:0xf
    v_and_b32_dpp v53, v26, v5 row_newbcast:7 row_mask:0xf bank_mask:0xf
    v_and_b32_dpp v54, v26, v6 row_newbcast:7 row_mask:0xf bank_mask:0xf
    v_and_b32_dpp v55, v26, v7 row_newbcast:7 row_mask:0xf bank_mask:0xf
    s_waitcnt lgkmcnt(1)
    v_mfma_f32_16x16x32_bf16 v[44:47], v[48:51], v[56:59], v[44:47]
    s_waitcnt vmcnt(11)
    v_and_b32_dpp v48, v26, v4 row_newbcast:8 row_mask:0xf bank_mask:0xf
    v_and_b32_dpp v49, v26, v5 row_newbcast:8 row_mask:0xf bank_mask:0xf
    v_and_b32_dpp v50, v26, v6 row_newbcast:8 row_mask:0xf bank_mask:0xf
    v_and_b32_dpp v51, v26, v7 row_newbcast:8 row_mask:0xf bank_mask:0xf
    s_waitcnt lgkmcnt(0)
    v_mfma_f32_16x16x32_bf16 v[44:47], v[52:55], v[60:63], v[44:47]
    buffer_load_dwordx4 v[176:179], v3, s[12:15], s34 offen offset:0 nt
    s_waitcnt vmcnt(11)
    v_and_b32_dpp v52, v26, v4 row_newbcast:9 row_mask:0xf bank_mask:0xf
    v_and_b32_dpp v53, v26, v5 row_newbcast:9 row_mask:0xf bank_mask:0xf
    v_and_b32_dpp v54, v26, v6 row_newbcast:9 row_mask:0xf bank_mask:0xf
    v_and_b32_dpp v55, v26, v7 row_newbcast:9 row_mask:0xf bank_mask:0xf
    v_mfma_f32_16x16x32_bf16 v[44:47], v[48:51], v[128:131], v[44:47]
    buffer_load_dwordx4 v[180:183], v3, s[12:15], s34 offen offset:1024 nt
    s_waitcnt vmcnt(11)
    v_and_b32_dpp v48, v26, v4 row_newbcast:10 row_mask:0xf bank_mask:0xf
    v_and_b32_dpp v49, v26, v5 row_newbcast:10 row_mask:0xf bank_mask:0xf
    v_and_b32_dpp v50, v26, v6 row_newbcast:10 row_mask:0xf bank_mask:0xf
    v_and_b32_dpp v51, v26, v7 row_newbcast:10 row_mask:0xf bank_mask:0xf
    v_mfma_f32_16x16x32_bf16 v[44:47], v[52:55], v[132:135], v[44:47]
    buffer_load_dwordx4 v[184:187], v3, s[12:15], s34 offen offset:2048 nt
    s_waitcnt vmcnt(11)
    v_and_b32_dpp v52, v26, v4 row_newbcast:11 row_mask:0xf bank_mask:0xf
    v_and_b32_dpp v53, v26, v5 row_newbcast:11 row_mask:0xf bank_mask:0xf
    v_and_b32_dpp v54, v26, v6 row_newbcast:11 row_mask:0xf bank_mask:0xf
    v_and_b32_dpp v55, v26, v7 row_newbcast:11 row_mask:0xf bank_mask:0xf
    v_mfma_f32_16x16x32_bf16 v[44:47], v[48:51], v[136:139], v[44:47]
    buffer_load_dwordx4 v[188:191], v3, s[12:15], s34 offen offset:3072 nt
    s_waitcnt vmcnt(11)
    v_and_b32_dpp v48, v26, v4 row_newbcast:12 row_mask:0xf bank_mask:0xf
    v_and_b32_dpp v49, v26, v5 row_newbcast:12 row_mask:0xf bank_mask:0xf
    v_and_b32_dpp v50, v26, v6 row_newbcast:12 row_mask:0xf bank_mask:0xf
    v_and_b32_dpp v51, v26, v7 row_newbcast:12 row_mask:0xf bank_mask:0xf
    v_mfma_f32_16x16x32_bf16 v[44:47], v[52:55], v[140:143], v[44:47]
    buffer_load_dwordx4 v[192:195], v2, s[12:15], s35 offen offset:0 nt
    s_waitcnt vmcnt(11)
    v_and_b32_dpp v52, v26, v4 row_newbcast:13 row_mask:0xf bank_mask:0xf
    v_and_b32_dpp v53, v26, v5 row_newbcast:13 row_mask:0xf bank_mask:0xf
    v_and_b32_dpp v54, v26, v6 row_newbcast:13 row_mask:0xf bank_mask:0xf
    v_and_b32_dpp v55, v26, v7 row_newbcast:13 row_mask:0xf bank_mask:0xf
    v_mfma_f32_16x16x32_bf16 v[44:47], v[48:51], v[144:147], v[44:47]
    buffer_load_dwordx4 v[196:199], v2, s[12:15], s35 offen offset:1024 nt
    s_waitcnt vmcnt(11)
    v_and_b32_dpp v48, v26, v4 row_newbcast:14 row_mask:0xf bank_mask:0xf
    v_and_b32_dpp v49, v26, v5 row_newbcast:14 row_mask:0xf bank_mask:0xf
    v_and_b32_dpp v50, v26, v6 row_newbcast:14 row_mask:0xf bank_mask:0xf
    v_and_b32_dpp v51, v26, v7 row_newbcast:14 row_mask:0xf bank_mask:0xf
    v_mfma_f32_16x16x32_bf16 v[44:47], v[52:55], v[148:151], v[44:47]
    buffer_load_dwordx4 v[200:203], v2, s[12:15], s35 offen offset:2048 nt
    s_waitcnt vmcnt(11)
    v_and_b32_dpp v52, v26, v4 row_newbcast:15 row_mask:0xf bank_mask:0xf
    v_and_b32_dpp v53, v26, v5 row_newbcast:15 row_mask:0xf bank_mask:0xf
    v_and_b32_dpp v54, v26, v6 row_newbcast:15 row_mask:0xf bank_mask:0xf
    v_and_b32_dpp v55, v26, v7 row_newbcast:15 row_mask:0xf bank_mask:0xf
    v_mfma_f32_16x16x32_bf16 v[44:47], v[48:51], v[152:155], v[44:47]
    buffer_load_dwordx4 v[204:207], v2, s[12:15], s35 offen offset:3072 nt
    s_waitcnt vmcnt(11)
    v_and_b32_dpp v48, v27, v4 row_newbcast:0 row_mask:0xf bank_mask:0xf
    v_and_b32_dpp v49, v27, v5 row_newbcast:0 row_mask:0xf bank_mask:0xf
    v_and_b32_dpp v50, v27, v6 row_newbcast:0 row_mask:0xf bank_mask:0xf
    v_and_b32_dpp v51, v27, v7 row_newbcast:0 row_mask:0xf bank_mask:0xf
    v_mfma_f32_16x16x32_bf16 v[44:47], v[52:55], v[156:159], v[44:47]
    buffer_load_dwordx4 v[208:211], v3, s[12:15], s35 offen offset:0 nt
    s_waitcnt vmcnt(11)
    v_and_b32_dpp v52, v27, v4 row_newbcast:1 row_mask:0xf bank_mask:0xf
    v_and_b32_dpp v53, v27, v5 row_newbcast:1 row_mask:0xf bank_mask:0xf
    v_and_b32_dpp v54, v27, v6 row_newbcast:1 row_mask:0xf bank_mask:0xf
    v_and_b32_dpp v55, v27, v7 row_newbcast:1 row_mask:0xf bank_mask:0xf
    v_mfma_f32_16x16x32_bf16 v[44:47], v[48:51], v[160:163], v[44:47]
    buffer_load_dwordx4 v[212:215], v3, s[12:15], s35 offen offset:1024 nt
    s_waitcnt vmcnt(11)
    v_and_b32_dpp v48, v27, v4 row_newbcast:2 row_mask:0xf bank_mask:0xf
    v_and_b32_dpp v49, v27, v5 row_newbcast:2 row_mask:0xf bank_mask:0xf
    v_and_b32_dpp v50, v27, v6 row_newbcast:2 row_mask:0xf bank_mask:0xf
    v_and_b32_dpp v51, v27, v7 row_newbcast:2 row_mask:0xf bank_mask:0xf
    v_mfma_f32_16x16x32_bf16 v[44:47], v[52:55], v[164:167], v[44:47]
    buffer_load_dwordx4 v[216:219], v3, s[12:15], s35 offen offset:2048 nt
    s_waitcnt vmcnt(11)
    v_and_b32_dpp v52, v27, v4 row_newbcast:3 row_mask:0xf bank_mask:0xf
    v_and_b32_dpp v53, v27, v5 row_newbcast:3 row_mask:0xf bank_mask:0xf
    v_and_b32_dpp v54, v27, v6 row_newbcast:3 row_mask:0xf bank_mask:0xf
    v_and_b32_dpp v55, v27, v7 row_newbcast:3 row_mask:0xf bank_mask:0xf
    v_mfma_f32_16x16x32_bf16 v[44:47], v[48:51], v[168:171], v[44:47]
    buffer_load_dwordx4 v[220:223], v3, s[12:15], s35 offen offset:3072 nt
    s_waitcnt vmcnt(11)
    v_and_b32_dpp v48, v27, v4 row_newbcast:4 row_mask:0xf bank_mask:0xf
    v_and_b32_dpp v49, v27, v5 row_newbcast:4 row_mask:0xf bank_mask:0xf
    v_and_b32_dpp v50, v27, v6 row_newbcast:4 row_mask:0xf bank_mask:0xf
    v_and_b32_dpp v51, v27, v7 row_newbcast:4 row_mask:0xf bank_mask:0xf
    v_mfma_f32_16x16x32_bf16 v[44:47], v[52:55], v[172:175], v[44:47]
    buffer_load_dwordx4 v[224:227], v2, s[12:15], s36 offen offset:0 nt
    s_waitcnt vmcnt(11)
    v_and_b32_dpp v52, v27, v4 row_newbcast:5 row_mask:0xf bank_mask:0xf
    v_and_b32_dpp v53, v27, v5 row_newbcast:5 row_mask:0xf bank_mask:0xf
    v_and_b32_dpp v54, v27, v6 row_newbcast:5 row_mask:0xf bank_mask:0xf
    v_and_b32_dpp v55, v27, v7 row_newbcast:5 row_mask:0xf bank_mask:0xf
    v_mfma_f32_16x16x32_bf16 v[44:47], v[48:51], v[176:179], v[44:47]
    buffer_load_dwordx4 v[228:231], v2, s[12:15], s36 offen offset:1024 nt
    s_waitcnt vmcnt(11)
    v_and_b32_dpp v48, v27, v4 row_newbcast:6 row_mask:0xf bank_mask:0xf
    v_and_b32_dpp v49, v27, v5 row_newbcast:6 row_mask:0xf bank_mask:0xf
    v_and_b32_dpp v50, v27, v6 row_newbcast:6 row_mask:0xf bank_mask:0xf
    v_and_b32_dpp v51, v27, v7 row_newbcast:6 row_mask:0xf bank_mask:0xf
    v_mfma_f32_16x16x32_bf16 v[44:47], v[52:55], v[180:183], v[44:47]
    buffer_load_dwordx4 v[232:235], v2, s[12:15], s36 offen offset:2048 nt
    s_waitcnt vmcnt(11)
    v_and_b32_dpp v52, v27, v4 row_newbcast:7 row_mask:0xf bank_mask:0xf
    v_and_b32_dpp v53, v27, v5 row_newbcast:7 row_mask:0xf bank_mask:0xf
    v_and_b32_dpp v54, v27, v6 row_newbcast:7 row_mask:0xf bank_mask:0xf
    v_and_b32_dpp v55, v27, v7 row_newbcast:7 row_mask:0xf bank_mask:0xf
    v_mfma_f32_16x16x32_bf16 v[44:47], v[48:51], v[184:187], v[44:47]
    buffer_load_dwordx4 v[236:239], v2, s[12:15], s36 offen offset:3072 nt
    s_waitcnt vmcnt(11)
    v_and_b32_dpp v48, v27, v4 row_newbcast:8 row_mask:0xf bank_mask:0xf
    v_and_b32_dpp v49, v27, v5 row_newbcast:8 row_mask:0xf bank_mask:0xf
    v_and_b32_dpp v50, v27, v6 row_newbcast:8 row_mask:0xf bank_mask:0xf
    v_and_b32_dpp v51, v27, v7 row_newbcast:8 row_mask:0xf bank_mask:0xf
    v_mfma_f32_16x16x32_bf16 v[44:47], v[52:55], v[188:191], v[44:47]
    buffer_load_dwordx4 v[240:243], v3, s[12:15], s36 offen offset:0 nt
    s_waitcnt vmcnt(11)
    v_and_b32_dpp v52, v27, v4 row_newbcast:9 row_mask:0xf bank_mask:0xf
    v_and_b32_dpp v53, v27, v5 row_newbcast:9 row_mask:0xf bank_mask:0xf
    v_and_b32_dpp v54, v27, v6 row_newbcast:9 row_mask:0xf bank_mask:0xf
    v_and_b32_dpp v55, v27, v7 row_newbcast:9 row_mask:0xf bank_mask:0xf
    v_mfma_f32_16x16x32_bf16 v[44:47], v[48:51], v[192:195], v[44:47]
    buffer_load_dwordx4 v[244:247], v3, s[12:15], s36 offen offset:1024 nt
    s_waitcnt vmcnt(11)
    v_and_b32_dpp v48, v27, v4 row_newbcast:10 row_mask:0xf bank_mask:0xf
    v_and_b32_dpp v49, v27, v5 row_newbcast:10 row_mask:0xf bank_mask:0xf
    v_and_b32_dpp v50, v27, v6 row_newbcast:10 row_mask:0xf bank_mask:0xf
    v_and_b32_dpp v51, v27, v7 row_newbcast:10 row_mask:0xf bank_mask:0xf
    v_mfma_f32_16x16x32_bf16 v[44:47], v[52:55], v[196:199], v[44:47]
    buffer_load_dwordx4 v[248:251], v3, s[12:15], s36 offen offset:2048 nt
    s_waitcnt vmcnt(11)
    v_and_b32_dpp v52, v27, v4 row_newbcast:11 row_mask:0xf bank_mask:0xf
    v_and_b32_dpp v53, v27, v5 row_newbcast:11 row_mask:0xf bank_mask:0xf
    v_and_b32_dpp v54, v27, v6 row_newbcast:11 row_mask:0xf bank_mask:0xf
    v_and_b32_dpp v55, v27, v7 row_newbcast:11 row_mask:0xf bank_mask:0xf
    v_mfma_f32_16x16x32_bf16 v[44:47], v[48:51], v[200:203], v[44:47]
    buffer_load_dwordx4 v[252:255], v3, s[12:15], s36 offen offset:3072 nt
    s_waitcnt vmcnt(11)
    v_and_b32_dpp v48, v27, v4 row_newbcast:12 row_mask:0xf bank_mask:0xf
    v_and_b32_dpp v49, v27, v5 row_newbcast:12 row_mask:0xf bank_mask:0xf
    v_and_b32_dpp v50, v27, v6 row_newbcast:12 row_mask:0xf bank_mask:0xf
    v_and_b32_dpp v51, v27, v7 row_newbcast:12 row_mask:0xf bank_mask:0xf
    v_mfma_f32_16x16x32_bf16 v[44:47], v[52:55], v[204:207], v[44:47]
    buffer_load_dwordx4 a[0:3], v2, s[12:15], s37 offen offset:0 nt
    s_waitcnt vmcnt(11)
    v_and_b32_dpp v52, v27, v4 row_newbcast:13 row_mask:0xf bank_mask:0xf
    v_and_b32_dpp v53, v27, v5 row_newbcast:13 row_mask:0xf bank_mask:0xf
    v_and_b32_dpp v54, v27, v6 row_newbcast:13 row_mask:0xf bank_mask:0xf
    v_and_b32_dpp v55, v27, v7 row_newbcast:13 row_mask:0xf bank_mask:0xf
    v_mfma_f32_16x16x32_bf16 v[44:47], v[48:51], v[208:211], v[44:47]
    buffer_load_dwordx4 a[4:7], v2, s[12:15], s37 offen offset:1024 nt
    s_waitcnt vmcnt(11)
    v_and_b32_dpp v48, v27, v4 row_newbcast:14 row_mask:0xf bank_mask:0xf
    v_and_b32_dpp v49, v27, v5 row_newbcast:14 row_mask:0xf bank_mask:0xf
    v_and_b32_dpp v50, v27, v6 row_newbcast:14 row_mask:0xf bank_mask:0xf
    v_and_b32_dpp v51, v27, v7 row_newbcast:14 row_mask:0xf bank_mask:0xf
    v_mfma_f32_16x16x32_bf16 v[44:47], v[52:55], v[212:215], v[44:47]
    buffer_load_dwordx4 a[8:11], v2, s[12:15], s37 offen offset:2048 nt
    s_waitcnt vmcnt(11)
    v_and_b32_dpp v52, v27, v4 row_newbcast:15 row_mask:0xf bank_mask:0xf
    v_and_b32_dpp v53, v27, v5 row_newbcast:15 row_mask:0xf bank_mask:0xf
    v_and_b32_dpp v54, v27, v6 row_newbcast:15 row_mask:0xf bank_mask:0xf
    v_and_b32_dpp v55, v27, v7 row_newbcast:15 row_mask:0xf bank_mask:0xf
    v_mfma_f32_16x16x32_bf16 v[44:47], v[48:51], v[216:219], v[44:47]
    buffer_load_dwordx4 a[12:15], v2, s[12:15], s37 offen offset:3072 nt
    s_waitcnt vmcnt(11)
    v_and_b32_dpp v48, v28, v4 row_newbcast:0 row_mask:0xf bank_mask:0xf
    v_and_b32_dpp v49, v28, v5 row_newbcast:0 row_mask:0xf bank_mask:0xf
    v_and_b32_dpp v50, v28, v6 row_newbcast:0 row_mask:0xf bank_mask:0xf
    v_and_b32_dpp v51, v28, v7 row_newbcast:0 row_mask:0xf bank_mask:0xf
    v_mfma_f32_16x16x32_bf16 v[44:47], v[52:55], v[220:223], v[44:47]
    buffer_load_dwordx4 a[16:19], v3, s[12:15], s37 offen offset:0 nt
    s_waitcnt vmcnt(11)
    v_and_b32_dpp v52, v28, v4 row_newbcast:1 row_mask:0xf bank_mask:0xf
    v_and_b32_dpp v53, v28, v5 row_newbcast:1 row_mask:0xf bank_mask:0xf
    v_and_b32_dpp v54, v28, v6 row_newbcast:1 row_mask:0xf bank_mask:0xf
    v_and_b32_dpp v55, v28, v7 row_newbcast:1 row_mask:0xf bank_mask:0xf
    v_mfma_f32_16x16x32_bf16 v[44:47], v[48:51], v[224:227], v[44:47]
    buffer_load_dwordx4 a[20:23], v3, s[12:15], s37 offen offset:1024 nt
    s_waitcnt vmcnt(11)
    v_and_b32_dpp v48, v28, v4 row_newbcast:2 row_mask:0xf bank_mask:0xf
    v_and_b32_dpp v49, v28, v5 row_newbcast:2 row_mask:0xf bank_mask:0xf
    v_and_b32_dpp v50, v28, v6 row_newbcast:2 row_mask:0xf bank_mask:0xf
    v_and_b32_dpp v51, v28, v7 row_newbcast:2 row_mask:0xf bank_mask:0xf
    v_mfma_f32_16x16x32_bf16 v[44:47], v[52:55], v[228:231], v[44:47]
    buffer_load_dwordx4 a[24:27], v3, s[12:15], s37 offen offset:2048 nt
    s_waitcnt vmcnt(11)
    v_and_b32_dpp v52, v28, v4 row_newbcast:3 row_mask:0xf bank_mask:0xf
    v_and_b32_dpp v53, v28, v5 row_newbcast:3 row_mask:0xf bank_mask:0xf
    v_and_b32_dpp v54, v28, v6 row_newbcast:3 row_mask:0xf bank_mask:0xf
    v_and_b32_dpp v55, v28, v7 row_newbcast:3 row_mask:0xf bank_mask:0xf
    v_mfma_f32_16x16x32_bf16 v[44:47], v[48:51], v[232:235], v[44:47]
    buffer_load_dwordx4 a[28:31], v3, s[12:15], s37 offen offset:3072 nt
    s_waitcnt vmcnt(11)
    v_and_b32_dpp v48, v28, v4 row_newbcast:4 row_mask:0xf bank_mask:0xf
    v_and_b32_dpp v49, v28, v5 row_newbcast:4 row_mask:0xf bank_mask:0xf
    v_and_b32_dpp v50, v28, v6 row_newbcast:4 row_mask:0xf bank_mask:0xf
    v_and_b32_dpp v51, v28, v7 row_newbcast:4 row_mask:0xf bank_mask:0xf
    v_mfma_f32_16x16x32_bf16 v[44:47], v[52:55], v[236:239], v[44:47]
    v_mov_b32 v40, 0
    global_load_dword v40, v40, s[58:59] offset:128 sc1
    s_waitcnt vmcnt(11)
    v_and_b32_dpp v52, v28, v4 row_newbcast:5 row_mask:0xf bank_mask:0xf
    v_and_b32_dpp v53, v28, v5 row_newbcast:5 row_mask:0xf bank_mask:0xf
    v_and_b32_dpp v54, v28, v6 row_newbcast:5 row_mask:0xf bank_mask:0xf
    v_and_b32_dpp v55, v28, v7 row_newbcast:5 row_mask:0xf bank_mask:0xf
    v_mfma_f32_16x16x32_bf16 v[44:47], v[48:51], v[240:243], v[44:47]
    buffer_load_dwordx4 v[96:99], v1, s[16:19], s28 offen offset:0 nt
    s_waitcnt vmcnt(11)
    v_and_b32_dpp v48, v28, v4 row_newbcast:6 row_mask:0xf bank_mask:0xf
    v_and_b32_dpp v49, v28, v5 row_newbcast:6 row_mask:0xf bank_mask:0xf
    v_and_b32_dpp v50, v28, v6 row_newbcast:6 row_mask:0xf bank_mask:0xf
    v_and_b32_dpp v51, v28, v7 row_newbcast:6 row_mask:0xf bank_mask:0xf
    v_mfma_f32_16x16x32_bf16 v[44:47], v[52:55], v[244:247], v[44:47]
    buffer_load_dwordx4 v[100:103], v1, s[16:19], s28 offen offset:128 nt
    s_waitcnt vmcnt(11)
    v_and_b32_dpp v52, v28, v4 row_newbcast:7 row_mask:0xf bank_mask:0xf
    v_and_b32_dpp v53, v28, v5 row_newbcast:7 row_mask:0xf bank_mask:0xf
    v_and_b32_dpp v54, v28, v6 row_newbcast:7 row_mask:0xf bank_mask:0xf
    v_and_b32_dpp v55, v28, v7 row_newbcast:7 row_mask:0xf bank_mask:0xf
    v_mfma_f32_16x16x32_bf16 v[44:47], v[48:51], v[248:251], v[44:47]
    buffer_load_dwordx4 v[104:107], v1, s[16:19], s28 offen offset:256 nt
    s_waitcnt vmcnt(11)
    v_and_b32_dpp v48, v28, v4 row_newbcast:8 row_mask:0xf bank_mask:0xf
    v_and_b32_dpp v49, v28, v5 row_newbcast:8 row_mask:0xf bank_mask:0xf
    v_and_b32_dpp v50, v28, v6 row_newbcast:8 row_mask:0xf bank_mask:0xf
    v_and_b32_dpp v51, v28, v7 row_newbcast:8 row_mask:0xf bank_mask:0xf
    v_mfma_f32_16x16x32_bf16 v[44:47], v[52:55], v[252:255], v[44:47]
    buffer_load_dwordx4 v[108:111], v1, s[16:19], s28 offen offset:384 nt
    s_waitcnt vmcnt(11)
    v_and_b32_dpp v52, v28, v4 row_newbcast:9 row_mask:0xf bank_mask:0xf
    v_and_b32_dpp v53, v28, v5 row_newbcast:9 row_mask:0xf bank_mask:0xf
    v_and_b32_dpp v54, v28, v6 row_newbcast:9 row_mask:0xf bank_mask:0xf
    v_and_b32_dpp v55, v28, v7 row_newbcast:9 row_mask:0xf bank_mask:0xf
    v_mfma_f32_16x16x32_bf16 v[44:47], v[48:51], a[0:3], v[44:47]
    s_waitcnt vmcnt(10)
    v_and_b32_dpp v48, v28, v4 row_newbcast:10 row_mask:0xf bank_mask:0xf
    v_and_b32_dpp v49, v28, v5 row_newbcast:10 row_mask:0xf bank_mask:0xf
    v_and_b32_dpp v50, v28, v6 row_newbcast:10 row_mask:0xf bank_mask:0xf
    v_and_b32_dpp v51, v28, v7 row_newbcast:10 row_mask:0xf bank_mask:0xf
    v_mfma_f32_16x16x32_bf16 v[44:47], v[52:55], a[4:7], v[44:47]
    s_add_u32 s74, s71, 8192
    buffer_load_dwordx4 v[16:19], v39, s[24:27], s74 offen sc1
    buffer_load_dwordx4 v[20:23], v39, s[24:27], s74 offen offset:128 sc1
    s_waitcnt vmcnt(11)
    v_and_b32_dpp v52, v28, v4 row_newbcast:11 row_mask:0xf bank_mask:0xf
    v_and_b32_dpp v53, v28, v5 row_newbcast:11 row_mask:0xf bank_mask:0xf
    v_and_b32_dpp v54, v28, v6 row_newbcast:11 row_mask:0xf bank_mask:0xf
    v_and_b32_dpp v55, v28, v7 row_newbcast:11 row_mask:0xf bank_mask:0xf
    v_mfma_f32_16x16x32_bf16 v[44:47], v[48:51], a[8:11], v[44:47]
    buffer_load_dwordx4 v[112:115], v1, s[16:19], s28 offen offset:512 nt
    s_waitcnt vmcnt(11)
    v_and_b32_dpp v48, v28, v4 row_newbcast:12 row_mask:0xf bank_mask:0xf
    v_and_b32_dpp v49, v28, v5 row_newbcast:12 row_mask:0xf bank_mask:0xf
    v_and_b32_dpp v50, v28, v6 row_newbcast:12 row_mask:0xf bank_mask:0xf
    v_and_b32_dpp v51, v28, v7 row_newbcast:12 row_mask:0xf bank_mask:0xf
    v_mfma_f32_16x16x32_bf16 v[44:47], v[52:55], a[12:15], v[44:47]
    buffer_load_dwordx4 v[116:119], v1, s[16:19], s28 offen offset:640 nt
    s_waitcnt vmcnt(11)
    v_and_b32_dpp v52, v28, v4 row_newbcast:13 row_mask:0xf bank_mask:0xf
    v_and_b32_dpp v53, v28, v5 row_newbcast:13 row_mask:0xf bank_mask:0xf
    v_and_b32_dpp v54, v28, v6 row_newbcast:13 row_mask:0xf bank_mask:0xf
    v_and_b32_dpp v55, v28, v7 row_newbcast:13 row_mask:0xf bank_mask:0xf
    v_mfma_f32_16x16x32_bf16 v[44:47], v[48:51], a[16:19], v[44:47]
    buffer_load_dwordx4 v[120:123], v1, s[16:19], s28 offen offset:768 nt
    s_waitcnt vmcnt(11)
    v_and_b32_dpp v48, v28, v4 row_newbcast:14 row_mask:0xf bank_mask:0xf
    v_and_b32_dpp v49, v28, v5 row_newbcast:14 row_mask:0xf bank_mask:0xf
    v_and_b32_dpp v50, v28, v6 row_newbcast:14 row_mask:0xf bank_mask:0xf
    v_and_b32_dpp v51, v28, v7 row_newbcast:14 row_mask:0xf bank_mask:0xf
    v_mfma_f32_16x16x32_bf16 v[44:47], v[52:55], a[20:23], v[44:47]
    buffer_load_dwordx4 v[124:127], v1, s[16:19], s28 offen offset:896 nt
    s_waitcnt vmcnt(11)
    v_and_b32_dpp v52, v28, v4 row_newbcast:15 row_mask:0xf bank_mask:0xf
    v_and_b32_dpp v53, v28, v5 row_newbcast:15 row_mask:0xf bank_mask:0xf
    v_and_b32_dpp v54, v28, v6 row_newbcast:15 row_mask:0xf bank_mask:0xf
    v_and_b32_dpp v55, v28, v7 row_newbcast:15 row_mask:0xf bank_mask:0xf
    v_mfma_f32_16x16x32_bf16 v[44:47], v[48:51], a[24:27], v[44:47]
    buffer_load_dwordx4 a[0:3], v1, s[16:19], s29 offen offset:0 nt
    v_mfma_f32_16x16x32_bf16 v[44:47], v[52:55], a[28:31], v[44:47]
    s_waitcnt vmcnt(11)
    v_cmp_gt_u32 vcc, 32, v40
    s_nop 4
    s_cbranch_vccz L_s_cb
    s_mov_b32 s73, 0
L_cw_7:
    v_mov_b32 v38, 0
    global_load_dword v38, v38, s[58:59] offset:128 sc1
    s_waitcnt vmcnt(0)
    v_cmp_gt_u32 vcc, 32, v38
    s_add_u32 s73, s73, 1
    s_cmp_gt_u32 s73, 60000
    s_nop 1
    s_cbranch_scc1 L_cwd_8
    s_cbranch_vccnz L_cw_7
L_cwd_8:
L_s_cb:
    v_add_f32_dpp v35, v35, v35 quad_perm:[1,0,3,2] row_mask:0xf bank_mask:0xf
    s_nop 1
    v_add_f32_dpp v35, v35, v35 quad_perm:[2,3,0,1] row_mask:0xf bank_mask:0xf
    s_nop 1
    v_add_f32_dpp v35, v35, v35 row_ror:4 row_mask:0xf bank_mask:0xf
    s_nop 1
    v_add_f32_dpp v35, v35, v35 row_ror:8 row_mask:0xf bank_mask:0xf
    v_mov_b32 v48, v35
    s_nop 1
    v_permlane16_swap_b32 v35, v48
    v_add_f32 v35, v35, v48
    v_mov_b32 v48, v35
    s_nop 1
    v_permlane32_swap_b32 v35, v48
    v_add_f32 v35, v35, v48
    v_log_f32 v50, v35
    v_rcp_f32 v35, v35
    v_and_b32 v48, 0xf0, v2
    v_lshlrev_b32 v48, 1, v48
    v_lshrrev_b32 v49, 8, v2
    v_lshlrev_b32 v49, 4, v49
    v_add_u32 v48, v48, v49
    s_add_u32 s74, s69, 0
    s_mov_b32 s82, 0x7060500
    s_mov_b32 s83, 0x7060501
    s_mov_b32 s84, 0x7060502
    s_mov_b32 s85, 0x7060503
    v_mul_f32 v50, 0x3f317218, v50
    v_add_f32 v50, v50, v34
    v_mul_f32 v44, v44, v35
    v_mul_f32 v45, v45, v35
    v_mul_f32 v46, v46, v35
    v_mul_f32 v47, v47, v35
    v_perm_b32 v44, v44, v50, s82
    v_perm_b32 v45, v45, v50, s83
    v_perm_b32 v46, v46, v50, s84
    v_perm_b32 v47, v47, v50, s85
    s_mov_b32 exec_lo, 0xffffffff
    s_mov_b32 exec_hi, 0x0
    buffer_store_dwordx4 v[44:47], v48, s[24:27], s74 offen sc1
    s_mov_b64 exec, -1
    s_waitcnt vmcnt(5)
    v_max3_u32 v38, v16, v17, v18
    v_max3_u32 v38, v38, v19, v20
    v_max3_u32 v38, v38, v21, v22
    v_max_u32 v38, v38, v23
    v_cmp_eq_u32 vcc, -1, v38
    s_nop 3
    s_cbranch_vccz L_qok_9
    v_mov_b32 v16, -1
    v_mov_b32 v17, -1
    v_mov_b32 v18, -1
    v_mov_b32 v19, -1
    v_mov_b32 v20, -1
    v_mov_b32 v21, -1
    v_mov_b32 v22, -1
    v_mov_b32 v23, -1
    s_mov_b32 s73, 0
    s_nop 0
L_pl_10:
    s_add_u32 s74, s71, 8192
    buffer_load_dwordx4 v[16:19], v39, s[24:27], s74 offen sc1
    buffer_load_dwordx4 v[20:23], v39, s[24:27], s74 offen offset:128 sc1
    s_waitcnt vmcnt(0)
    v_max3_u32 v38, v16, v17, v18
    v_max3_u32 v38, v38, v19, v20
    v_max3_u32 v38, v38, v21, v22
    v_max_u32 v38, v38, v23
    v_cmp_eq_u32 vcc, -1, v38
    s_add_u32 s73, s73, 1
    s_cmp_gt_u32 s73, 60000
    s_nop 1
    s_cbranch_scc1 L_pd_11
    s_cbranch_vccnz L_pl_10
L_pd_11:
L_qok_9:
    v_mfma_f32_16x16x32_bf16 v[48:51], v[16:19], v[96:99], 0
    v_mfma_f32_16x16x32_bf16 v[52:55], v[16:19], v[104:107], 0
    v_mfma_f32_16x16x32_bf16 v[48:51], v[20:23], v[100:103], v[48:51]
    v_mfma_f32_16x16x32_bf16 v[52:55], v[20:23], v[108:111], v[52:55]
    buffer_load_dwordx4 a[4:7], v1, s[16:19], s29 offen offset:128 nt
    buffer_load_dwordx4 a[8:11], v1, s[16:19], s29 offen offset:256 nt
    buffer_load_dwordx4 a[12:15], v1, s[16:19], s29 offen offset:384 nt
    buffer_load_dwordx4 a[16:19], v1, s[16:19], s29 offen offset:512 nt
    buffer_load_dwordx4 a[20:23], v1, s[16:19], s29 offen offset:640 nt
    buffer_load_dwordx4 a[24:27], v1, s[16:19], s29 offen offset:768 nt
    buffer_load_dwordx4 a[28:31], v1, s[16:19], s29 offen offset:896 nt
    v_add_f32_dpp v29, v49, v48 row_ror:8 row_mask:0x1 bank_mask:0x3
    s_nop 1
    v_add_f32_dpp v29, v53, v52 row_ror:8 row_mask:0x2 bank_mask:0x3
    s_waitcnt vmcnt(8)
    v_mfma_f32_16x16x32_bf16 v[48:51], v[16:19], v[112:115], 0
    v_mfma_f32_16x16x32_bf16 v[52:55], v[16:19], v[120:123], 0
    v_mfma_f32_16x16x32_bf16 v[48:51], v[20:23], v[116:119], v[48:51]
    v_mfma_f32_16x16x32_bf16 v[52:55], v[20:23], v[124:127], v[52:55]
    buffer_load_dwordx4 v[96:99], v1, s[16:19], s30 offen offset:0 nt
    buffer_load_dwordx4 v[100:103], v1, s[16:19], s30 offen offset:128 nt
    buffer_load_dwordx4 v[104:107], v1, s[16:19], s30 offen offset:256 nt
    buffer_load_dwordx4 v[108:111], v1, s[16:19], s30 offen offset:384 nt
    s_nop 2
    v_add_f32_dpp v29, v49, v48 row_ror:8 row_mask:0x4 bank_mask:0x3
    s_nop 1
    v_add_f32_dpp v29, v53, v52 row_ror:8 row_mask:0x8 bank_mask:0x3
    s_waitcnt vmcnt(8)
    v_mfma_f32_16x16x32_bf16 v[48:51], v[16:19], a[0:3], 0
    v_mfma_f32_16x16x32_bf16 v[52:55], v[16:19], a[8:11], 0
    v_mfma_f32_16x16x32_bf16 v[48:51], v[20:23], a[4:7], v[48:51]
    v_mfma_f32_16x16x32_bf16 v[52:55], v[20:23], a[12:15], v[52:55]
    buffer_load_dwordx4 v[112:115], v1, s[16:19], s30 offen offset:512 nt
    buffer_load_dwordx4 v[116:119], v1, s[16:19], s30 offen offset:640 nt
    buffer_load_dwordx4 v[120:123], v1, s[16:19], s30 offen offset:768 nt
    buffer_load_dwordx4 v[124:127], v1, s[16:19], s30 offen offset:896 nt
    s_nop 2
    v_add_f32_dpp v29, v48, v49 row_ror:8 row_mask:0x1 bank_mask:0xc
    s_nop 1
    v_add_f32_dpp v29, v52, v53 row_ror:8 row_mask:0x2 bank_mask:0xc
    s_waitcnt vmcnt(8)
    v_mfma_f32_16x16x32_bf16 v[48:51], v[16:19], a[16:19], 0
    v_mfma_f32_16x16x32_bf16 v[52:55], v[16:19], a[24:27], 0
    v_mfma_f32_16x16x32_bf16 v[48:51], v[20:23], a[20:23], v[48:51]
    v_mfma_f32_16x16x32_bf16 v[52:55], v[20:23], a[28:31], v[52:55]
    buffer_load_dwordx4 a[0:3], v1, s[16:19], s31 offen offset:0 nt
    buffer_load_dwordx4 a[4:7], v1, s[16:19], s31 offen offset:128 nt
    buffer_load_dwordx4 a[8:11], v1, s[16:19], s31 offen offset:256 nt
    buffer_load_dwordx4 a[12:15], v1, s[16:19], s31 offen offset:384 nt
    s_nop 2
    v_add_f32_dpp v29, v48, v49 row_ror:8 row_mask:0x4 bank_mask:0xc
    s_nop 1
    v_add_f32_dpp v29, v52, v53 row_ror:8 row_mask:0x8 bank_mask:0xc
    s_waitcnt vmcnt(8)
    v_mfma_f32_16x16x32_bf16 v[48:51], v[16:19], v[96:99], 0
    v_mfma_f32_16x16x32_bf16 v[52:55], v[16:19], v[104:107], 0
    v_mfma_f32_16x16x32_bf16 v[48:51], v[20:23], v[100:103], v[48:51]
    v_mfma_f32_16x16x32_bf16 v[52:55], v[20:23], v[108:111], v[52:55]
    buffer_load_dwordx4 a[16:19], v1, s[16:19], s31 offen offset:512 nt
    buffer_load_dwordx4 a[20:23], v1, s[16:19], s31 offen offset:640 nt
    buffer_load_dwordx4 a[24:27], v1, s[16:19], s31 offen offset:768 nt
    buffer_load_dwordx4 a[28:31], v1, s[16:19], s31 offen offset:896 nt
    s_nop 2
    v_add_f32_dpp v30, v49, v48 row_ror:8 row_mask:0x1 bank_mask:0x3
    s_nop 1
    v_add_f32_dpp v30, v53, v52 row_ror:8 row_mask:0x2 bank_mask:0x3
    s_waitcnt vmcnt(8)
    v_mfma_f32_16x16x32_bf16 v[48:51], v[16:19], v[112:115], 0
    v_mfma_f32_16x16x32_bf16 v[52:55], v[16:19], v[120:123], 0
    v_mfma_f32_16x16x32_bf16 v[48:51], v[20:23], v[116:119], v[48:51]
    v_mfma_f32_16x16x32_bf16 v[52:55], v[20:23], v[124:127], v[52:55]
    buffer_load_dwordx4 v[96:99], v1, s[16:19], s32 offen offset:0 nt
    buffer_load_dwordx4 v[100:103], v1, s[16:19], s32 offen offset:128 nt
    buffer_load_dwordx4 v[104:107], v1, s[16:19], s32 offen offset:256 nt
    buffer_load_dwordx4 v[108:111], v1, s[16:19], s32 offen offset:384 nt
    s_nop 2
    v_add_f32_dpp v30, v49, v48 row_ror:8 row_mask:0x4 bank_mask:0x3
    s_nop 1
    v_add_f32_dpp v30, v53, v52 row_ror:8 row_mask:0x8 bank_mask:0x3
    s_waitcnt vmcnt(8)
    v_mfma_f32_16x16x32_bf16 v[48:51], v[16:19], a[0:3], 0
    v_mfma_f32_16x16x32_bf16 v[52:55], v[16:19], a[8:11], 0
    v_mfma_f32_16x16x32_bf16 v[48:51], v[20:23], a[4:7], v[48:51]
    v_mfma_f32_16x16x32_bf16 v[52:55], v[20:23], a[12:15], v[52:55]
    buffer_load_dwordx4 v[112:115], v1, s[16:19], s32 offen offset:512 nt
    buffer_load_dwordx4 v[116:119], v1, s[16:19], s32 offen offset:640 nt
    buffer_load_dwordx4 v[120:123], v1, s[16:19], s32 offen offset:768 nt
    buffer_load_dwordx4 v[124:127], v1, s[16:19], s32 offen offset:896 nt
    s_nop 2
    v_add_f32_dpp v30, v48, v49 row_ror:8 row_mask:0x1 bank_mask:0xc
    s_nop 1
    v_add_f32_dpp v30, v52, v53 row_ror:8 row_mask:0x2 bank_mask:0xc
    s_waitcnt vmcnt(8)
    v_mfma_f32_16x16x32_bf16 v[48:51], v[16:19], a[16:19], 0
    v_mfma_f32_16x16x32_bf16 v[52:55], v[16:19], a[24:27], 0
    v_mfma_f32_16x16x32_bf16 v[48:51], v[20:23], a[20:23], v[48:51]
    v_mfma_f32_16x16x32_bf16 v[52:55], v[20:23], a[28:31], v[52:55]
    buffer_load_dwordx4 a[0:3], v1, s[16:19], s33 offen offset:0 nt
    buffer_load_dwordx4 a[4:7], v1, s[16:19], s33 offen offset:128 nt
    buffer_load_dwordx4 a[8:11], v1, s[16:19], s33 offen offset:256 nt
    buffer_load_dwordx4 a[12:15], v1, s[16:19], s33 offen offset:384 nt
    s_nop 2
    v_add_f32_dpp v30, v48, v49 row_ror:8 row_mask:0x4 bank_mask:0xc
    s_nop 1
    v_add_f32_dpp v30, v52, v53 row_ror:8 row_mask:0x8 bank_mask:0xc
    s_waitcnt vmcnt(8)
    v_mfma_f32_16x16x32_bf16 v[48:51], v[16:19], v[96:99], 0
    v_mfma_f32_16x16x32_bf16 v[52:55], v[16:19], v[104:107], 0
    v_mfma_f32_16x16x32_bf16 v[48:51], v[20:23], v[100:103], v[48:51]
    v_mfma_f32_16x16x32_bf16 v[52:55], v[20:23], v[108:111], v[52:55]
    buffer_load_dwordx4 a[16:19], v1, s[16:19], s33 offen offset:512 nt
    buffer_load_dwordx4 a[20:23], v1, s[16:19], s33 offen offset:640 nt
    buffer_load_dwordx4 a[24:27], v1, s[16:19], s33 offen offset:768 nt
    buffer_load_dwordx4 a[28:31], v1, s[16:19], s33 offen offset:896 nt
    s_nop 2
    v_add_f32_dpp v31, v49, v48 row_ror:8 row_mask:0x1 bank_mask:0x3
    s_nop 1
    v_add_f32_dpp v31, v53, v52 row_ror:8 row_mask:0x2 bank_mask:0x3
    s_waitcnt vmcnt(8)
    v_mfma_f32_16x16x32_bf16 v[48:51], v[16:19], v[112:115], 0
    v_mfma_f32_16x16x32_bf16 v[52:55], v[16:19], v[120:123], 0
    v_mfma_f32_16x16x32_bf16 v[48:51], v[20:23], v[116:119], v[48:51]
    v_mfma_f32_16x16x32_bf16 v[52:55], v[20:23], v[124:127], v[52:55]
    buffer_load_dwordx4 v[96:99], v1, s[16:19], s34 offen offset:0 nt
    buffer_load_dwordx4 v[100:103], v1, s[16:19], s34 offen offset:128 nt
    buffer_load_dwordx4 v[104:107], v1, s[16:19], s34 offen offset:256 nt
    buffer_load_dwordx4 v[108:111], v1, s[16:19], s34 offen offset:384 nt
    s_nop 2
    v_add_f32_dpp v31, v49, v48 row_ror:8 row_mask:0x4 bank_mask:0x3
    s_nop 1
    v_add_f32_dpp v31, v53, v52 row_ror:8 row_mask:0x8 bank_mask:0x3
    s_waitcnt vmcnt(8)
    v_mfma_f32_16x16x32_bf16 v[48:51], v[16:19], a[0:3], 0
    v_mfma_f32_16x16x32_bf16 v[52:55], v[16:19], a[8:11], 0
    v_mfma_f32_16x16x32_bf16 v[48:51], v[20:23], a[4:7], v[48:51]
    v_mfma_f32_16x16x32_bf16 v[52:55], v[20:23], a[12:15], v[52:55]
    buffer_load_dwordx4 v[112:115], v1, s[16:19], s34 offen offset:512 nt
    buffer_load_dwordx4 v[116:119], v1, s[16:19], s34 offen offset:640 nt
    buffer_load_dwordx4 v[120:123], v1, s[16:19], s34 offen offset:768 nt
    buffer_load_dwordx4 v[124:127], v1, s[16:19], s34 offen offset:896 nt
    s_nop 2
    v_add_f32_dpp v31, v48, v49 row_ror:8 row_mask:0x1 bank_mask:0xc
    s_nop 1
    v_add_f32_dpp v31, v52, v53 row_ror:8 row_mask:0x2 bank_mask:0xc
    s_waitcnt vmcnt(8)
    v_mfma_f32_16x16x32_bf16 v[48:51], v[16:19], a[16:19], 0
    v_mfma_f32_16x16x32_bf16 v[52:55], v[16:19], a[24:27], 0
    v_mfma_f32_16x16x32_bf16 v[48:51], v[20:23], a[20:23], v[48:51]
    v_mfma_f32_16x16x32_bf16 v[52:55], v[20:23], a[28:31], v[52:55]
    buffer_load_dwordx4 a[0:3], v1, s[16:19], s35 offen offset:0 nt
    buffer_load_dwordx4 a[4:7], v1, s[16:19], s35 offen offset:128 nt
    buffer_load_dwordx4 a[8:11], v1, s[16:19], s35 offen offset:256 nt
    buffer_load_dwordx4 a[12:15], v1, s[16:19], s35 offen offset:384 nt
    s_nop 2
    v_add_f32_dpp v31, v48, v49 row_ror:8 row_mask:0x4 bank_mask:0xc
    s_nop 1
    v_add_f32_dpp v31, v52, v53 row_ror:8 row_mask:0x8 bank_mask:0xc
    s_waitcnt vmcnt(8)
    v_mfma_f32_16x16x32_bf16 v[48:51], v[16:19], v[96:99], 0
    v_mfma_f32_16x16x32_bf16 v[52:55], v[16:19], v[104:107], 0
    v_mfma_f32_16x16x32_bf16 v[48:51], v[20:23], v[100:103], v[48:51]
    v_mfma_f32_16x16x32_bf16 v[52:55], v[20:23], v[108:111], v[52:55]
    buffer_load_dwordx4 a[16:19], v1, s[16:19], s35 offen offset:512 nt
    buffer_load_dwordx4 a[20:23], v1, s[16:19], s35 offen offset:640 nt
    buffer_load_dwordx4 a[24:27], v1, s[16:19], s35 offen offset:768 nt
    buffer_load_dwordx4 a[28:31], v1, s[16:19], s35 offen offset:896 nt
    s_nop 2
    v_add_f32_dpp v32, v49, v48 row_ror:8 row_mask:0x1 bank_mask:0x3
    s_nop 1
    v_add_f32_dpp v32, v53, v52 row_ror:8 row_mask:0x2 bank_mask:0x3
    s_waitcnt vmcnt(8)
    v_mfma_f32_16x16x32_bf16 v[48:51], v[16:19], v[112:115], 0
    v_mfma_f32_16x16x32_bf16 v[52:55], v[16:19], v[120:123], 0
    v_mfma_f32_16x16x32_bf16 v[48:51], v[20:23], v[116:119], v[48:51]
    v_mfma_f32_16x16x32_bf16 v[52:55], v[20:23], v[124:127], v[52:55]
    buffer_load_dwordx4 v[96:99], v1, s[16:19], s36 offen offset:0 nt
    buffer_load_dwordx4 v[100:103], v1, s[16:19], s36 offen offset:128 nt
    buffer_load_dwordx4 v[104:107], v1, s[16:19], s36 offen offset:256 nt
    buffer_load_dwordx4 v[108:111], v1, s[16:19], s36 offen offset:384 nt
    s_nop 2
    v_add_f32_dpp v32, v49, v48 row_ror:8 row_mask:0x4 bank_mask:0x3
    s_nop 1
    v_add_f32_dpp v32, v53, v52 row_ror:8 row_mask:0x8 bank_mask:0x3
    s_waitcnt vmcnt(8)
    v_mfma_f32_16x16x32_bf16 v[48:51], v[16:19], a[0:3], 0
    v_mfma_f32_16x16x32_bf16 v[52:55], v[16:19], a[8:11], 0
    v_mfma_f32_16x16x32_bf16 v[48:51], v[20:23], a[4:7], v[48:51]
    v_mfma_f32_16x16x32_bf16 v[52:55], v[20:23], a[12:15], v[52:55]
    s_add_u32 s74, s71, 16384
    buffer_load_dwordx4 v[8:11], v39, s[24:27], s74 offen sc1
    buffer_load_dwordx4 v[12:15], v39, s[24:27], s74 offen offset:128 sc1
    buffer_load_dwordx4 v[112:115], v1, s[16:19], s36 offen offset:512 nt
    buffer_load_dwordx4 v[116:119], v1, s[16:19], s36 offen offset:640 nt
    s_nop 1
    v_add_f32_dpp v32, v48, v49 row_ror:8 row_mask:0x1 bank_mask:0xc
    s_nop 1
    v_add_f32_dpp v32, v52, v53 row_ror:8 row_mask:0x2 bank_mask:0xc
    s_waitcnt vmcnt(8)
    v_mfma_f32_16x16x32_bf16 v[48:51], v[16:19], a[16:19], 0
    v_mfma_f32_16x16x32_bf16 v[52:55], v[16:19], a[24:27], 0
    v_mfma_f32_16x16x32_bf16 v[48:51], v[20:23], a[20:23], v[48:51]
    v_mfma_f32_16x16x32_bf16 v[52:55], v[20:23], a[28:31], v[52:55]
    buffer_load_dwordx4 v[120:123], v1, s[16:19], s36 offen offset:768 nt
    buffer_load_dwordx4 v[124:127], v1, s[16:19], s36 offen offset:896 nt
    buffer_load_dwordx4 a[0:3], v1, s[16:19], s38 offen offset:0 nt
    buffer_load_dwordx4 a[4:7], v1, s[16:19], s38 offen offset:128 nt
    s_nop 2
    v_add_f32_dpp v32, v48, v49 row_ror:8 row_mask:0x4 bank_mask:0xc
    s_nop 1
    v_add_f32_dpp v32, v52, v53 row_ror:8 row_mask:0x8 bank_mask:0xc
    s_waitcnt vmcnt(8)
    v_mfma_f32_16x16x32_bf16 v[48:51], v[16:19], v[96:99], 0
    v_mfma_f32_16x16x32_bf16 v[52:55], v[16:19], v[104:107], 0
    v_mfma_f32_16x16x32_bf16 v[48:51], v[20:23], v[100:103], v[48:51]
    v_mfma_f32_16x16x32_bf16 v[52:55], v[20:23], v[108:111], v[52:55]
    buffer_load_dwordx4 a[8:11], v1, s[16:19], s38 offen offset:256 nt
    buffer_load_dwordx4 a[12:15], v1, s[16:19], s38 offen offset:384 nt
    buffer_load_dwordx4 a[16:19], v1, s[16:19], s38 offen offset:512 nt
    buffer_load_dwordx4 a[20:23], v1, s[16:19], s38 offen offset:640 nt
    s_nop 2
    v_add_f32_dpp v33, v49, v48 row_ror:8 row_mask:0x1 bank_mask:0x3
    s_nop 1
    v_add_f32_dpp v33, v53, v52 row_ror:8 row_mask:0x2 bank_mask:0x3
    s_waitcnt vmcnt(6)
    v_mfma_f32_16x16x32_bf16 v[48:51], v[16:19], v[112:115], 0
    v_mfma_f32_16x16x32_bf16 v[52:55], v[16:19], v[120:123], 0
    v_mfma_f32_16x16x32_bf16 v[48:51], v[20:23], v[116:119], v[48:51]
    v_mfma_f32_16x16x32_bf16 v[52:55], v[20:23], v[124:127], v[52:55]
    buffer_load_dwordx4 a[24:27], v1, s[16:19], s38 offen offset:768 nt
    buffer_load_dwordx4 a[28:31], v1, s[16:19], s38 offen offset:896 nt
    buffer_load_dwordx4 v[96:99], v2, s[20:23], s28 offen offset:0 nt
    buffer_load_dwordx4 v[100:103], v2, s[20:23], s28 offen offset:1024 nt
    buffer_load_dwordx4 v[104:107], v2, s[20:23], s28 offen offset:2048 nt
    buffer_load_dwordx4 v[108:111], v2, s[20:23], s28 offen offset:3072 nt
    s_nop 0
    v_add_f32_dpp v33, v49, v48 row_ror:8 row_mask:0x4 bank_mask:0x3
    s_nop 1
    v_add_f32_dpp v33, v53, v52 row_ror:8 row_mask:0x8 bank_mask:0x3
    s_waitcnt vmcnt(8)
    v_mfma_f32_16x16x32_bf16 v[48:51], v[16:19], a[0:3], 0
    v_mfma_f32_16x16x32_bf16 v[52:55], v[16:19], a[8:11], 0
    v_mfma_f32_16x16x32_bf16 v[48:51], v[20:23], a[4:7], v[48:51]
    v_mfma_f32_16x16x32_bf16 v[52:55], v[20:23], a[12:15], v[52:55]
    buffer_load_dwordx4 v[112:115], v3, s[20:23], s28 offen offset:0 nt
    buffer_load_dwordx4 v[116:119], v3, s[20:23], s28 offen offset:1024 nt
    buffer_load_dwordx4 v[120:123], v3, s[20:23], s28 offen offset:2048 nt
    buffer_load_dwordx4 v[124:127], v3, s[20:23], s28 offen offset:3072 nt
    s_nop 2
    v_add_f32_dpp v33, v48, v49 row_ror:8 row_mask:0x1 bank_mask:0xc
    s_nop 1
    v_add_f32_dpp v33, v52, v53 row_ror:8 row_mask:0x2 bank_mask:0xc
    s_waitcnt vmcnt(8)
    v_mfma_f32_16x16x32_bf16 v[48:51], v[16:19], a[16:19], 0
    v_mfma_f32_16x16x32_bf16 v[52:55], v[16:19], a[24:27], 0
    v_mfma_f32_16x16x32_bf16 v[48:51], v[20:23], a[20:23], v[48:51]
    v_mfma_f32_16x16x32_bf16 v[52:55], v[20:23], a[28:31], v[52:55]
    buffer_load_dwordx4 a[0:3], v2, s[20:23], s29 offen offset:0 nt
    buffer_load_dwordx4 a[4:7], v2, s[20:23], s29 offen offset:1024 nt
    buffer_load_dwordx4 a[8:11], v2, s[20:23], s29 offen offset:2048 nt
    buffer_load_dwordx4 a[12:15], v2, s[20:23], s29 offen offset:3072 nt
    s_nop 2
    v_add_f32_dpp v33, v48, v49 row_ror:8 row_mask:0x4 bank_mask:0xc
    s_nop 1
    v_add_f32_dpp v33, v52, v53 row_ror:8 row_mask:0x8 bank_mask:0xc
    v_cvt_pk_bf16_f32 v48, v29, v30
    v_lshlrev_b32 v29, 16, v48
    v_and_b32 v30, 0xffff0000, v48
    v_mul_f32 v29, 0x3db504f3, v29
    v_mul_f32 v30, 0x3db504f3, v30
    v_cvt_pk_bf16_f32 v48, v29, v30
    v_lshlrev_b32 v29, 16, v48
    v_and_b32 v30, 0xffff0000, v48
    v_cvt_pk_bf16_f32 v48, v31, v32
    v_lshlrev_b32 v31, 16, v48
    v_and_b32 v32, 0xffff0000, v48
    v_mul_f32 v31, 0x3db504f3, v31
    v_mul_f32 v32, 0x3db504f3, v32
    v_cvt_pk_bf16_f32 v48, v31, v32
    v_lshlrev_b32 v31, 16, v48
    v_and_b32 v32, 0xffff0000, v48
    v_cvt_pk_bf16_f32 v48, v33, v33
    v_lshlrev_b32 v33, 16, v48
    v_mul_f32 v33, 0x3db504f3, v33
    v_cvt_pk_bf16_f32 v48, v33, v33
    v_lshlrev_b32 v33, 16, v48
    v_mov_b32 v48, 0xff800000
    v_cndmask_b32 v33, v33, v48, s[66:67]
    v_max_f32 v36, v29, v30
    v_max3_f32 v36, v36, v31, v32
    v_max_f32 v36, v36, v33
    s_nop 1
    v_max_f32_dpp v36, v36, v36 quad_perm:[1,0,3,2] row_mask:0xf bank_mask:0xf
    s_nop 1
    v_max_f32_dpp v36, v36, v36 quad_perm:[2,3,0,1] row_mask:0xf bank_mask:0xf
    s_nop 1
    v_max_f32_dpp v36, v36, v36 row_ror:4 row_mask:0xf bank_mask:0xf
    s_nop 1
    v_max_f32_dpp v36, v36, v36 row_ror:8 row_mask:0xf bank_mask:0xf
    v_mov_b32 v48, v36
    s_nop 1
    v_permlane16_swap_b32 v36, v48
    v_max_f32 v36, v36, v48
    v_mov_b32 v48, v36
    s_nop 1
    v_permlane32_swap_b32 v36, v48
    v_max_f32 v36, v36, v48
    v_sub_f32 v29, v29, v36
    v_mul_f32 v29, 0x3fb8aa3b, v29
    v_exp_f32 v29, v29
    v_sub_f32 v30, v30, v36
    v_mul_f32 v30, 0x3fb8aa3b, v30
    v_exp_f32 v30, v30
    v_sub_f32 v31, v31, v36
    v_mul_f32 v31, 0x3fb8aa3b, v31
    v_exp_f32 v31, v31
    v_sub_f32 v32, v32, v36
    v_mul_f32 v32, 0x3fb8aa3b, v32
    v_exp_f32 v32, v32
    v_sub_f32 v33, v33, v36
    v_mul_f32 v33, 0x3fb8aa3b, v33
    v_exp_f32 v33, v33
    v_add_f32 v37, v29, v30
    v_add_f32 v48, v31, v32
    v_add_f32 v37, v37, v33
    v_add_f32 v37, v37, v48
    v_cvt_pk_bf16_f32 v29, v29, v29
    v_cvt_pk_bf16_f32 v30, v30, v30
    v_cvt_pk_bf16_f32 v31, v31, v31
    v_cvt_pk_bf16_f32 v32, v32, v32
    v_cvt_pk_bf16_f32 v33, v33, v33
    s_waitcnt vmcnt(11)
    buffer_load_dwordx4 a[16:19], v3, s[20:23], s29 offen offset:0 nt
    v_and_b32_dpp v48, v29, v4 row_newbcast:0 row_mask:0xf bank_mask:0xf
    v_and_b32_dpp v49, v29, v5 row_newbcast:0 row_mask:0xf bank_mask:0xf
    v_and_b32_dpp v50, v29, v6 row_newbcast:0 row_mask:0xf bank_mask:0xf
    v_and_b32_dpp v51, v29, v7 row_newbcast:0 row_mask:0xf bank_mask:0xf
    s_waitcnt vmcnt(11)
    v_and_b32_dpp v52, v29, v4 row_newbcast:1 row_mask:0xf bank_mask:0xf
    v_and_b32_dpp v53, v29, v5 row_newbcast:1 row_mask:0xf bank_mask:0xf
    v_and_b32_dpp v54, v29, v6 row_newbcast:1 row_mask:0xf bank_mask:0xf
    v_and_b32_dpp v55, v29, v7 row_newbcast:1 row_mask:0xf bank_mask:0xf
    v_mfma_f32_16x16x32_bf16 v[40:43], v[48:51], v[96:99], 0
    buffer_load_dwordx4 a[20:23], v3, s[20:23], s29 offen offset:1024 nt
    s_waitcnt vmcnt(11)
    v_and_b32_dpp v48, v29, v4 row_newbcast:2 row_mask:0xf bank_mask:0xf
    v_and_b32_dpp v49, v29, v5 row_newbcast:2 row_mask:0xf bank_mask:0xf
    v_and_b32_dpp v50, v29, v6 row_newbcast:2 row_mask:0xf bank_mask:0xf
    v_and_b32_dpp v51, v29, v7 row_newbcast:2 row_mask:0xf bank_mask:0xf
    v_mfma_f32_16x16x32_bf16 v[40:43], v[52:55], v[100:103], v[40:43]
    buffer_load_dwordx4 a[24:27], v3, s[20:23], s29 offen offset:2048 nt
    s_waitcnt vmcnt(11)
    v_and_b32_dpp v52, v29, v4 row_newbcast:3 row_mask:0xf bank_mask:0xf
    v_and_b32_dpp v53, v29, v5 row_newbcast:3 row_mask:0xf bank_mask:0xf
    v_and_b32_dpp v54, v29, v6 row_newbcast:3 row_mask:0xf bank_mask:0xf
    v_and_b32_dpp v55, v29, v7 row_newbcast:3 row_mask:0xf bank_mask:0xf
    v_mfma_f32_16x16x32_bf16 v[40:43], v[48:51], v[104:107], v[40:43]
    buffer_load_dwordx4 a[28:31], v3, s[20:23], s29 offen offset:3072 nt
    s_waitcnt vmcnt(11)
    v_and_b32_dpp v48, v29, v4 row_newbcast:4 row_mask:0xf bank_mask:0xf
    v_and_b32_dpp v49, v29, v5 row_newbcast:4 row_mask:0xf bank_mask:0xf
    v_and_b32_dpp v50, v29, v6 row_newbcast:4 row_mask:0xf bank_mask:0xf
    v_and_b32_dpp v51, v29, v7 row_newbcast:4 row_mask:0xf bank_mask:0xf
    v_mfma_f32_16x16x32_bf16 v[40:43], v[52:55], v[108:111], v[40:43]
    buffer_load_dwordx4 v[96:99], v2, s[20:23], s30 offen offset:0 nt
    s_waitcnt vmcnt(11)
    v_and_b32_dpp v52, v29, v4 row_newbcast:5 row_mask:0xf bank_mask:0xf
    v_and_b32_dpp v53, v29, v5 row_newbcast:5 row_mask:0xf bank_mask:0xf
    v_and_b32_dpp v54, v29, v6 row_newbcast:5 row_mask:0xf bank_mask:0xf
    v_and_b32_dpp v55, v29, v7 row_newbcast:5 row_mask:0xf bank_mask:0xf
    v_mfma_f32_16x16x32_bf16 v[40:43], v[48:51], v[112:115], v[40:43]
    buffer_load_dwordx4 v[100:103], v2, s[20:23], s30 offen offset:1024 nt
    s_waitcnt vmcnt(11)
    v_and_b32_dpp v48, v29, v4 row_newbcast:6 row_mask:0xf bank_mask:0xf
    v_and_b32_dpp v49, v29, v5 row_newbcast:6 row_mask:0xf bank_mask:0xf
    v_and_b32_dpp v50, v29, v6 row_newbcast:6 row_mask:0xf bank_mask:0xf
    v_and_b32_dpp v51, v29, v7 row_newbcast:6 row_mask:0xf bank_mask:0xf
    v_mfma_f32_16x16x32_bf16 v[40:43], v[52:55], v[116:119], v[40:43]
    buffer_load_dwordx4 v[104:107], v2, s[20:23], s30 offen offset:2048 nt
    s_waitcnt vmcnt(11)
    v_and_b32_dpp v52, v29, v4 row_newbcast:7 row_mask:0xf bank_mask:0xf
    v_and_b32_dpp v53, v29, v5 row_newbcast:7 row_mask:0xf bank_mask:0xf
    v_and_b32_dpp v54, v29, v6 row_newbcast:7 row_mask:0xf bank_mask:0xf
    v_and_b32_dpp v55, v29, v7 row_newbcast:7 row_mask:0xf bank_mask:0xf
    v_mfma_f32_16x16x32_bf16 v[40:43], v[48:51], v[120:123], v[40:43]
    buffer_load_dwordx4 v[108:111], v2, s[20:23], s30 offen offset:3072 nt
    s_waitcnt vmcnt(11)
    v_and_b32_dpp v48, v29, v4 row_newbcast:8 row_mask:0xf bank_mask:0xf
    v_and_b32_dpp v49, v29, v5 row_newbcast:8 row_mask:0xf bank_mask:0xf
    v_and_b32_dpp v50, v29, v6 row_newbcast:8 row_mask:0xf bank_mask:0xf
    v_and_b32_dpp v51, v29, v7 row_newbcast:8 row_mask:0xf bank_mask:0xf
    v_mfma_f32_16x16x32_bf16 v[40:43], v[52:55], v[124:127], v[40:43]
    buffer_load_dwordx4 v[112:115], v3, s[20:23], s30 offen offset:0 nt
    s_waitcnt vmcnt(11)
    v_and_b32_dpp v52, v29, v4 row_newbcast:9 row_mask:0xf bank_mask:0xf
    v_and_b32_dpp v53, v29, v5 row_newbcast:9 row_mask:0xf bank_mask:0xf
    v_and_b32_dpp v54, v29, v6 row_newbcast:9 row_mask:0xf bank_mask:0xf
    v_and_b32_dpp v55, v29, v7 row_newbcast:9 row_mask:0xf bank_mask:0xf
    v_mfma_f32_16x16x32_bf16 v[40:43], v[48:51], a[0:3], v[40:43]
    buffer_load_dwordx4 v[116:119], v3, s[20:23], s30 offen offset:1024 nt
    s_waitcnt vmcnt(11)
    v_and_b32_dpp v48, v29, v4 row_newbcast:10 row_mask:0xf bank_mask:0xf
    v_and_b32_dpp v49, v29, v5 row_newbcast:10 row_mask:0xf bank_mask:0xf
    v_and_b32_dpp v50, v29, v6 row_newbcast:10 row_mask:0xf bank_mask:0xf
    v_and_b32_dpp v51, v29, v7 row_newbcast:10 row_mask:0xf bank_mask:0xf
    v_mfma_f32_16x16x32_bf16 v[40:43], v[52:55], a[4:7], v[40:43]
    buffer_load_dwordx4 v[120:123], v3, s[20:23], s30 offen offset:2048 nt
    s_waitcnt vmcnt(11)
    v_and_b32_dpp v52, v29, v4 row_newbcast:11 row_mask:0xf bank_mask:0xf
    v_and_b32_dpp v53, v29, v5 row_newbcast:11 row_mask:0xf bank_mask:0xf
    v_and_b32_dpp v54, v29, v6 row_newbcast:11 row_mask:0xf bank_mask:0xf
    v_and_b32_dpp v55, v29, v7 row_newbcast:11 row_mask:0xf bank_mask:0xf
    v_mfma_f32_16x16x32_bf16 v[40:43], v[48:51], a[8:11], v[40:43]
    buffer_load_dwordx4 v[124:127], v3, s[20:23], s30 offen offset:3072 nt
    s_waitcnt vmcnt(11)
    v_and_b32_dpp v48, v29, v4 row_newbcast:12 row_mask:0xf bank_mask:0xf
    v_and_b32_dpp v49, v29, v5 row_newbcast:12 row_mask:0xf bank_mask:0xf
    v_and_b32_dpp v50, v29, v6 row_newbcast:12 row_mask:0xf bank_mask:0xf
    v_and_b32_dpp v51, v29, v7 row_newbcast:12 row_mask:0xf bank_mask:0xf
    v_mfma_f32_16x16x32_bf16 v[40:43], v[52:55], a[12:15], v[40:43]
    buffer_load_dwordx4 a[0:3], v1, s[8:11], s28 offen offset:0 nt
    s_waitcnt vmcnt(11)
    v_and_b32_dpp v52, v29, v4 row_newbcast:13 row_mask:0xf bank_mask:0xf
    v_and_b32_dpp v53, v29, v5 row_newbcast:13 row_mask:0xf bank_mask:0xf
    v_and_b32_dpp v54, v29, v6 row_newbcast:13 row_mask:0xf bank_mask:0xf
    v_and_b32_dpp v55, v29, v7 row_newbcast:13 row_mask:0xf bank_mask:0xf
    v_mfma_f32_16x16x32_bf16 v[40:43], v[48:51], a[16:19], v[40:43]
    buffer_load_dwordx4 a[4:7], v1, s[8:11], s28 offen offset:128 nt
    s_waitcnt vmcnt(11)
    v_and_b32_dpp v48, v29, v4 row_newbcast:14 row_mask:0xf bank_mask:0xf
    v_and_b32_dpp v49, v29, v5 row_newbcast:14 row_mask:0xf bank_mask:0xf
    v_and_b32_dpp v50, v29, v6 row_newbcast:14 row_mask:0xf bank_mask:0xf
    v_and_b32_dpp v51, v29, v7 row_newbcast:14 row_mask:0xf bank_mask:0xf
    v_mfma_f32_16x16x32_bf16 v[40:43], v[52:55], a[20:23], v[40:43]
    buffer_load_dwordx4 a[8:11], v1, s[8:11], s28 offen offset:256 nt
    s_waitcnt vmcnt(11)
    v_and_b32_dpp v52, v29, v4 row_newbcast:15 row_mask:0xf bank_mask:0xf
    v_and_b32_dpp v53, v29, v5 row_newbcast:15 row_mask:0xf bank_mask:0xf
    v_and_b32_dpp v54, v29, v6 row_newbcast:15 row_mask:0xf bank_mask:0xf
    v_and_b32_dpp v55, v29, v7 row_newbcast:15 row_mask:0xf bank_mask:0xf
    v_mfma_f32_16x16x32_bf16 v[40:43], v[48:51], a[24:27], v[40:43]
    buffer_load_dwordx4 a[12:15], v1, s[8:11], s28 offen offset:384 nt
    s_waitcnt vmcnt(11)
    v_and_b32_dpp v48, v30, v4 row_newbcast:0 row_mask:0xf bank_mask:0xf
    v_and_b32_dpp v49, v30, v5 row_newbcast:0 row_mask:0xf bank_mask:0xf
    v_and_b32_dpp v50, v30, v6 row_newbcast:0 row_mask:0xf bank_mask:0xf
    v_and_b32_dpp v51, v30, v7 row_newbcast:0 row_mask:0xf bank_mask:0xf
    v_mfma_f32_16x16x32_bf16 v[40:43], v[52:55], a[28:31], v[40:43]
    buffer_load_dwordx4 a[16:19], v1, s[8:11], s28 offen offset:512 nt
    s_waitcnt vmcnt(11)
    v_and_b32_dpp v52, v30, v4 row_newbcast:1 row_mask:0xf bank_mask:0xf
    v_and_b32_dpp v53, v30, v5 row_newbcast:1 row_mask:0xf bank_mask:0xf
    v_and_b32_dpp v54, v30, v6 row_newbcast:1 row_mask:0xf bank_mask:0xf
    v_and_b32_dpp v55, v30, v7 row_newbcast:1 row_mask:0xf bank_mask:0xf
    v_mfma_f32_16x16x32_bf16 v[40:43], v[48:51], v[96:99], v[40:43]
    buffer_load_dwordx4 a[20:23], v1, s[8:11], s28 offen offset:640 nt
    s_waitcnt vmcnt(11)
    v_and_b32_dpp v48, v30, v4 row_newbcast:2 row_mask:0xf bank_mask:0xf
    v_and_b32_dpp v49, v30, v5 row_newbcast:2 row_mask:0xf bank_mask:0xf
    v_and_b32_dpp v50, v30, v6 row_newbcast:2 row_mask:0xf bank_mask:0xf
    v_and_b32_dpp v51, v30, v7 row_newbcast:2 row_mask:0xf bank_mask:0xf
    v_mfma_f32_16x16x32_bf16 v[40:43], v[52:55], v[100:103], v[40:43]
    buffer_load_dwordx4 a[24:27], v1, s[8:11], s28 offen offset:768 nt
    s_waitcnt vmcnt(11)
    v_and_b32_dpp v52, v30, v4 row_newbcast:3 row_mask:0xf bank_mask:0xf
    v_and_b32_dpp v53, v30, v5 row_newbcast:3 row_mask:0xf bank_mask:0xf
    v_and_b32_dpp v54, v30, v6 row_newbcast:3 row_mask:0xf bank_mask:0xf
    v_and_b32_dpp v55, v30, v7 row_newbcast:3 row_mask:0xf bank_mask:0xf
    v_mfma_f32_16x16x32_bf16 v[40:43], v[48:51], v[104:107], v[40:43]
    buffer_load_dwordx4 a[28:31], v1, s[8:11], s28 offen offset:896 nt
    s_waitcnt vmcnt(11)
    v_and_b32_dpp v48, v30, v4 row_newbcast:4 row_mask:0xf bank_mask:0xf
    v_and_b32_dpp v49, v30, v5 row_newbcast:4 row_mask:0xf bank_mask:0xf
    v_and_b32_dpp v50, v30, v6 row_newbcast:4 row_mask:0xf bank_mask:0xf
    v_and_b32_dpp v51, v30, v7 row_newbcast:4 row_mask:0xf bank_mask:0xf
    v_mfma_f32_16x16x32_bf16 v[40:43], v[52:55], v[108:111], v[40:43]
    buffer_load_dwordx4 v[96:99], v1, s[8:11], s37 offen offset:0 nt
    s_waitcnt vmcnt(11)
    v_and_b32_dpp v52, v30, v4 row_newbcast:5 row_mask:0xf bank_mask:0xf
    v_and_b32_dpp v53, v30, v5 row_newbcast:5 row_mask:0xf bank_mask:0xf
    v_and_b32_dpp v54, v30, v6 row_newbcast:5 row_mask:0xf bank_mask:0xf
    v_and_b32_dpp v55, v30, v7 row_newbcast:5 row_mask:0xf bank_mask:0xf
    v_mfma_f32_16x16x32_bf16 v[40:43], v[48:51], v[112:115], v[40:43]
    buffer_load_dwordx4 v[100:103], v1, s[8:11], s37 offen offset:128 nt
    s_waitcnt vmcnt(11)
    v_and_b32_dpp v48, v30, v4 row_newbcast:6 row_mask:0xf bank_mask:0xf
    v_and_b32_dpp v49, v30, v5 row_newbcast:6 row_mask:0xf bank_mask:0xf
    v_and_b32_dpp v50, v30, v6 row_newbcast:6 row_mask:0xf bank_mask:0xf
    v_and_b32_dpp v51, v30, v7 row_newbcast:6 row_mask:0xf bank_mask:0xf
    v_mfma_f32_16x16x32_bf16 v[40:43], v[52:55], v[116:119], v[40:43]
    buffer_load_dwordx4 v[104:107], v1, s[8:11], s37 offen offset:256 nt
    s_waitcnt vmcnt(11)
    v_and_b32_dpp v52, v30, v4 row_newbcast:7 row_mask:0xf bank_mask:0xf
    v_and_b32_dpp v53, v30, v5 row_newbcast:7 row_mask:0xf bank_mask:0xf
    v_and_b32_dpp v54, v30, v6 row_newbcast:7 row_mask:0xf bank_mask:0xf
    v_and_b32_dpp v55, v30, v7 row_newbcast:7 row_mask:0xf bank_mask:0xf
    v_mfma_f32_16x16x32_bf16 v[40:43], v[48:51], v[120:123], v[40:43]
    buffer_load_dwordx4 v[108:111], v1, s[8:11], s37 offen offset:384 nt
    v_mfma_f32_16x16x32_bf16 v[40:43], v[52:55], v[124:127], v[40:43]
    v_max3_u32 v38, v8, v9, v10
    v_max3_u32 v38, v38, v11, v12
    v_max3_u32 v38, v38, v13, v14
    v_max_u32 v38, v38, v15
    v_cmp_eq_u32 vcc, -1, v38
    s_nop 3
    s_cbranch_vccz L_qok_12
    v_mov_b32 v8, -1
    v_mov_b32 v9, -1
    v_mov_b32 v10, -1
    v_mov_b32 v11, -1
    v_mov_b32 v12, -1
    v_mov_b32 v13, -1
    v_mov_b32 v14, -1
    v_mov_b32 v15, -1
    s_mov_b32 s73, 0
    s_nop 0
L_pl_13:
    s_add_u32 s74, s71, 16384
    buffer_load_dwordx4 v[8:11], v39, s[24:27], s74 offen sc1
    buffer_load_dwordx4 v[12:15], v39, s[24:27], s74 offen offset:128 sc1
    s_waitcnt vmcnt(0)
    v_max3_u32 v38, v8, v9, v10
    v_max3_u32 v38, v38, v11, v12
    v_max3_u32 v38, v38, v13, v14
    v_max_u32 v38, v38, v15
    v_cmp_eq_u32 vcc, -1, v38
    s_add_u32 s73, s73, 1
    s_cmp_gt_u32 s73, 60000
    s_nop 1
    s_cbranch_scc1 L_pd_14
    s_cbranch_vccnz L_pl_13
L_pd_14:
L_qok_12:
    v_mfma_f32_16x16x32_bf16 v[48:51], v[8:11], a[32:35], 0
    v_mfma_f32_16x16x32_bf16 v[52:55], v[8:11], a[40:43], 0
    v_mfma_f32_16x16x32_bf16 v[48:51], v[12:15], a[36:39], v[48:51]
    v_mfma_f32_16x16x32_bf16 v[52:55], v[12:15], a[44:47], v[52:55]
    v_mfma_f32_16x16x32_bf16 v[56:59], v[8:11], a[48:51], 0
    v_mfma_f32_16x16x32_bf16 v[60:63], v[8:11], a[56:59], 0
    v_mfma_f32_16x16x32_bf16 v[56:59], v[12:15], a[52:55], v[56:59]
    v_mfma_f32_16x16x32_bf16 v[60:63], v[12:15], a[60:63], v[60:63]
    s_nop 2
    v_add_f32_dpp v24, v48, v49 row_ror:8 row_mask:0x1 bank_mask:0xc
    s_nop 1
    v_add_f32_dpp v24, v52, v53 row_ror:8 row_mask:0x2 bank_mask:0xc
    v_mfma_f32_16x16x32_bf16 v[48:51], v[8:11], a[64:67], 0
    v_mfma_f32_16x16x32_bf16 v[52:55], v[8:11], a[72:75], 0
    v_mfma_f32_16x16x32_bf16 v[48:51], v[12:15], a[68:71], v[48:51]
    v_mfma_f32_16x16x32_bf16 v[52:55], v[12:15], a[76:79], v[52:55]
    v_add_f32_dpp v24, v56, v57 row_ror:8 row_mask:0x4 bank_mask:0xc
    s_nop 1
    v_add_f32_dpp v24, v60, v61 row_ror:8 row_mask:0x8 bank_mask:0xc
    v_mfma_f32_16x16x32_bf16 v[56:59], v[8:11], a[80:83], 0
    v_mfma_f32_16x16x32_bf16 v[60:63], v[8:11], a[88:91], 0
    v_mfma_f32_16x16x32_bf16 v[56:59], v[12:15], a[84:87], v[56:59]
    v_mfma_f32_16x16x32_bf16 v[60:63], v[12:15], a[92:95], v[60:63]
    v_add_f32_dpp v25, v49, v48 row_ror:8 row_mask:0x1 bank_mask:0x3
    s_nop 1
    v_add_f32_dpp v25, v53, v52 row_ror:8 row_mask:0x2 bank_mask:0x3
    s_waitcnt vmcnt(11)
    buffer_load_dwordx4 v[112:115], v1, s[8:11], s37 offen offset:512 nt
    v_mfma_f32_16x16x32_bf16 v[48:51], v[8:11], a[96:99], 0
    v_mfma_f32_16x16x32_bf16 v[52:55], v[8:11], a[104:107], 0
    v_mfma_f32_16x16x32_bf16 v[48:51], v[12:15], a[100:103], v[48:51]
    v_mfma_f32_16x16x32_bf16 v[52:55], v[12:15], a[108:111], v[52:55]
    v_add_f32_dpp v25, v57, v56 row_ror:8 row_mask:0x4 bank_mask:0x3
    s_nop 1
    v_add_f32_dpp v25, v61, v60 row_ror:8 row_mask:0x8 bank_mask:0x3
    v_mfma_f32_16x16x32_bf16 v[56:59], v[8:11], a[112:115], 0
    v_mfma_f32_16x16x32_bf16 v[60:63], v[8:11], a[120:123], 0
    v_mfma_f32_16x16x32_bf16 v[56:59], v[12:15], a[116:119], v[56:59]
    v_mfma_f32_16x16x32_bf16 v[60:63], v[12:15], a[124:127], v[60:63]
    v_add_f32_dpp v25, v48, v49 row_ror:8 row_mask:0x1 bank_mask:0xc
    s_nop 1
    v_add_f32_dpp v25, v52, v53 row_ror:8 row_mask:0x2 bank_mask:0xc
    v_mfma_f32_16x16x32_bf16 v[48:51], v[8:11], a[128:131], 0
    v_mfma_f32_16x16x32_bf16 v[52:55], v[8:11], a[136:139], 0
    v_mfma_f32_16x16x32_bf16 v[48:51], v[12:15], a[132:135], v[48:51]
    v_mfma_f32_16x16x32_bf16 v[52:55], v[12:15], a[140:143], v[52:55]
    v_add_f32_dpp v25, v56, v57 row_ror:8 row_mask:0x4 bank_mask:0xc
    s_nop 1
    v_add_f32_dpp v25, v60, v61 row_ror:8 row_mask:0x8 bank_mask:0xc
    v_mfma_f32_16x16x32_bf16 v[56:59], v[8:11], a[144:147], 0
    v_mfma_f32_16x16x32_bf16 v[60:63], v[8:11], a[152:155], 0
    v_mfma_f32_16x16x32_bf16 v[56:59], v[12:15], a[148:151], v[56:59]
    v_mfma_f32_16x16x32_bf16 v[60:63], v[12:15], a[156:159], v[60:63]
    v_add_f32_dpp v26, v49, v48 row_ror:8 row_mask:0x1 bank_mask:0x3
    s_nop 1
    v_add_f32_dpp v26, v53, v52 row_ror:8 row_mask:0x2 bank_mask:0x3
    v_mfma_f32_16x16x32_bf16 v[48:51], v[8:11], a[160:163], 0
    v_mfma_f32_16x16x32_bf16 v[52:55], v[8:11], a[168:171], 0
    v_mfma_f32_16x16x32_bf16 v[48:51], v[12:15], a[164:167], v[48:51]
    v_mfma_f32_16x16x32_bf16 v[52:55], v[12:15], a[172:175], v[52:55]
    v_add_f32_dpp v26, v57, v56 row_ror:8 row_mask:0x4 bank_mask:0x3
    s_nop 1
    v_add_f32_dpp v26, v61, v60 row_ror:8 row_mask:0x8 bank_mask:0x3
    s_waitcnt vmcnt(11)
    buffer_load_dwordx4 v[116:119], v1, s[8:11], s37 offen offset:640 nt
    v_mfma_f32_16x16x32_bf16 v[56:59], v[8:11], a[176:179], 0
    v_mfma_f32_16x16x32_bf16 v[60:63], v[8:11], a[184:187], 0
    v_mfma_f32_16x16x32_bf16 v[56:59], v[12:15], a[180:183], v[56:59]
    v_mfma_f32_16x16x32_bf16 v[60:63], v[12:15], a[188:191], v[60:63]
    v_add_f32_dpp v26, v48, v49 row_ror:8 row_mask:0x1 bank_mask:0xc
    s_nop 1
    v_add_f32_dpp v26, v52, v53 row_ror:8 row_mask:0x2 bank_mask:0xc
    v_mfma_f32_16x16x32_bf16 v[48:51], v[8:11], a[192:195], 0
    v_mfma_f32_16x16x32_bf16 v[52:55], v[8:11], a[200:203], 0
    v_mfma_f32_16x16x32_bf16 v[48:51], v[12:15], a[196:199], v[48:51]
    v_mfma_f32_16x16x32_bf16 v[52:55], v[12:15], a[204:207], v[52:55]
    v_add_f32_dpp v26, v56, v57 row_ror:8 row_mask:0x4 bank_mask:0xc
    s_nop 1
    v_add_f32_dpp v26, v60, v61 row_ror:8 row_mask:0x8 bank_mask:0xc
    v_mfma_f32_16x16x32_bf16 v[56:59], v[8:11], a[208:211], 0
    v_mfma_f32_16x16x32_bf16 v[60:63], v[8:11], a[216:219], 0
    v_mfma_f32_16x16x32_bf16 v[56:59], v[12:15], a[212:215], v[56:59]
    v_mfma_f32_16x16x32_bf16 v[60:63], v[12:15], a[220:223], v[60:63]
    v_add_f32_dpp v27, v49, v48 row_ror:8 row_mask:0x1 bank_mask:0x3
    s_nop 1
    v_add_f32_dpp v27, v53, v52 row_ror:8 row_mask:0x2 bank_mask:0x3
    v_mfma_f32_16x16x32_bf16 v[48:51], v[8:11], a[224:227], 0
    v_mfma_f32_16x16x32_bf16 v[52:55], v[8:11], a[232:235], 0
    v_mfma_f32_16x16x32_bf16 v[48:51], v[12:15], a[228:231], v[48:51]
    v_mfma_f32_16x16x32_bf16 v[52:55], v[12:15], a[236:239], v[52:55]
    v_add_f32_dpp v27, v57, v56 row_ror:8 row_mask:0x4 bank_mask:0x3
    s_nop 1
    v_add_f32_dpp v27, v61, v60 row_ror:8 row_mask:0x8 bank_mask:0x3
    v_mfma_f32_16x16x32_bf16 v[56:59], v[8:11], a[240:243], 0
    v_mfma_f32_16x16x32_bf16 v[60:63], v[8:11], a[248:251], 0
    v_mfma_f32_16x16x32_bf16 v[56:59], v[12:15], a[244:247], v[56:59]
    v_mfma_f32_16x16x32_bf16 v[60:63], v[12:15], a[252:255], v[60:63]
    v_add_f32_dpp v27, v48, v49 row_ror:8 row_mask:0x1 bank_mask:0xc
    s_nop 1
    v_add_f32_dpp v27, v52, v53 row_ror:8 row_mask:0x2 bank_mask:0xc
    s_waitcnt vmcnt(11)
    buffer_load_dwordx4 v[120:123], v1, s[8:11], s37 offen offset:768 nt
    v_mfma_f32_16x16x32_bf16 v[48:51], v[8:11], v[64:67], 0
    v_mfma_f32_16x16x32_bf16 v[52:55], v[8:11], v[72:75], 0
    v_mfma_f32_16x16x32_bf16 v[48:51], v[12:15], v[68:71], v[48:51]
    v_mfma_f32_16x16x32_bf16 v[52:55], v[12:15], v[76:79], v[52:55]
    v_add_f32_dpp v27, v56, v57 row_ror:8 row_mask:0x4 bank_mask:0xc
    s_nop 1
    v_add_f32_dpp v27, v60, v61 row_ror:8 row_mask:0x8 bank_mask:0xc
    v_mfma_f32_16x16x32_bf16 v[56:59], v[8:11], v[80:83], 0
    v_mfma_f32_16x16x32_bf16 v[60:63], v[8:11], v[88:91], 0
    v_mfma_f32_16x16x32_bf16 v[56:59], v[12:15], v[84:87], v[56:59]
    v_mfma_f32_16x16x32_bf16 v[60:63], v[12:15], v[92:95], v[60:63]
    v_add_f32_dpp v28, v49, v48 row_ror:8 row_mask:0x1 bank_mask:0x3
    s_nop 1
    v_add_f32_dpp v28, v53, v52 row_ror:8 row_mask:0x2 bank_mask:0x3
    s_waitcnt vmcnt(11)
    v_mfma_f32_16x16x32_bf16 v[48:51], v[8:11], a[0:3], 0
    v_mfma_f32_16x16x32_bf16 v[52:55], v[8:11], a[8:11], 0
    v_mfma_f32_16x16x32_bf16 v[48:51], v[12:15], a[4:7], v[48:51]
    v_mfma_f32_16x16x32_bf16 v[52:55], v[12:15], a[12:15], v[52:55]
    v_add_f32_dpp v28, v57, v56 row_ror:8 row_mask:0x4 bank_mask:0x3
    s_nop 1
    v_add_f32_dpp v28, v61, v60 row_ror:8 row_mask:0x8 bank_mask:0x3
    buffer_load_dwordx4 v[124:127], v1, s[8:11], s37 offen offset:896 nt
    s_waitcnt vmcnt(8)
    v_mfma_f32_16x16x32_bf16 v[56:59], v[8:11], a[16:19], 0
    v_mfma_f32_16x16x32_bf16 v[60:63], v[8:11], a[24:27], 0
    v_mfma_f32_16x16x32_bf16 v[56:59], v[12:15], a[20:23], v[56:59]
    v_mfma_f32_16x16x32_bf16 v[60:63], v[12:15], a[28:31], v[60:63]
    v_add_f32_dpp v24, v49, v48 row_ror:8 row_mask:0x1 bank_mask:0x3
    s_nop 1
    v_add_f32_dpp v24, v53, v52 row_ror:8 row_mask:0x2 bank_mask:0x3
    buffer_load_dwordx4 a[32:35], v2, s[12:15], s37 offen offset:0 nt
    buffer_load_dwordx4 a[36:39], v2, s[12:15], s37 offen offset:1024 nt
    buffer_load_dwordx4 a[40:43], v2, s[12:15], s37 offen offset:2048 nt
    buffer_load_dwordx4 a[44:47], v2, s[12:15], s37 offen offset:3072 nt
    s_waitcnt vmcnt(8)
    v_mfma_f32_16x16x32_bf16 v[48:51], v[8:11], v[96:99], 0
    v_mfma_f32_16x16x32_bf16 v[52:55], v[8:11], v[104:107], 0
    v_mfma_f32_16x16x32_bf16 v[48:51], v[12:15], v[100:103], v[48:51]
    v_mfma_f32_16x16x32_bf16 v[52:55], v[12:15], v[108:111], v[52:55]
    v_add_f32_dpp v24, v57, v56 row_ror:8 row_mask:0x4 bank_mask:0x3
    s_nop 1
    v_add_f32_dpp v24, v61, v60 row_ror:8 row_mask:0x8 bank_mask:0x3
    buffer_load_dwordx4 a[48:51], v3, s[12:15], s37 offen offset:0 nt
    buffer_load_dwordx4 a[52:55], v3, s[12:15], s37 offen offset:1024 nt
    buffer_load_dwordx4 a[56:59], v3, s[12:15], s37 offen offset:2048 nt
    buffer_load_dwordx4 a[60:63], v3, s[12:15], s37 offen offset:3072 nt
    s_waitcnt vmcnt(8)
    v_mfma_f32_16x16x32_bf16 v[56:59], v[8:11], v[112:115], 0
    v_mfma_f32_16x16x32_bf16 v[60:63], v[8:11], v[120:123], 0
    v_mfma_f32_16x16x32_bf16 v[56:59], v[12:15], v[116:119], v[56:59]
    v_mfma_f32_16x16x32_bf16 v[60:63], v[12:15], v[124:127], v[60:63]
    v_add_f32_dpp v28, v48, v49 row_ror:8 row_mask:0x1 bank_mask:0xc
    s_nop 1
    v_add_f32_dpp v28, v52, v53 row_ror:8 row_mask:0x2 bank_mask:0xc
    buffer_load_dwordx4 a[64:67], v2, s[20:23], s31 offen offset:0 nt
    buffer_load_dwordx4 a[68:71], v2, s[20:23], s31 offen offset:1024 nt
    buffer_load_dwordx4 a[72:75], v2, s[20:23], s31 offen offset:2048 nt
    buffer_load_dwordx4 a[76:79], v2, s[20:23], s31 offen offset:3072 nt
    v_add_f32_dpp v28, v56, v57 row_ror:8 row_mask:0x4 bank_mask:0xc
    s_nop 1
    v_add_f32_dpp v28, v60, v61 row_ror:8 row_mask:0x8 bank_mask:0xc
    v_cvt_pk_bf16_f32 v48, v24, v25
    v_lshlrev_b32 v24, 16, v48
    v_and_b32 v25, 0xffff0000, v48
    v_mul_f32 v24, 0x3db504f3, v24
    v_mul_f32 v25, 0x3db504f3, v25
    v_cvt_pk_bf16_f32 v48, v24, v25
    v_lshlrev_b32 v24, 16, v48
    v_and_b32 v25, 0xffff0000, v48
    v_cvt_pk_bf16_f32 v48, v26, v27
    v_lshlrev_b32 v26, 16, v48
    v_and_b32 v27, 0xffff0000, v48
    v_mul_f32 v26, 0x3db504f3, v26
    v_mul_f32 v27, 0x3db504f3, v27
    v_cvt_pk_bf16_f32 v48, v26, v27
    v_lshlrev_b32 v26, 16, v48
    v_and_b32 v27, 0xffff0000, v48
    v_cvt_pk_bf16_f32 v48, v28, v28
    v_lshlrev_b32 v28, 16, v48
    v_mul_f32 v28, 0x3db504f3, v28
    v_cvt_pk_bf16_f32 v48, v28, v28
    v_lshlrev_b32 v28, 16, v48
    v_mov_b32 v48, 0xff800000
    v_cndmask_b32 v28, v28, v48, s[64:65]
    v_max_f32 v34, v24, v25
    v_max3_f32 v34, v34, v26, v27
    v_max_f32 v34, v34, v28
    s_nop 1
    v_max_f32_dpp v34, v34, v34 quad_perm:[1,0,3,2] row_mask:0xf bank_mask:0xf
    s_nop 1
    v_max_f32_dpp v34, v34, v34 quad_perm:[2,3,0,1] row_mask:0xf bank_mask:0xf
    s_nop 1
    v_max_f32_dpp v34, v34, v34 row_ror:4 row_mask:0xf bank_mask:0xf
    s_nop 1
    v_max_f32_dpp v34, v34, v34 row_ror:8 row_mask:0xf bank_mask:0xf
    v_mov_b32 v48, v34
    s_nop 1
    v_permlane16_swap_b32 v34, v48
    v_max_f32 v34, v34, v48
    v_mov_b32 v48, v34
    s_nop 1
    v_permlane32_swap_b32 v34, v48
    v_max_f32 v34, v34, v48
    v_sub_f32 v24, v24, v34
    v_mul_f32 v24, 0x3fb8aa3b, v24
    v_exp_f32 v24, v24
    v_sub_f32 v25, v25, v34
    v_mul_f32 v25, 0x3fb8aa3b, v25
    v_exp_f32 v25, v25
    v_sub_f32 v26, v26, v34
    v_mul_f32 v26, 0x3fb8aa3b, v26
    v_exp_f32 v26, v26
    v_sub_f32 v27, v27, v34
    v_mul_f32 v27, 0x3fb8aa3b, v27
    v_exp_f32 v27, v27
    v_sub_f32 v28, v28, v34
    v_mul_f32 v28, 0x3fb8aa3b, v28
    v_exp_f32 v28, v28
    v_add_f32 v35, v24, v25
    v_add_f32 v48, v26, v27
    v_add_f32 v35, v35, v28
    v_add_f32 v35, v35, v48
    v_cvt_pk_bf16_f32 v24, v24, v24
    v_cvt_pk_bf16_f32 v25, v25, v25
    v_cvt_pk_bf16_f32 v26, v26, v26
    v_cvt_pk_bf16_f32 v27, v27, v27
    v_cvt_pk_bf16_f32 v28, v28, v28
    s_waitcnt vmcnt(11)
    buffer_load_dwordx4 a[80:83], v3, s[20:23], s31 offen offset:0 nt
    v_mov_b32 v8, v24
    v_mov_b32 v13, v24
    v_mov_b32 v9, v25
    v_mov_b32 v14, v25
    v_mov_b32 v10, v26
    v_mov_b32 v15, v26
    v_mov_b32 v11, v27
    v_mov_b32 v16, v27
    v_mov_b32 v12, v28
    v_mov_b32 v17, v28
    v_mov_b32_dpp v8, v24 row_shr:4 row_mask:0xf bank_mask:0xa
    v_mov_b32_dpp v13, v24 row_shl:4 row_mask:0xf bank_mask:0x5
    v_mov_b32_dpp v9, v25 row_shr:4 row_mask:0xf bank_mask:0xa
    v_mov_b32_dpp v14, v25 row_shl:4 row_mask:0xf bank_mask:0x5
    v_mov_b32_dpp v10, v26 row_shr:4 row_mask:0xf bank_mask:0xa
    v_mov_b32_dpp v15, v26 row_shl:4 row_mask:0xf bank_mask:0x5
    v_mov_b32_dpp v11, v27 row_shr:4 row_mask:0xf bank_mask:0xa
    v_mov_b32_dpp v16, v27 row_shl:4 row_mask:0xf bank_mask:0x5
    v_mov_b32_dpp v12, v28 row_shr:4 row_mask:0xf bank_mask:0xa
    v_mov_b32_dpp v17, v28 row_shl:4 row_mask:0xf bank_mask:0x5
    ds_read_b128 v[104:107], v0 offset:0
    ds_read_b128 v[108:111], v0 offset:8192
    ds_read_b128 v[112:115], v0 offset:1024
    ds_read_b128 v[116:119], v0 offset:9216
    ds_read_b128 v[120:123], v0 offset:2048
    ds_read_b128 v[124:127], v0 offset:10240
    v_and_b32_dpp v48, v8, v4 quad_perm:[0,0,0,0] row_mask:0xf bank_mask:0xf
    v_and_b32_dpp v49, v8, v5 quad_perm:[0,0,0,0] row_mask:0xf bank_mask:0xf
    v_and_b32_dpp v50, v8, v6 quad_perm:[0,0,0,0] row_mask:0xf bank_mask:0xf
    v_and_b32_dpp v51, v8, v7 quad_perm:[0,0,0,0] row_mask:0xf bank_mask:0xf
    v_and_b32_dpp v52, v8, v4 quad_perm:[1,1,1,1] row_mask:0xf bank_mask:0xf
    v_and_b32_dpp v53, v8, v5 quad_perm:[1,1,1,1] row_mask:0xf bank_mask:0xf
    v_and_b32_dpp v54, v8, v6 quad_perm:[1,1,1,1] row_mask:0xf bank_mask:0xf
    v_and_b32_dpp v55, v8, v7 quad_perm:[1,1,1,1] row_mask:0xf bank_mask:0xf
    s_waitcnt lgkmcnt(5)
    v_mfma_f32_16x16x32_bf16 v[44:47], v[48:51], v[104:107], 0
    s_waitcnt lgkmcnt(4)
    v_mfma_f32_16x16x32_bf16 v[20:23], v[48:51], v[108:111], 0
    ds_read_b128 v[104:107], v0 offset:3072
    ds_read_b128 v[108:111], v0 offset:11264
    v_and_b32_dpp v48, v11, v4 quad_perm:[0,0,0,0] row_mask:0xf bank_mask:0xf
    v_and_b32_dpp v49, v11, v5 quad_perm:[0,0,0,0] row_mask:0xf bank_mask:0xf
    v_and_b32_dpp v50, v11, v6 quad_perm:[0,0,0,0] row_mask:0xf bank_mask:0xf
    v_and_b32_dpp v51, v11, v7 quad_perm:[0,0,0,0] row_mask:0xf bank_mask:0xf
    s_waitcnt lgkmcnt(5)
    v_mfma_f32_16x16x32_bf16 v[44:47], v[52:55], v[112:115], v[44:47]
    s_waitcnt lgkmcnt(4)
    v_mfma_f32_16x16x32_bf16 v[20:23], v[52:55], v[116:119], v[20:23]
    ds_read_b128 v[112:115], v0 offset:4096
    ds_read_b128 v[116:119], v0 offset:12288
    v_and_b32_dpp v52, v8, v4 quad_perm:[2,2,2,2] row_mask:0xf bank_mask:0xf
    v_and_b32_dpp v53, v8, v5 quad_perm:[2,2,2,2] row_mask:0xf bank_mask:0xf
    v_and_b32_dpp v54, v8, v6 quad_perm:[2,2,2,2] row_mask:0xf bank_mask:0xf
    v_and_b32_dpp v55, v8, v7 quad_perm:[2,2,2,2] row_mask:0xf bank_mask:0xf
    v_mfma_f32_16x16x32_bf16 v[44:47], v[48:51], v[160:163], v[44:47]
    v_mfma_f32_16x16x32_bf16 v[20:23], v[48:51], v[192:195], v[20:23]
    v_and_b32_dpp v48, v8, v4 quad_perm:[3,3,3,3] row_mask:0xf bank_mask:0xf
    v_and_b32_dpp v49, v8, v5 quad_perm:[3,3,3,3] row_mask:0xf bank_mask:0xf
    v_and_b32_dpp v50, v8, v6 quad_perm:[3,3,3,3] row_mask:0xf bank_mask:0xf
    v_and_b32_dpp v51, v8, v7 quad_perm:[3,3,3,3] row_mask:0xf bank_mask:0xf
    s_waitcnt lgkmcnt(5)
    v_mfma_f32_16x16x32_bf16 v[44:47], v[52:55], v[120:123], v[44:47]
    s_waitcnt lgkmcnt(4)
    v_mfma_f32_16x16x32_bf16 v[20:23], v[52:55], v[124:127], v[20:23]
    ds_read_b128 v[120:123], v0 offset:5120
    ds_read_b128 v[124:127], v0 offset:13312
    v_and_b32_dpp v52, v13, v4 quad_perm:[0,0,0,0] row_mask:0xf bank_mask:0xf
    v_and_b32_dpp v53, v13, v5 quad_perm:[0,0,0,0] row_mask:0xf bank_mask:0xf
    v_and_b32_dpp v54, v13, v6 quad_perm:[0,0,0,0] row_mask:0xf bank_mask:0xf
    v_and_b32_dpp v55, v13, v7 quad_perm:[0,0,0,0] row_mask:0xf bank_mask:0xf
    s_waitcnt lgkmcnt(5)
    v_mfma_f32_16x16x32_bf16 v[44:47], v[48:51], v[104:107], v[44:47]
    s_waitcnt lgkmcnt(4)
    v_mfma_f32_16x16x32_bf16 v[20:23], v[48:51], v[108:111], v[20:23]
    ds_read_b128 v[104:107], v0 offset:6144
    ds_read_b128 v[108:111], v0 offset:14336
    v_and_b32_dpp v48, v11, v4 quad_perm:[1,1,1,1] row_mask:0xf bank_mask:0xf
    v_and_b32_dpp v49, v11, v5 quad_perm:[1,1,1,1] row_mask:0xf bank_mask:0xf
    v_and_b32_dpp v50, v11, v6 quad_perm:[1,1,1,1] row_mask:0xf bank_mask:0xf
    v_and_b32_dpp v51, v11, v7 quad_perm:[1,1,1,1] row_mask:0xf bank_mask:0xf
    s_waitcnt lgkmcnt(5)
    v_mfma_f32_16x16x32_bf16 v[44:47], v[52:55], v[112:115], v[44:47]
    s_waitcnt lgkmcnt(4)
    v_mfma_f32_16x16x32_bf16 v[20:23], v[52:55], v[116:119], v[20:23]
    ds_read_b128 v[112:115], v0 offset:7168
    ds_read_b128 v[116:119], v0 offset:15360
    s_waitcnt vmcnt(11)
    s_add_u32 m0, s68, 7168
    s_nop 0
    buffer_load_dwordx4 v3, s[20:23], s31 offen offset:1024 nt lds
    v_and_b32_dpp v52, v13, v4 quad_perm:[1,1,1,1] row_mask:0xf bank_mask:0xf
    v_and_b32_dpp v53, v13, v5 quad_perm:[1,1,1,1] row_mask:0xf bank_mask:0xf
    v_and_b32_dpp v54, v13, v6 quad_perm:[1,1,1,1] row_mask:0xf bank_mask:0xf
    v_and_b32_dpp v55, v13, v7 quad_perm:[1,1,1,1] row_mask:0xf bank_mask:0xf
    v_mfma_f32_16x16x32_bf16 v[44:47], v[48:51], v[164:167], v[44:47]
    v_mfma_f32_16x16x32_bf16 v[20:23], v[48:51], v[196:199], v[20:23]
    v_and_b32_dpp v48, v13, v4 quad_perm:[2,2,2,2] row_mask:0xf bank_mask:0xf
    v_and_b32_dpp v49, v13, v5 quad_perm:[2,2,2,2] row_mask:0xf bank_mask:0xf
    v_and_b32_dpp v50, v13, v6 quad_perm:[2,2,2,2] row_mask:0xf bank_mask:0xf
    v_and_b32_dpp v51, v13, v7 quad_perm:[2,2,2,2] row_mask:0xf bank_mask:0xf
    s_waitcnt lgkmcnt(5)
    v_mfma_f32_16x16x32_bf16 v[44:47], v[52:55], v[120:123], v[44:47]
    s_waitcnt lgkmcnt(4)
    v_mfma_f32_16x16x32_bf16 v[20:23], v[52:55], v[124:127], v[20:23]
    ds_read_b128 v[120:123], v0 offset:16384
    ds_read_b128 v[124:127], v0 offset:24576
    v_and_b32_dpp v52, v13, v4 quad_perm:[3,3,3,3] row_mask:0xf bank_mask:0xf
    v_and_b32_dpp v53, v13, v5 quad_perm:[3,3,3,3] row_mask:0xf bank_mask:0xf
    v_and_b32_dpp v54, v13, v6 quad_perm:[3,3,3,3] row_mask:0xf bank_mask:0xf
    v_and_b32_dpp v55, v13, v7 quad_perm:[3,3,3,3] row_mask:0xf bank_mask:0xf
    s_waitcnt lgkmcnt(5)
    v_mfma_f32_16x16x32_bf16 v[44:47], v[48:51], v[104:107], v[44:47]
    s_waitcnt lgkmcnt(4)
    v_mfma_f32_16x16x32_bf16 v[20:23], v[48:51], v[108:111], v[20:23]
    ds_read_b128 v[104:107], v0 offset:17408
    ds_read_b128 v[108:111], v0 offset:25600
    v_and_b32_dpp v48, v11, v4 quad_perm:[2,2,2,2] row_mask:0xf bank_mask:0xf
    v_and_b32_dpp v49, v11, v5 quad_perm:[2,2,2,2] row_mask:0xf bank_mask:0xf
    v_and_b32_dpp v50, v11, v6 quad_perm:[2,2,2,2] row_mask:0xf bank_mask:0xf
    v_and_b32_dpp v51, v11, v7 quad_perm:[2,2,2,2] row_mask:0xf bank_mask:0xf
    s_waitcnt lgkmcnt(5)
    v_mfma_f32_16x16x32_bf16 v[44:47], v[52:55], v[112:115], v[44:47]
    s_waitcnt lgkmcnt(4)
    v_mfma_f32_16x16x32_bf16 v[20:23], v[52:55], v[116:119], v[20:23]
    ds_read_b128 v[112:115], v0 offset:18432
    ds_read_b128 v[116:119], v0 offset:26624
    v_and_b32_dpp v52, v9, v4 quad_perm:[0,0,0,0] row_mask:0xf bank_mask:0xf
    v_and_b32_dpp v53, v9, v5 quad_perm:[0,0,0,0] row_mask:0xf bank_mask:0xf
    v_and_b32_dpp v54, v9, v6 quad_perm:[0,0,0,0] row_mask:0xf bank_mask:0xf
    v_and_b32_dpp v55, v9, v7 quad_perm:[0,0,0,0] row_mask:0xf bank_mask:0xf
    v_mfma_f32_16x16x32_bf16 v[44:47], v[48:51], v[168:171], v[44:47]
    v_mfma_f32_16x16x32_bf16 v[20:23], v[48:51], v[200:203], v[20:23]
    v_and_b32_dpp v48, v9, v4 quad_perm:[1,1,1,1] row_mask:0xf bank_mask:0xf
    v_and_b32_dpp v49, v9, v5 quad_perm:[1,1,1,1] row_mask:0xf bank_mask:0xf
    v_and_b32_dpp v50, v9, v6 quad_perm:[1,1,1,1] row_mask:0xf bank_mask:0xf
    v_and_b32_dpp v51, v9, v7 quad_perm:[1,1,1,1] row_mask:0xf bank_mask:0xf
    s_waitcnt lgkmcnt(5)
    v_mfma_f32_16x16x32_bf16 v[44:47], v[52:55], v[120:123], v[44:47]
    s_waitcnt lgkmcnt(4)
    v_mfma_f32_16x16x32_bf16 v[20:23], v[52:55], v[124:127], v[20:23]
    ds_read_b128 v[120:123], v0 offset:19456
    ds_read_b128 v[124:127], v0 offset:27648
    v_and_b32_dpp v52, v11, v4 quad_perm:[3,3,3,3] row_mask:0xf bank_mask:0xf
    v_and_b32_dpp v53, v11, v5 quad_perm:[3,3,3,3] row_mask:0xf bank_mask:0xf
    v_and_b32_dpp v54, v11, v6 quad_perm:[3,3,3,3] row_mask:0xf bank_mask:0xf
    v_and_b32_dpp v55, v11, v7 quad_perm:[3,3,3,3] row_mask:0xf bank_mask:0xf
    s_waitcnt lgkmcnt(5)
    v_mfma_f32_16x16x32_bf16 v[44:47], v[48:51], v[104:107], v[44:47]
    s_waitcnt lgkmcnt(4)
    v_mfma_f32_16x16x32_bf16 v[20:23], v[48:51], v[108:111], v[20:23]
    ds_read_b128 v[104:107], v0 offset:20480
    ds_read_b128 v[108:111], v0 offset:28672
    v_and_b32_dpp v48, v9, v4 quad_perm:[2,2,2,2] row_mask:0xf bank_mask:0xf
    v_and_b32_dpp v49, v9, v5 quad_perm:[2,2,2,2] row_mask:0xf bank_mask:0xf
    v_and_b32_dpp v50, v9, v6 quad_perm:[2,2,2,2] row_mask:0xf bank_mask:0xf
    v_and_b32_dpp v51, v9, v7 quad_perm:[2,2,2,2] row_mask:0xf bank_mask:0xf
    v_mfma_f32_16x16x32_bf16 v[44:47], v[52:55], v[172:175], v[44:47]
    v_mfma_f32_16x16x32_bf16 v[20:23], v[52:55], v[204:207], v[20:23]
    v_and_b32_dpp v52, v9, v4 quad_perm:[3,3,3,3] row_mask:0xf bank_mask:0xf
    v_and_b32_dpp v53, v9, v5 quad_perm:[3,3,3,3] row_mask:0xf bank_mask:0xf
    v_and_b32_dpp v54, v9, v6 quad_perm:[3,3,3,3] row_mask:0xf bank_mask:0xf
    v_and_b32_dpp v55, v9, v7 quad_perm:[3,3,3,3] row_mask:0xf bank_mask:0xf
    s_waitcnt lgkmcnt(5)
    v_mfma_f32_16x16x32_bf16 v[44:47], v[48:51], v[112:115], v[44:47]
    s_waitcnt lgkmcnt(4)
    v_mfma_f32_16x16x32_bf16 v[20:23], v[48:51], v[116:119], v[20:23]
    ds_read_b128 v[112:115], v0 offset:21504
    ds_read_b128 v[116:119], v0 offset:29696
    v_and_b32_dpp v48, v14, v4 quad_perm:[0,0,0,0] row_mask:0xf bank_mask:0xf
    v_and_b32_dpp v49, v14, v5 quad_perm:[0,0,0,0] row_mask:0xf bank_mask:0xf
    v_and_b32_dpp v50, v14, v6 quad_perm:[0,0,0,0] row_mask:0xf bank_mask:0xf
    v_and_b32_dpp v51, v14, v7 quad_perm:[0,0,0,0] row_mask:0xf bank_mask:0xf
    s_waitcnt lgkmcnt(5)
    v_mfma_f32_16x16x32_bf16 v[44:47], v[52:55], v[120:123], v[44:47]
    s_waitcnt lgkmcnt(4)
    v_mfma_f32_16x16x32_bf16 v[20:23], v[52:55], v[124:127], v[20:23]
    ds_read_b128 v[120:123], v0 offset:22528
    ds_read_b128 v[124:127], v0 offset:30720
    s_waitcnt vmcnt(11)
    s_add_u32 m0, s68, 7168
    s_nop 0
    buffer_load_dwordx4 v3, s[20:23], s31 offen offset:2048 nt lds
    v_and_b32_dpp v52, v16, v4 quad_perm:[0,0,0,0] row_mask:0xf bank_mask:0xf
    v_and_b32_dpp v53, v16, v5 quad_perm:[0,0,0,0] row_mask:0xf bank_mask:0xf
    v_and_b32_dpp v54, v16, v6 quad_perm:[0,0,0,0] row_mask:0xf bank_mask:0xf
    v_and_b32_dpp v55, v16, v7 quad_perm:[0,0,0,0] row_mask:0xf bank_mask:0xf
    s_waitcnt lgkmcnt(5)
    v_mfma_f32_16x16x32_bf16 v[44:47], v[48:51], v[104:107], v[44:47]
    s_waitcnt lgkmcnt(4)
    v_mfma_f32_16x16x32_bf16 v[20:23], v[48:51], v[108:111], v[20:23]
    ds_read_b128 v[104:107], v0 offset:23552
    ds_read_b128 v[108:111], v0 offset:31744
    v_and_b32_dpp v48, v14, v4 quad_perm:[1,1,1,1] row_mask:0xf bank_mask:0xf
    v_and_b32_dpp v49, v14, v5 quad_perm:[1,1,1,1] row_mask:0xf bank_mask:0xf
    v_and_b32_dpp v50, v14, v6 quad_perm:[1,1,1,1] row_mask:0xf bank_mask:0xf
    v_and_b32_dpp v51, v14, v7 quad_perm:[1,1,1,1] row_mask:0xf bank_mask:0xf
    v_mfma_f32_16x16x32_bf16 v[44:47], v[52:55], v[176:179], v[44:47]
    v_mfma_f32_16x16x32_bf16 v[20:23], v[52:55], v[208:211], v[20:23]
    v_and_b32_dpp v52, v14, v4 quad_perm:[2,2,2,2] row_mask:0xf bank_mask:0xf
    v_and_b32_dpp v53, v14, v5 quad_perm:[2,2,2,2] row_mask:0xf bank_mask:0xf
    v_and_b32_dpp v54, v14, v6 quad_perm:[2,2,2,2] row_mask:0xf bank_mask:0xf
    v_and_b32_dpp v55, v14, v7 quad_perm:[2,2,2,2] row_mask:0xf bank_mask:0xf
    s_waitcnt lgkmcnt(5)
    v_mfma_f32_16x16x32_bf16 v[44:47], v[48:51], v[112:115], v[44:47]
    s_waitcnt lgkmcnt(4)
    v_mfma_f32_16x16x32_bf16 v[20:23], v[48:51], v[116:119], v[20:23]
    ds_read_b128 v[112:115], v0 offset:32768
    ds_read_b128 v[116:119], v0 offset:33792
    v_and_b32_dpp v48, v14, v4 quad_perm:[3,3,3,3] row_mask:0xf bank_mask:0xf
    v_and_b32_dpp v49, v14, v5 quad_perm:[3,3,3,3] row_mask:0xf bank_mask:0xf
    v_and_b32_dpp v50, v14, v6 quad_perm:[3,3,3,3] row_mask:0xf bank_mask:0xf
    v_and_b32_dpp v51, v14, v7 quad_perm:[3,3,3,3] row_mask:0xf bank_mask:0xf
    s_waitcnt lgkmcnt(5)
    v_mfma_f32_16x16x32_bf16 v[44:47], v[52:55], v[120:123], v[44:47]
    s_waitcnt lgkmcnt(4)
    v_mfma_f32_16x16x32_bf16 v[20:23], v[52:55], v[124:127], v[20:23]
    ds_read_b128 v[120:123], v0 offset:34816
    ds_read_b128 v[124:127], v0 offset:35840
    v_and_b32_dpp v52, v16, v4 quad_perm:[1,1,1,1] row_mask:0xf bank_mask:0xf
    v_and_b32_dpp v53, v16, v5 quad_perm:[1,1,1,1] row_mask:0xf bank_mask:0xf
    v_and_b32_dpp v54, v16, v6 quad_perm:[1,1,1,1] row_mask:0xf bank_mask:0xf
    v_and_b32_dpp v55, v16, v7 quad_perm:[1,1,1,1] row_mask:0xf bank_mask:0xf
    s_waitcnt lgkmcnt(5)
    v_mfma_f32_16x16x32_bf16 v[44:47], v[48:51], v[104:107], v[44:47]
    s_waitcnt lgkmcnt(4)
    v_mfma_f32_16x16x32_bf16 v[20:23], v[48:51], v[108:111], v[20:23]
    ds_read_b128 v[104:107], v0 offset:36864
    ds_read_b128 v[108:111], v0 offset:37888
    v_and_b32_dpp v48, v10, v4 quad_perm:[0,0,0,0] row_mask:0xf bank_mask:0xf
    v_and_b32_dpp v49, v10, v5 quad_perm:[0,0,0,0] row_mask:0xf bank_mask:0xf
    v_and_b32_dpp v50, v10, v6 quad_perm:[0,0,0,0] row_mask:0xf bank_mask:0xf
    v_and_b32_dpp v51, v10, v7 quad_perm:[0,0,0,0] row_mask:0xf bank_mask:0xf
    v_mfma_f32_16x16x32_bf16 v[44:47], v[52:55], v[180:183], v[44:47]
    v_mfma_f32_16x16x32_bf16 v[20:23], v[52:55], v[212:215], v[20:23]
    v_and_b32_dpp v52, v10, v4 quad_perm:[1,1,1,1] row_mask:0xf bank_mask:0xf
    v_and_b32_dpp v53, v10, v5 quad_perm:[1,1,1,1] row_mask:0xf bank_mask:0xf
    v_and_b32_dpp v54, v10, v6 quad_perm:[1,1,1,1] row_mask:0xf bank_mask:0xf
    v_and_b32_dpp v55, v10, v7 quad_perm:[1,1,1,1] row_mask:0xf bank_mask:0xf
    s_waitcnt lgkmcnt(5)
    v_mfma_f32_16x16x32_bf16 v[44:47], v[48:51], v[112:115], v[44:47]
    v_mfma_f32_16x16x32_bf16 v[20:23], v[48:51], v[128:131], v[20:23]
    ds_read_b128 v[112:115], v0 offset:38912
    v_and_b32_dpp v48, v16, v4 quad_perm:[2,2,2,2] row_mask:0xf bank_mask:0xf
    v_and_b32_dpp v49, v16, v5 quad_perm:[2,2,2,2] row_mask:0xf bank_mask:0xf
    v_and_b32_dpp v50, v16, v6 quad_perm:[2,2,2,2] row_mask:0xf bank_mask:0xf
    v_and_b32_dpp v51, v16, v7 quad_perm:[2,2,2,2] row_mask:0xf bank_mask:0xf
    s_waitcnt lgkmcnt(5)
    v_mfma_f32_16x16x32_bf16 v[44:47], v[52:55], v[116:119], v[44:47]
    v_mfma_f32_16x16x32_bf16 v[20:23], v[52:55], v[132:135], v[20:23]
    ds_read_b128 v[116:119], v0 offset:39936
    v_and_b32_dpp v52, v10, v4 quad_perm:[2,2,2,2] row_mask:0xf bank_mask:0xf
    v_and_b32_dpp v53, v10, v5 quad_perm:[2,2,2,2] row_mask:0xf bank_mask:0xf
    v_and_b32_dpp v54, v10, v6 quad_perm:[2,2,2,2] row_mask:0xf bank_mask:0xf
    v_and_b32_dpp v55, v10, v7 quad_perm:[2,2,2,2] row_mask:0xf bank_mask:0xf
    v_mfma_f32_16x16x32_bf16 v[44:47], v[48:51], v[184:187], v[44:47]
    v_mfma_f32_16x16x32_bf16 v[20:23], v[48:51], v[216:219], v[20:23]
    s_waitcnt vmcnt(11)
    s_add_u32 m0, s68, 7168
    s_nop 0
    buffer_load_dwordx4 v3, s[20:23], s31 offen offset:3072 nt lds
    v_and_b32_dpp v48, v10, v4 quad_perm:[3,3,3,3] row_mask:0xf bank_mask:0xf
    v_and_b32_dpp v49, v10, v5 quad_perm:[3,3,3,3] row_mask:0xf bank_mask:0xf
    v_and_b32_dpp v50, v10, v6 quad_perm:[3,3,3,3] row_mask:0xf bank_mask:0xf
    v_and_b32_dpp v51, v10, v7 quad_perm:[3,3,3,3] row_mask:0xf bank_mask:0xf
    s_waitcnt lgkmcnt(5)
    v_mfma_f32_16x16x32_bf16 v[44:47], v[52:55], v[120:123], v[44:47]
    v_mfma_f32_16x16x32_bf16 v[20:23], v[52:55], v[136:139], v[20:23]
    v_and_b32_dpp v52, v15, v4 quad_perm:[0,0,0,0] row_mask:0xf bank_mask:0xf
    v_and_b32_dpp v53, v15, v5 quad_perm:[0,0,0,0] row_mask:0xf bank_mask:0xf
    v_and_b32_dpp v54, v15, v6 quad_perm:[0,0,0,0] row_mask:0xf bank_mask:0xf
    v_and_b32_dpp v55, v15, v7 quad_perm:[0,0,0,0] row_mask:0xf bank_mask:0xf
    s_waitcnt lgkmcnt(4)
    v_mfma_f32_16x16x32_bf16 v[44:47], v[48:51], v[124:127], v[44:47]
    v_mfma_f32_16x16x32_bf16 v[20:23], v[48:51], v[140:143], v[20:23]
    v_and_b32_dpp v48, v16, v4 quad_perm:[3,3,3,3] row_mask:0xf bank_mask:0xf
    v_and_b32_dpp v49, v16, v5 quad_perm:[3,3,3,3] row_mask:0xf bank_mask:0xf
    v_and_b32_dpp v50, v16, v6 quad_perm:[3,3,3,3] row_mask:0xf bank_mask:0xf
    v_and_b32_dpp v51, v16, v7 quad_perm:[3,3,3,3] row_mask:0xf bank_mask:0xf
    s_waitcnt lgkmcnt(3)
    v_mfma_f32_16x16x32_bf16 v[44:47], v[52:55], v[104:107], v[44:47]
    v_mfma_f32_16x16x32_bf16 v[20:23], v[52:55], v[144:147], v[20:23]
    v_and_b32_dpp v52, v15, v4 quad_perm:[1,1,1,1] row_mask:0xf bank_mask:0xf
    v_and_b32_dpp v53, v15, v5 quad_perm:[1,1,1,1] row_mask:0xf bank_mask:0xf
    v_and_b32_dpp v54, v15, v6 quad_perm:[1,1,1,1] row_mask:0xf bank_mask:0xf
    v_and_b32_dpp v55, v15, v7 quad_perm:[1,1,1,1] row_mask:0xf bank_mask:0xf
    v_mfma_f32_16x16x32_bf16 v[44:47], v[48:51], v[188:191], v[44:47]
    v_mfma_f32_16x16x32_bf16 v[20:23], v[48:51], v[220:223], v[20:23]
    v_and_b32_dpp v48, v15, v4 quad_perm:[2,2,2,2] row_mask:0xf bank_mask:0xf
    v_and_b32_dpp v49, v15, v5 quad_perm:[2,2,2,2] row_mask:0xf bank_mask:0xf
    v_and_b32_dpp v50, v15, v6 quad_perm:[2,2,2,2] row_mask:0xf bank_mask:0xf
    v_and_b32_dpp v51, v15, v7 quad_perm:[2,2,2,2] row_mask:0xf bank_mask:0xf
    s_waitcnt lgkmcnt(2)
    v_mfma_f32_16x16x32_bf16 v[44:47], v[52:55], v[108:111], v[44:47]
    v_mfma_f32_16x16x32_bf16 v[20:23], v[52:55], v[148:151], v[20:23]
    v_and_b32_dpp v52, v15, v4 quad_perm:[3,3,3,3] row_mask:0xf bank_mask:0xf
    v_and_b32_dpp v53, v15, v5 quad_perm:[3,3,3,3] row_mask:0xf bank_mask:0xf
    v_and_b32_dpp v54, v15, v6 quad_perm:[3,3,3,3] row_mask:0xf bank_mask:0xf
    v_and_b32_dpp v55, v15, v7 quad_perm:[3,3,3,3] row_mask:0xf bank_mask:0xf
    s_waitcnt lgkmcnt(1)
    v_mfma_f32_16x16x32_bf16 v[44:47], v[48:51], v[112:115], v[44:47]
    v_mfma_f32_16x16x32_bf16 v[20:23], v[48:51], v[152:155], v[20:23]
    v_and_b32_dpp v48, v12, v4 quad_perm:[0,0,0,0] row_mask:0xf bank_mask:0xf
    v_and_b32_dpp v49, v12, v5 quad_perm:[0,0,0,0] row_mask:0xf bank_mask:0xf
    v_and_b32_dpp v50, v12, v6 quad_perm:[0,0,0,0] row_mask:0xf bank_mask:0xf
    v_and_b32_dpp v51, v12, v7 quad_perm:[0,0,0,0] row_mask:0xf bank_mask:0xf
    s_waitcnt lgkmcnt(0)
    v_mfma_f32_16x16x32_bf16 v[44:47], v[52:55], v[116:119], v[44:47]
    v_mfma_f32_16x16x32_bf16 v[20:23], v[52:55], v[156:159], v[20:23]
    v_and_b32_dpp v52, v12, v4 quad_perm:[1,1,1,1] row_mask:0xf bank_mask:0xf
    v_and_b32_dpp v53, v12, v5 quad_perm:[1,1,1,1] row_mask:0xf bank_mask:0xf
    v_and_b32_dpp v54, v12, v6 quad_perm:[1,1,1,1] row_mask:0xf bank_mask:0xf
    v_and_b32_dpp v55, v12, v7 quad_perm:[1,1,1,1] row_mask:0xf bank_mask:0xf
    v_mfma_f32_16x16x32_bf16 v[44:47], v[48:51], v[224:227], v[44:47]
    v_mfma_f32_16x16x32_bf16 v[20:23], v[48:51], a[32:35], v[20:23]
    v_and_b32_dpp v48, v12, v4 quad_perm:[2,2,2,2] row_mask:0xf bank_mask:0xf
    v_and_b32_dpp v49, v12, v5 quad_perm:[2,2,2,2] row_mask:0xf bank_mask:0xf
    v_and_b32_dpp v50, v12, v6 quad_perm:[2,2,2,2] row_mask:0xf bank_mask:0xf
    v_and_b32_dpp v51, v12, v7 quad_perm:[2,2,2,2] row_mask:0xf bank_mask:0xf
    v_mfma_f32_16x16x32_bf16 v[44:47], v[52:55], v[228:231], v[44:47]
    v_mfma_f32_16x16x32_bf16 v[20:23], v[52:55], a[36:39], v[20:23]
    s_waitcnt vmcnt(11)
    s_add_u32 m0, s68, 0
    s_nop 0
    buffer_load_dwordx4 v2, s[20:23], s32 offen offset:0 nt lds
    v_and_b32_dpp v52, v12, v4 quad_perm:[3,3,3,3] row_mask:0xf bank_mask:0xf
    v_and_b32_dpp v53, v12, v5 quad_perm:[3,3,3,3] row_mask:0xf bank_mask:0xf
    v_and_b32_dpp v54, v12, v6 quad_perm:[3,3,3,3] row_mask:0xf bank_mask:0xf
    v_and_b32_dpp v55, v12, v7 quad_perm:[3,3,3,3] row_mask:0xf bank_mask:0xf
    v_mfma_f32_16x16x32_bf16 v[44:47], v[48:51], v[232:235], v[44:47]
    v_mfma_f32_16x16x32_bf16 v[20:23], v[48:51], a[40:43], v[20:23]
    v_and_b32_dpp v48, v17, v4 quad_perm:[0,0,0,0] row_mask:0xf bank_mask:0xf
    v_and_b32_dpp v49, v17, v5 quad_perm:[0,0,0,0] row_mask:0xf bank_mask:0xf
    v_and_b32_dpp v50, v17, v6 quad_perm:[0,0,0,0] row_mask:0xf bank_mask:0xf
    v_and_b32_dpp v51, v17, v7 quad_perm:[0,0,0,0] row_mask:0xf bank_mask:0xf
    v_mfma_f32_16x16x32_bf16 v[44:47], v[52:55], v[236:239], v[44:47]
    v_mfma_f32_16x16x32_bf16 v[20:23], v[52:55], a[44:47], v[20:23]
    v_and_b32_dpp v52, v17, v4 quad_perm:[1,1,1,1] row_mask:0xf bank_mask:0xf
    v_and_b32_dpp v53, v17, v5 quad_perm:[1,1,1,1] row_mask:0xf bank_mask:0xf
    v_and_b32_dpp v54, v17, v6 quad_perm:[1,1,1,1] row_mask:0xf bank_mask:0xf
    v_and_b32_dpp v55, v17, v7 quad_perm:[1,1,1,1] row_mask:0xf bank_mask:0xf
    v_mfma_f32_16x16x32_bf16 v[44:47], v[48:51], v[240:243], v[44:47]
    v_mfma_f32_16x16x32_bf16 v[20:23], v[48:51], a[48:51], v[20:23]
    v_and_b32_dpp v48, v17, v4 quad_perm:[2,2,2,2] row_mask:0xf bank_mask:0xf
    v_and_b32_dpp v49, v17, v5 quad_perm:[2,2,2,2] row_mask:0xf bank_mask:0xf
    v_and_b32_dpp v50, v17, v6 quad_perm:[2,2,2,2] row_mask:0xf bank_mask:0xf
    v_and_b32_dpp v51, v17, v7 quad_perm:[2,2,2,2] row_mask:0xf bank_mask:0xf
    v_mfma_f32_16x16x32_bf16 v[44:47], v[52:55], v[244:247], v[44:47]
    s_waitcnt vmcnt(11)
    v_mfma_f32_16x16x32_bf16 v[20:23], v[52:55], a[52:55], v[20:23]
    s_add_u32 m0, s68, 0
    s_nop 0
    buffer_load_dwordx4 v2, s[20:23], s32 offen offset:1024 nt lds
    v_and_b32_dpp v52, v17, v4 quad_perm:[3,3,3,3] row_mask:0xf bank_mask:0xf
    v_and_b32_dpp v53, v17, v5 quad_perm:[3,3,3,3] row_mask:0xf bank_mask:0xf
    v_and_b32_dpp v54, v17, v6 quad_perm:[3,3,3,3] row_mask:0xf bank_mask:0xf
    v_and_b32_dpp v55, v17, v7 quad_perm:[3,3,3,3] row_mask:0xf bank_mask:0xf
    v_mfma_f32_16x16x32_bf16 v[44:47], v[48:51], v[248:251], v[44:47]
    s_waitcnt vmcnt(11)
    v_mfma_f32_16x16x32_bf16 v[20:23], v[48:51], a[56:59], v[20:23]
    s_add_u32 m0, s68, 0
    s_nop 0
    buffer_load_dwordx4 v2, s[20:23], s32 offen offset:2048 nt lds
    v_mfma_f32_16x16x32_bf16 v[44:47], v[52:55], v[252:255], v[44:47]
    s_waitcnt vmcnt(11)
    v_mfma_f32_16x16x32_bf16 v[20:23], v[52:55], a[60:63], v[20:23]
    s_add_u32 m0, s68, 0
    s_nop 0
    buffer_load_dwordx4 v2, s[20:23], s32 offen offset:3072 nt lds
    s_nop 4
    v_mov_b32 v48, v20
    v_mov_b32 v49, v21
    v_mov_b32 v50, v22
    v_mov_b32 v51, v23
    v_permlane32_swap_b32 v48, v20
    v_permlane32_swap_b32 v49, v21
    v_permlane32_swap_b32 v50, v22
    v_permlane32_swap_b32 v51, v23
    v_add_f32 v44, v44, v20
    v_add_f32 v45, v45, v21
    v_add_f32 v46, v46, v22
    v_add_f32 v47, v47, v23
    v_add_f32_dpp v35, v35, v35 quad_perm:[1,0,3,2] row_mask:0xf bank_mask:0xf
    s_nop 1
    v_add_f32_dpp v35, v35, v35 quad_perm:[2,3,0,1] row_mask:0xf bank_mask:0xf
    s_nop 1
    v_add_f32_dpp v35, v35, v35 row_ror:4 row_mask:0xf bank_mask:0xf
    s_nop 1
    v_add_f32_dpp v35, v35, v35 row_ror:8 row_mask:0xf bank_mask:0xf
    v_mov_b32 v48, v35
    s_nop 1
    v_permlane16_swap_b32 v35, v48
    v_add_f32 v35, v35, v48
    v_mov_b32 v48, v35
    s_nop 1
    v_permlane32_swap_b32 v35, v48
    v_add_f32 v35, v35, v48
    v_log_f32 v50, v35
    v_rcp_f32 v35, v35
    v_and_b32 v48, 0xf0, v2
    v_lshlrev_b32 v48, 1, v48
    v_lshrrev_b32 v49, 8, v2
    v_lshlrev_b32 v49, 4, v49
    v_add_u32 v48, v48, v49
    s_add_u32 s74, s69, 917504
    s_mov_b32 s82, 0x7060500
    s_mov_b32 s83, 0x7060501
    s_mov_b32 s84, 0x7060502
    s_mov_b32 s85, 0x7060503
    v_mul_f32 v50, 0x3f317218, v50
    v_add_f32 v50, v50, v34
    v_mul_f32 v44, v44, v35
    v_mul_f32 v45, v45, v35
    v_mul_f32 v46, v46, v35
    v_mul_f32 v47, v47, v35
    v_perm_b32 v44, v44, v50, s82
    v_perm_b32 v45, v45, v50, s83
    v_perm_b32 v46, v46, v50, s84
    v_perm_b32 v47, v47, v50, s85
    s_mov_b32 exec_lo, 0xffffffff
    s_mov_b32 exec_hi, 0x0
    buffer_store_dwordx4 v[44:47], v48, s[24:27], s74 offen sc1
    s_mov_b64 exec, -1
    s_waitcnt vmcnt(11)
    v_and_b32_dpp v48, v30, v4 row_newbcast:8 row_mask:0xf bank_mask:0xf
    v_and_b32_dpp v49, v30, v5 row_newbcast:8 row_mask:0xf bank_mask:0xf
    v_and_b32_dpp v50, v30, v6 row_newbcast:8 row_mask:0xf bank_mask:0xf
    v_and_b32_dpp v51, v30, v7 row_newbcast:8 row_mask:0xf bank_mask:0xf
    s_waitcnt vmcnt(10)
    v_and_b32_dpp v52, v30, v4 row_newbcast:9 row_mask:0xf bank_mask:0xf
    v_and_b32_dpp v53, v30, v5 row_newbcast:9 row_mask:0xf bank_mask:0xf
    v_and_b32_dpp v54, v30, v6 row_newbcast:9 row_mask:0xf bank_mask:0xf
    v_and_b32_dpp v55, v30, v7 row_newbcast:9 row_mask:0xf bank_mask:0xf
    v_mfma_f32_16x16x32_bf16 v[40:43], v[48:51], a[64:67], v[40:43]
    s_add_u32 m0, s68, 11264
    s_nop 0
    buffer_load_dwordx4 v3, s[20:23], s32 offen offset:0 nt lds
    s_add_u32 m0, s68, 3072
    s_nop 0
    buffer_load_dwordx4 v3, s[20:23], s32 offen offset:1024 nt lds
    s_waitcnt vmcnt(11)
    v_and_b32_dpp v48, v30, v4 row_newbcast:10 row_mask:0xf bank_mask:0xf
    v_and_b32_dpp v49, v30, v5 row_newbcast:10 row_mask:0xf bank_mask:0xf
    v_and_b32_dpp v50, v30, v6 row_newbcast:10 row_mask:0xf bank_mask:0xf
    v_and_b32_dpp v51, v30, v7 row_newbcast:10 row_mask:0xf bank_mask:0xf
    v_mfma_f32_16x16x32_bf16 v[40:43], v[52:55], a[68:71], v[40:43]
    s_add_u32 m0, s68, 10240
    s_nop 0
    buffer_load_dwordx4 v3, s[20:23], s32 offen offset:2048 nt lds
    s_waitcnt vmcnt(11)
    v_and_b32_dpp v52, v30, v4 row_newbcast:11 row_mask:0xf bank_mask:0xf
    v_and_b32_dpp v53, v30, v5 row_newbcast:11 row_mask:0xf bank_mask:0xf
    v_and_b32_dpp v54, v30, v6 row_newbcast:11 row_mask:0xf bank_mask:0xf
    v_and_b32_dpp v55, v30, v7 row_newbcast:11 row_mask:0xf bank_mask:0xf
    v_mfma_f32_16x16x32_bf16 v[40:43], v[48:51], a[72:75], v[40:43]
    s_add_u32 m0, s68, 2048
    s_nop 0
    buffer_load_dwordx4 v3, s[20:23], s32 offen offset:3072 nt lds
    s_waitcnt vmcnt(11)
    v_and_b32_dpp v48, v30, v4 row_newbcast:12 row_mask:0xf bank_mask:0xf
    v_and_b32_dpp v49, v30, v5 row_newbcast:12 row_mask:0xf bank_mask:0xf
    v_and_b32_dpp v50, v30, v6 row_newbcast:12 row_mask:0xf bank_mask:0xf
    v_and_b32_dpp v51, v30, v7 row_newbcast:12 row_mask:0xf bank_mask:0xf
    v_mfma_f32_16x16x32_bf16 v[40:43], v[52:55], a[76:79], v[40:43]
    s_add_u32 m0, s68, 13312
    s_nop 0
    buffer_load_dwordx4 v2, s[20:23], s33 offen offset:0 nt lds
    s_waitcnt vmcnt(11)
    ds_read_b128 v[60:63], v0 offset:8192
    v_and_b32_dpp v52, v30, v4 row_newbcast:13 row_mask:0xf bank_mask:0xf
    v_and_b32_dpp v53, v30, v5 row_newbcast:13 row_mask:0xf bank_mask:0xf
    v_and_b32_dpp v54, v30, v6 row_newbcast:13 row_mask:0xf bank_mask:0xf
    v_and_b32_dpp v55, v30, v7 row_newbcast:13 row_mask:0xf bank_mask:0xf
    v_mfma_f32_16x16x32_bf16 v[40:43], v[48:51], a[80:83], v[40:43]
    s_add_u32 m0, s68, 5120
    s_nop 0
    buffer_load_dwordx4 v2, s[20:23], s33 offen offset:1024 nt lds
    s_waitcnt vmcnt(11)
    ds_read_b128 v[56:59], v0 offset:9216
    v_and_b32_dpp v48, v30, v4 row_newbcast:14 row_mask:0xf bank_mask:0xf
    v_and_b32_dpp v49, v30, v5 row_newbcast:14 row_mask:0xf bank_mask:0xf
    v_and_b32_dpp v50, v30, v6 row_newbcast:14 row_mask:0xf bank_mask:0xf
    v_and_b32_dpp v51, v30, v7 row_newbcast:14 row_mask:0xf bank_mask:0xf
    s_waitcnt lgkmcnt(1)
    v_mfma_f32_16x16x32_bf16 v[40:43], v[52:55], v[60:63], v[40:43]
    s_add_u32 m0, s68, 12288
    s_nop 0
    buffer_load_dwordx4 v2, s[20:23], s33 offen offset:2048 nt lds
    s_waitcnt vmcnt(11)
    ds_read_b128 v[60:63], v0 offset:10240
    v_and_b32_dpp v52, v30, v4 row_newbcast:15 row_mask:0xf bank_mask:0xf
    v_and_b32_dpp v53, v30, v5 row_newbcast:15 row_mask:0xf bank_mask:0xf
    v_and_b32_dpp v54, v30, v6 row_newbcast:15 row_mask:0xf bank_mask:0xf
    v_and_b32_dpp v55, v30, v7 row_newbcast:15 row_mask:0xf bank_mask:0xf
    s_waitcnt lgkmcnt(1)
    v_mfma_f32_16x16x32_bf16 v[40:43], v[48:51], v[56:59], v[40:43]
    s_add_u32 m0, s68, 4096
    s_nop 0
    buffer_load_dwordx4 v2, s[20:23], s33 offen offset:3072 nt lds
    s_waitcnt vmcnt(11)
    ds_read_b128 v[56:59], v0 offset:0
    v_and_b32_dpp v48, v31, v4 row_newbcast:0 row_mask:0xf bank_mask:0xf
    v_and_b32_dpp v49, v31, v5 row_newbcast:0 row_mask:0xf bank_mask:0xf
    v_and_b32_dpp v50, v31, v6 row_newbcast:0 row_mask:0xf bank_mask:0xf
    v_and_b32_dpp v51, v31, v7 row_newbcast:0 row_mask:0xf bank_mask:0xf
    s_waitcnt lgkmcnt(1)
    v_mfma_f32_16x16x32_bf16 v[40:43], v[52:55], v[60:63], v[40:43]
    s_add_u32 m0, s68, 15360
    s_nop 0
    buffer_load_dwordx4 v3, s[20:23], s33 offen offset:0 nt lds
    s_waitcnt vmcnt(11)
    ds_read_b128 v[60:63], v0 offset:1024
    v_and_b32_dpp v52, v31, v4 row_newbcast:1 row_mask:0xf bank_mask:0xf
    v_and_b32_dpp v53, v31, v5 row_newbcast:1 row_mask:0xf bank_mask:0xf
    v_and_b32_dpp v54, v31, v6 row_newbcast:1 row_mask:0xf bank_mask:0xf
    v_and_b32_dpp v55, v31, v7 row_newbcast:1 row_mask:0xf bank_mask:0xf
    s_waitcnt lgkmcnt(1)
    v_mfma_f32_16x16x32_bf16 v[40:43], v[48:51], v[56:59], v[40:43]
    s_add_u32 m0, s68, 15360
    s_nop 0
    buffer_load_dwordx4 v3, s[20:23], s33 offen offset:1024 nt lds
    s_waitcnt vmcnt(11)
    ds_read_b128 v[56:59], v0 offset:2048
    v_and_b32_dpp v48, v31, v4 row_newbcast:2 row_mask:0xf bank_mask:0xf
    v_and_b32_dpp v49, v31, v5 row_newbcast:2 row_mask:0xf bank_mask:0xf
    v_and_b32_dpp v50, v31, v6 row_newbcast:2 row_mask:0xf bank_mask:0xf
    v_and_b32_dpp v51, v31, v7 row_newbcast:2 row_mask:0xf bank_mask:0xf
    s_waitcnt lgkmcnt(1)
    v_mfma_f32_16x16x32_bf16 v[40:43], v[52:55], v[60:63], v[40:43]
    s_add_u32 m0, s68, 22528
    s_nop 0
    buffer_load_dwordx4 v3, s[20:23], s33 offen offset:2048 nt lds
    s_waitcnt vmcnt(11)
    ds_read_b128 v[60:63], v0 offset:3072
    v_and_b32_dpp v52, v31, v4 row_newbcast:3 row_mask:0xf bank_mask:0xf
    v_and_b32_dpp v53, v31, v5 row_newbcast:3 row_mask:0xf bank_mask:0xf
    v_and_b32_dpp v54, v31, v6 row_newbcast:3 row_mask:0xf bank_mask:0xf
    v_and_b32_dpp v55, v31, v7 row_newbcast:3 row_mask:0xf bank_mask:0xf
    s_waitcnt lgkmcnt(1)
    v_mfma_f32_16x16x32_bf16 v[40:43], v[48:51], v[56:59], v[40:43]
    s_add_u32 m0, s68, 14336
    s_nop 0
    buffer_load_dwordx4 v3, s[20:23], s33 offen offset:3072 nt lds
    s_waitcnt vmcnt(11)
    ds_read_b128 v[56:59], v0 offset:11264
    v_and_b32_dpp v48, v31, v4 row_newbcast:4 row_mask:0xf bank_mask:0xf
    v_and_b32_dpp v49, v31, v5 row_newbcast:4 row_mask:0xf bank_mask:0xf
    v_and_b32_dpp v50, v31, v6 row_newbcast:4 row_mask:0xf bank_mask:0xf
    v_and_b32_dpp v51, v31, v7 row_newbcast:4 row_mask:0xf bank_mask:0xf
    s_waitcnt lgkmcnt(1)
    v_mfma_f32_16x16x32_bf16 v[40:43], v[52:55], v[60:63], v[40:43]
    s_add_u32 m0, s68, 25600
    s_nop 0
    buffer_load_dwordx4 v2, s[20:23], s34 offen offset:0 nt lds
    s_waitcnt vmcnt(11)
    ds_read_b128 v[60:63], v0 offset:4096
    v_and_b32_dpp v52, v31, v4 row_newbcast:5 row_mask:0xf bank_mask:0xf
    v_and_b32_dpp v53, v31, v5 row_newbcast:5 row_mask:0xf bank_mask:0xf
    v_and_b32_dpp v54, v31, v6 row_newbcast:5 row_mask:0xf bank_mask:0xf
    v_and_b32_dpp v55, v31, v7 row_newbcast:5 row_mask:0xf bank_mask:0xf
    s_waitcnt lgkmcnt(1)
    v_mfma_f32_16x16x32_bf16 v[40:43], v[48:51], v[56:59], v[40:43]
    s_add_u32 m0, s68, 17408
    s_nop 0
    buffer_load_dwordx4 v2, s[20:23], s34 offen offset:1024 nt lds
    s_waitcnt vmcnt(11)
    ds_read_b128 v[56:59], v0 offset:12288
    v_and_b32_dpp v48, v31, v4 row_newbcast:6 row_mask:0xf bank_mask:0xf
    v_and_b32_dpp v49, v31, v5 row_newbcast:6 row_mask:0xf bank_mask:0xf
    v_and_b32_dpp v50, v31, v6 row_newbcast:6 row_mask:0xf bank_mask:0xf
    v_and_b32_dpp v51, v31, v7 row_newbcast:6 row_mask:0xf bank_mask:0xf
    s_waitcnt lgkmcnt(1)
    v_mfma_f32_16x16x32_bf16 v[40:43], v[52:55], v[60:63], v[40:43]
    s_add_u32 m0, s68, 24576
    s_nop 0
    buffer_load_dwordx4 v2, s[20:23], s34 offen offset:2048 nt lds
    s_waitcnt vmcnt(11)
    ds_read_b128 v[60:63], v0 offset:5120
    v_and_b32_dpp v52, v31, v4 row_newbcast:7 row_mask:0xf bank_mask:0xf
    v_and_b32_dpp v53, v31, v5 row_newbcast:7 row_mask:0xf bank_mask:0xf
    v_and_b32_dpp v54, v31, v6 row_newbcast:7 row_mask:0xf bank_mask:0xf
    v_and_b32_dpp v55, v31, v7 row_newbcast:7 row_mask:0xf bank_mask:0xf
    s_waitcnt lgkmcnt(1)
    v_mfma_f32_16x16x32_bf16 v[40:43], v[48:51], v[56:59], v[40:43]
    s_add_u32 m0, s68, 16384
    s_nop 0
    buffer_load_dwordx4 v2, s[20:23], s34 offen offset:3072 nt lds
    s_waitcnt vmcnt(11)
    ds_read_b128 v[56:59], v0 offset:13312
    v_and_b32_dpp v48, v31, v4 row_newbcast:8 row_mask:0xf bank_mask:0xf
    v_and_b32_dpp v49, v31, v5 row_newbcast:8 row_mask:0xf bank_mask:0xf
    v_and_b32_dpp v50, v31, v6 row_newbcast:8 row_mask:0xf bank_mask:0xf
    v_and_b32_dpp v51, v31, v7 row_newbcast:8 row_mask:0xf bank_mask:0xf
    s_waitcnt lgkmcnt(1)
    v_mfma_f32_16x16x32_bf16 v[40:43], v[52:55], v[60:63], v[40:43]
    s_add_u32 m0, s68, 27648
    s_nop 0
    buffer_load_dwordx4 v3, s[20:23], s34 offen offset:0 nt lds
    s_waitcnt vmcnt(11)
    ds_read_b128 v[60:63], v0 offset:6144
    v_and_b32_dpp v52, v31, v4 row_newbcast:9 row_mask:0xf bank_mask:0xf
    v_and_b32_dpp v53, v31, v5 row_newbcast:9 row_mask:0xf bank_mask:0xf
    v_and_b32_dpp v54, v31, v6 row_newbcast:9 row_mask:0xf bank_mask:0xf
    v_and_b32_dpp v55, v31, v7 row_newbcast:9 row_mask:0xf bank_mask:0xf
    s_waitcnt lgkmcnt(1)
    v_mfma_f32_16x16x32_bf16 v[40:43], v[48:51], v[56:59], v[40:43]
    s_add_u32 m0, s68, 19456
    s_nop 0
    buffer_load_dwordx4 v3, s[20:23], s34 offen offset:1024 nt lds
    s_waitcnt vmcnt(11)
    ds_read_b128 v[56:59], v0 offset:14336
    v_and_b32_dpp v48, v31, v4 row_newbcast:10 row_mask:0xf bank_mask:0xf
    v_and_b32_dpp v49, v31, v5 row_newbcast:10 row_mask:0xf bank_mask:0xf
    v_and_b32_dpp v50, v31, v6 row_newbcast:10 row_mask:0xf bank_mask:0xf
    v_and_b32_dpp v51, v31, v7 row_newbcast:10 row_mask:0xf bank_mask:0xf
    s_waitcnt lgkmcnt(1)
    v_mfma_f32_16x16x32_bf16 v[40:43], v[52:55], v[60:63], v[40:43]
    s_add_u32 m0, s68, 26624
    s_nop 0
    buffer_load_dwordx4 v3, s[20:23], s34 offen offset:2048 nt lds
    s_waitcnt vmcnt(11)
    ds_read_b128 v[60:63], v0 offset:7168
    v_and_b32_dpp v52, v31, v4 row_newbcast:11 row_mask:0xf bank_mask:0xf
    v_and_b32_dpp v53, v31, v5 row_newbcast:11 row_mask:0xf bank_mask:0xf
    v_and_b32_dpp v54, v31, v6 row_newbcast:11 row_mask:0xf bank_mask:0xf
    v_and_b32_dpp v55, v31, v7 row_newbcast:11 row_mask:0xf bank_mask:0xf
    s_waitcnt lgkmcnt(1)
    v_mfma_f32_16x16x32_bf16 v[40:43], v[48:51], v[56:59], v[40:43]
    s_add_u32 m0, s68, 18432
    s_nop 0
    buffer_load_dwordx4 v3, s[20:23], s34 offen offset:3072 nt lds
    s_waitcnt vmcnt(11)
    ds_read_b128 v[56:59], v0 offset:15360
    v_and_b32_dpp v48, v31, v4 row_newbcast:12 row_mask:0xf bank_mask:0xf
    v_and_b32_dpp v49, v31, v5 row_newbcast:12 row_mask:0xf bank_mask:0xf
    v_and_b32_dpp v50, v31, v6 row_newbcast:12 row_mask:0xf bank_mask:0xf
    v_and_b32_dpp v51, v31, v7 row_newbcast:12 row_mask:0xf bank_mask:0xf
    s_waitcnt lgkmcnt(1)
    v_mfma_f32_16x16x32_bf16 v[40:43], v[52:55], v[60:63], v[40:43]
    s_add_u32 m0, s68, 29696
    s_nop 0
    buffer_load_dwordx4 v2, s[20:23], s35 offen offset:0 nt lds
    s_waitcnt vmcnt(11)
    ds_read_b128 v[60:63], v0 offset:16384
    v_and_b32_dpp v52, v31, v4 row_newbcast:13 row_mask:0xf bank_mask:0xf
    v_and_b32_dpp v53, v31, v5 row_newbcast:13 row_mask:0xf bank_mask:0xf
    v_and_b32_dpp v54, v31, v6 row_newbcast:13 row_mask:0xf bank_mask:0xf
    v_and_b32_dpp v55, v31, v7 row_newbcast:13 row_mask:0xf bank_mask:0xf
    s_waitcnt lgkmcnt(1)
    v_mfma_f32_16x16x32_bf16 v[40:43], v[48:51], v[56:59], v[40:43]
    s_add_u32 m0, s68, 21504
    s_nop 0
    buffer_load_dwordx4 v2, s[20:23], s35 offen offset:1024 nt lds
    s_waitcnt vmcnt(11)
    ds_read_b128 v[56:59], v0 offset:24576
    v_and_b32_dpp v48, v31, v4 row_newbcast:14 row_mask:0xf bank_mask:0xf
    v_and_b32_dpp v49, v31, v5 row_newbcast:14 row_mask:0xf bank_mask:0xf
    v_and_b32_dpp v50, v31, v6 row_newbcast:14 row_mask:0xf bank_mask:0xf
    v_and_b32_dpp v51, v31, v7 row_newbcast:14 row_mask:0xf bank_mask:0xf
    s_waitcnt lgkmcnt(1)
    v_mfma_f32_16x16x32_bf16 v[40:43], v[52:55], v[60:63], v[40:43]
    s_add_u32 m0, s68, 28672
    s_nop 0
    buffer_load_dwordx4 v2, s[20:23], s35 offen offset:2048 nt lds
    s_waitcnt vmcnt(11)
    ds_read_b128 v[60:63], v0 offset:17408
    v_and_b32_dpp v52, v31, v4 row_newbcast:15 row_mask:0xf bank_mask:0xf
    v_and_b32_dpp v53, v31, v5 row_newbcast:15 row_mask:0xf bank_mask:0xf
    v_and_b32_dpp v54, v31, v6 row_newbcast:15 row_mask:0xf bank_mask:0xf
    v_and_b32_dpp v55, v31, v7 row_newbcast:15 row_mask:0xf bank_mask:0xf
    s_waitcnt lgkmcnt(1)
    v_mfma_f32_16x16x32_bf16 v[40:43], v[48:51], v[56:59], v[40:43]
    s_add_u32 m0, s68, 20480
    s_nop 0
    buffer_load_dwordx4 v2, s[20:23], s35 offen offset:3072 nt lds
    s_waitcnt vmcnt(11)
    ds_read_b128 v[56:59], v0 offset:25600
    v_and_b32_dpp v48, v32, v4 row_newbcast:0 row_mask:0xf bank_mask:0xf
    v_and_b32_dpp v49, v32, v5 row_newbcast:0 row_mask:0xf bank_mask:0xf
    v_and_b32_dpp v50, v32, v6 row_newbcast:0 row_mask:0xf bank_mask:0xf
    v_and_b32_dpp v51, v32, v7 row_newbcast:0 row_mask:0xf bank_mask:0xf
    s_waitcnt lgkmcnt(1)
    v_mfma_f32_16x16x32_bf16 v[40:43], v[52:55], v[60:63], v[40:43]
    s_add_u32 m0, s68, 31744
    s_nop 0
    buffer_load_dwordx4 v3, s[20:23], s35 offen offset:0 nt lds
    s_waitcnt vmcnt(11)
    ds_read_b128 v[60:63], v0 offset:18432
    v_and_b32_dpp v52, v32, v4 row_newbcast:1 row_mask:0xf bank_mask:0xf
    v_and_b32_dpp v53, v32, v5 row_newbcast:1 row_mask:0xf bank_mask:0xf
    v_and_b32_dpp v54, v32, v6 row_newbcast:1 row_mask:0xf bank_mask:0xf
    v_and_b32_dpp v55, v32, v7 row_newbcast:1 row_mask:0xf bank_mask:0xf
    s_waitcnt lgkmcnt(1)
    v_mfma_f32_16x16x32_bf16 v[40:43], v[48:51], v[56:59], v[40:43]
    s_add_u32 m0, s68, 31744
    s_nop 0
    buffer_load_dwordx4 v3, s[20:23], s35 offen offset:1024 nt lds
    s_waitcnt vmcnt(11)
    ds_read_b128 v[56:59], v0 offset:26624
    v_and_b32_dpp v48, v32, v4 row_newbcast:2 row_mask:0xf bank_mask:0xf
    v_and_b32_dpp v49, v32, v5 row_newbcast:2 row_mask:0xf bank_mask:0xf
    v_and_b32_dpp v50, v32, v6 row_newbcast:2 row_mask:0xf bank_mask:0xf
    v_and_b32_dpp v51, v32, v7 row_newbcast:2 row_mask:0xf bank_mask:0xf
    s_waitcnt lgkmcnt(1)
    v_mfma_f32_16x16x32_bf16 v[40:43], v[52:55], v[60:63], v[40:43]
    s_add_u32 m0, s68, 31744
    s_nop 0
    buffer_load_dwordx4 v3, s[20:23], s35 offen offset:2048 nt lds
    s_waitcnt vmcnt(11)
    ds_read_b128 v[60:63], v0 offset:19456
    v_and_b32_dpp v52, v32, v4 row_newbcast:3 row_mask:0xf bank_mask:0xf
    v_and_b32_dpp v53, v32, v5 row_newbcast:3 row_mask:0xf bank_mask:0xf
    v_and_b32_dpp v54, v32, v6 row_newbcast:3 row_mask:0xf bank_mask:0xf
    v_and_b32_dpp v55, v32, v7 row_newbcast:3 row_mask:0xf bank_mask:0xf
    s_waitcnt lgkmcnt(1)
    v_mfma_f32_16x16x32_bf16 v[40:43], v[48:51], v[56:59], v[40:43]
    s_add_u32 m0, s68, 31744
    s_nop 0
    buffer_load_dwordx4 v3, s[20:23], s35 offen offset:3072 nt lds
    s_waitcnt vmcnt(11)
    ds_read_b128 v[56:59], v0 offset:27648
    v_and_b32_dpp v48, v32, v4 row_newbcast:4 row_mask:0xf bank_mask:0xf
    v_and_b32_dpp v49, v32, v5 row_newbcast:4 row_mask:0xf bank_mask:0xf
    v_and_b32_dpp v50, v32, v6 row_newbcast:4 row_mask:0xf bank_mask:0xf
    v_and_b32_dpp v51, v32, v7 row_newbcast:4 row_mask:0xf bank_mask:0xf
    s_waitcnt lgkmcnt(1)
    v_mfma_f32_16x16x32_bf16 v[40:43], v[52:55], v[60:63], v[40:43]
    s_add_u32 m0, s68, 35840
    s_nop 0
    buffer_load_dwordx4 v2, s[20:23], s36 offen offset:0 nt lds
    s_waitcnt vmcnt(11)
    ds_read_b128 v[60:63], v0 offset:20480
    v_and_b32_dpp v52, v32, v4 row_newbcast:5 row_mask:0xf bank_mask:0xf
    v_and_b32_dpp v53, v32, v5 row_newbcast:5 row_mask:0xf bank_mask:0xf
    v_and_b32_dpp v54, v32, v6 row_newbcast:5 row_mask:0xf bank_mask:0xf
    v_and_b32_dpp v55, v32, v7 row_newbcast:5 row_mask:0xf bank_mask:0xf
    s_waitcnt lgkmcnt(1)
    v_mfma_f32_16x16x32_bf16 v[40:43], v[48:51], v[56:59], v[40:43]
    s_add_u32 m0, s68, 35840
    s_nop 0
    buffer_load_dwordx4 v2, s[20:23], s36 offen offset:1024 nt lds
    s_waitcnt vmcnt(11)
    ds_read_b128 v[56:59], v0 offset:28672
    v_and_b32_dpp v48, v32, v4 row_newbcast:6 row_mask:0xf bank_mask:0xf
    v_and_b32_dpp v49, v32, v5 row_newbcast:6 row_mask:0xf bank_mask:0xf
    v_and_b32_dpp v50, v32, v6 row_newbcast:6 row_mask:0xf bank_mask:0xf
    v_and_b32_dpp v51, v32, v7 row_newbcast:6 row_mask:0xf bank_mask:0xf
    s_waitcnt lgkmcnt(1)
    v_mfma_f32_16x16x32_bf16 v[40:43], v[52:55], v[60:63], v[40:43]
    s_add_u32 m0, s68, 35840
    s_nop 0
    buffer_load_dwordx4 v2, s[20:23], s36 offen offset:2048 nt lds
    s_waitcnt vmcnt(11)
    ds_read_b128 v[60:63], v0 offset:21504
    v_and_b32_dpp v52, v32, v4 row_newbcast:7 row_mask:0xf bank_mask:0xf
    v_and_b32_dpp v53, v32, v5 row_newbcast:7 row_mask:0xf bank_mask:0xf
    v_and_b32_dpp v54, v32, v6 row_newbcast:7 row_mask:0xf bank_mask:0xf
    v_and_b32_dpp v55, v32, v7 row_newbcast:7 row_mask:0xf bank_mask:0xf
    s_waitcnt lgkmcnt(1)
    v_mfma_f32_16x16x32_bf16 v[40:43], v[48:51], v[56:59], v[40:43]
    s_add_u32 m0, s68, 35840
    s_nop 0
    buffer_load_dwordx4 v2, s[20:23], s36 offen offset:3072 nt lds
    s_waitcnt vmcnt(11)
    ds_read_b128 v[56:59], v0 offset:29696
    v_and_b32_dpp v48, v32, v4 row_newbcast:8 row_mask:0xf bank_mask:0xf
    v_and_b32_dpp v49, v32, v5 row_newbcast:8 row_mask:0xf bank_mask:0xf
    v_and_b32_dpp v50, v32, v6 row_newbcast:8 row_mask:0xf bank_mask:0xf
    v_and_b32_dpp v51, v32, v7 row_newbcast:8 row_mask:0xf bank_mask:0xf
    s_waitcnt lgkmcnt(1)
    v_mfma_f32_16x16x32_bf16 v[40:43], v[52:55], v[60:63], v[40:43]
    s_add_u32 m0, s68, 39936
    s_nop 0
    buffer_load_dwordx4 v3, s[20:23], s36 offen offset:0 nt lds
    s_waitcnt vmcnt(11)
    ds_read_b128 v[60:63], v0 offset:22528
    v_and_b32_dpp v52, v32, v4 row_newbcast:9 row_mask:0xf bank_mask:0xf
    v_and_b32_dpp v53, v32, v5 row_newbcast:9 row_mask:0xf bank_mask:0xf
    v_and_b32_dpp v54, v32, v6 row_newbcast:9 row_mask:0xf bank_mask:0xf
    v_and_b32_dpp v55, v32, v7 row_newbcast:9 row_mask:0xf bank_mask:0xf
    s_waitcnt lgkmcnt(1)
    v_mfma_f32_16x16x32_bf16 v[40:43], v[48:51], v[56:59], v[40:43]
    buffer_load_dwordx4 a[84:87], v3, s[20:23], s36 offen offset:1024 nt
    s_waitcnt vmcnt(11)
    ds_read_b128 v[56:59], v0 offset:30720
    v_and_b32_dpp v48, v32, v4 row_newbcast:10 row_mask:0xf bank_mask:0xf
    v_and_b32_dpp v49, v32, v5 row_newbcast:10 row_mask:0xf bank_mask:0xf
    v_and_b32_dpp v50, v32, v6 row_newbcast:10 row_mask:0xf bank_mask:0xf
    v_and_b32_dpp v51, v32, v7 row_newbcast:10 row_mask:0xf bank_mask:0xf
    s_waitcnt lgkmcnt(1)
    v_mfma_f32_16x16x32_bf16 v[40:43], v[52:55], v[60:63], v[40:43]
    buffer_load_dwordx4 a[88:91], v3, s[20:23], s36 offen offset:2048 nt
    s_waitcnt vmcnt(11)
    ds_read_b128 v[60:63], v0 offset:23552
    v_and_b32_dpp v52, v32, v4 row_newbcast:11 row_mask:0xf bank_mask:0xf
    v_and_b32_dpp v53, v32, v5 row_newbcast:11 row_mask:0xf bank_mask:0xf
    v_and_b32_dpp v54, v32, v6 row_newbcast:11 row_mask:0xf bank_mask:0xf
    v_and_b32_dpp v55, v32, v7 row_newbcast:11 row_mask:0xf bank_mask:0xf
    s_waitcnt lgkmcnt(1)
    v_mfma_f32_16x16x32_bf16 v[40:43], v[48:51], v[56:59], v[40:43]
    buffer_load_dwordx4 a[92:95], v3, s[20:23], s36 offen offset:3072 nt
    s_waitcnt vmcnt(11)
    ds_read_b128 v[56:59], v0 offset:31744
    v_and_b32_dpp v48, v32, v4 row_newbcast:12 row_mask:0xf bank_mask:0xf
    v_and_b32_dpp v49, v32, v5 row_newbcast:12 row_mask:0xf bank_mask:0xf
    v_and_b32_dpp v50, v32, v6 row_newbcast:12 row_mask:0xf bank_mask:0xf
    v_and_b32_dpp v51, v32, v7 row_newbcast:12 row_mask:0xf bank_mask:0xf
    s_waitcnt lgkmcnt(1)
    v_mfma_f32_16x16x32_bf16 v[40:43], v[52:55], v[60:63], v[40:43]
    buffer_load_dwordx4 a[96:99], v2, s[20:23], s38 offen offset:0 nt
    s_waitcnt vmcnt(11)
    ds_read_b128 v[60:63], v0 offset:32768
    v_and_b32_dpp v52, v32, v4 row_newbcast:13 row_mask:0xf bank_mask:0xf
    v_and_b32_dpp v53, v32, v5 row_newbcast:13 row_mask:0xf bank_mask:0xf
    v_and_b32_dpp v54, v32, v6 row_newbcast:13 row_mask:0xf bank_mask:0xf
    v_and_b32_dpp v55, v32, v7 row_newbcast:13 row_mask:0xf bank_mask:0xf
    s_waitcnt lgkmcnt(1)
    v_mfma_f32_16x16x32_bf16 v[40:43], v[48:51], v[56:59], v[40:43]
    buffer_load_dwordx4 a[100:103], v2, s[20:23], s38 offen offset:1024 nt
    s_waitcnt vmcnt(11)
    ds_read_b128 v[56:59], v0 offset:33792
    v_and_b32_dpp v48, v32, v4 row_newbcast:14 row_mask:0xf bank_mask:0xf
    v_and_b32_dpp v49, v32, v5 row_newbcast:14 row_mask:0xf bank_mask:0xf
    v_and_b32_dpp v50, v32, v6 row_newbcast:14 row_mask:0xf bank_mask:0xf
    v_and_b32_dpp v51, v32, v7 row_newbcast:14 row_mask:0xf bank_mask:0xf
    s_waitcnt lgkmcnt(1)
    v_mfma_f32_16x16x32_bf16 v[40:43], v[52:55], v[60:63], v[40:43]
    buffer_load_dwordx4 a[104:107], v2, s[20:23], s38 offen offset:2048 nt
    s_waitcnt vmcnt(11)
    ds_read_b128 v[60:63], v0 offset:34816
    v_and_b32_dpp v52, v32, v4 row_newbcast:15 row_mask:0xf bank_mask:0xf
    v_and_b32_dpp v53, v32, v5 row_newbcast:15 row_mask:0xf bank_mask:0xf
    v_and_b32_dpp v54, v32, v6 row_newbcast:15 row_mask:0xf bank_mask:0xf
    v_and_b32_dpp v55, v32, v7 row_newbcast:15 row_mask:0xf bank_mask:0xf
    s_waitcnt lgkmcnt(1)
    v_mfma_f32_16x16x32_bf16 v[40:43], v[48:51], v[56:59], v[40:43]
    buffer_load_dwordx4 a[108:111], v2, s[20:23], s38 offen offset:3072 nt
    s_waitcnt vmcnt(11)
    ds_read_b128 v[56:59], v0 offset:35840
    v_and_b32_dpp v48, v33, v4 row_newbcast:0 row_mask:0xf bank_mask:0xf
    v_and_b32_dpp v49, v33, v5 row_newbcast:0 row_mask:0xf bank_mask:0xf
    v_and_b32_dpp v50, v33, v6 row_newbcast:0 row_mask:0xf bank_mask:0xf
    v_and_b32_dpp v51, v33, v7 row_newbcast:0 row_mask:0xf bank_mask:0xf
    s_waitcnt lgkmcnt(1)
    v_mfma_f32_16x16x32_bf16 v[40:43], v[52:55], v[60:63], v[40:43]
    buffer_load_dwordx4 a[112:115], v3, s[20:23], s38 offen offset:0 nt
    s_waitcnt vmcnt(11)
    ds_read_b128 v[60:63], v0 offset:36864
    v_and_b32_dpp v52, v33, v4 row_newbcast:1 row_mask:0xf bank_mask:0xf
    v_and_b32_dpp v53, v33, v5 row_newbcast:1 row_mask:0xf bank_mask:0xf
    v_and_b32_dpp v54, v33, v6 row_newbcast:1 row_mask:0xf bank_mask:0xf
    v_and_b32_dpp v55, v33, v7 row_newbcast:1 row_mask:0xf bank_mask:0xf
    s_waitcnt lgkmcnt(1)
    v_mfma_f32_16x16x32_bf16 v[40:43], v[48:51], v[56:59], v[40:43]
    buffer_load_dwordx4 a[116:119], v3, s[20:23], s38 offen offset:1024 nt
    s_waitcnt vmcnt(11)
    ds_read_b128 v[56:59], v0 offset:37888
    v_and_b32_dpp v48, v33, v4 row_newbcast:2 row_mask:0xf bank_mask:0xf
    v_and_b32_dpp v49, v33, v5 row_newbcast:2 row_mask:0xf bank_mask:0xf
    v_and_b32_dpp v50, v33, v6 row_newbcast:2 row_mask:0xf bank_mask:0xf
    v_and_b32_dpp v51, v33, v7 row_newbcast:2 row_mask:0xf bank_mask:0xf
    s_waitcnt lgkmcnt(1)
    v_mfma_f32_16x16x32_bf16 v[40:43], v[52:55], v[60:63], v[40:43]
    buffer_load_dwordx4 a[120:123], v3, s[20:23], s38 offen offset:2048 nt
    s_waitcnt vmcnt(11)
    ds_read_b128 v[60:63], v0 offset:38912
    v_and_b32_dpp v52, v33, v4 row_newbcast:3 row_mask:0xf bank_mask:0xf
    v_and_b32_dpp v53, v33, v5 row_newbcast:3 row_mask:0xf bank_mask:0xf
    v_and_b32_dpp v54, v33, v6 row_newbcast:3 row_mask:0xf bank_mask:0xf
    v_and_b32_dpp v55, v33, v7 row_newbcast:3 row_mask:0xf bank_mask:0xf
    s_waitcnt lgkmcnt(1)
    v_mfma_f32_16x16x32_bf16 v[40:43], v[48:51], v[56:59], v[40:43]
    buffer_load_dwordx4 a[124:127], v3, s[20:23], s38 offen offset:3072 nt
    s_waitcnt vmcnt(11)
    ds_read_b128 v[56:59], v0 offset:39936
    v_and_b32_dpp v48, v33, v4 row_newbcast:4 row_mask:0xf bank_mask:0xf
    v_and_b32_dpp v49, v33, v5 row_newbcast:4 row_mask:0xf bank_mask:0xf
    v_and_b32_dpp v50, v33, v6 row_newbcast:4 row_mask:0xf bank_mask:0xf
    v_and_b32_dpp v51, v33, v7 row_newbcast:4 row_mask:0xf bank_mask:0xf
    s_waitcnt lgkmcnt(1)
    v_mfma_f32_16x16x32_bf16 v[40:43], v[52:55], v[60:63], v[40:43]
    buffer_load_dwordx4 a[128:131], v1, s[16:19], s28 offen offset:0 nt
    s_waitcnt vmcnt(11)
    v_and_b32_dpp v52, v33, v4 row_newbcast:5 row_mask:0xf bank_mask:0xf
    v_and_b32_dpp v53, v33, v5 row_newbcast:5 row_mask:0xf bank_mask:0xf
    v_and_b32_dpp v54, v33, v6 row_newbcast:5 row_mask:0xf bank_mask:0xf
    v_and_b32_dpp v55, v33, v7 row_newbcast:5 row_mask:0xf bank_mask:0xf
    s_waitcnt lgkmcnt(0)
    v_mfma_f32_16x16x32_bf16 v[40:43], v[48:51], v[56:59], v[40:43]
    buffer_load_dwordx4 a[132:135], v1, s[16:19], s28 offen offset:128 nt
    s_waitcnt vmcnt(11)
    v_and_b32_dpp v48, v33, v4 row_newbcast:6 row_mask:0xf bank_mask:0xf
    v_and_b32_dpp v49, v33, v5 row_newbcast:6 row_mask:0xf bank_mask:0xf
    v_and_b32_dpp v50, v33, v6 row_newbcast:6 row_mask:0xf bank_mask:0xf
    v_and_b32_dpp v51, v33, v7 row_newbcast:6 row_mask:0xf bank_mask:0xf
    v_mfma_f32_16x16x32_bf16 v[40:43], v[52:55], a[84:87], v[40:43]
    buffer_load_dwordx4 a[136:139], v1, s[16:19], s28 offen offset:256 nt
    s_waitcnt vmcnt(11)
    v_and_b32_dpp v52, v33, v4 row_newbcast:7 row_mask:0xf bank_mask:0xf
    v_and_b32_dpp v53, v33, v5 row_newbcast:7 row_mask:0xf bank_mask:0xf
    v_and_b32_dpp v54, v33, v6 row_newbcast:7 row_mask:0xf bank_mask:0xf
    v_and_b32_dpp v55, v33, v7 row_newbcast:7 row_mask:0xf bank_mask:0xf
    v_mfma_f32_16x16x32_bf16 v[40:43], v[48:51], a[88:91], v[40:43]
    buffer_load_dwordx4 a[140:143], v1, s[16:19], s28 offen offset:384 nt
    s_waitcnt vmcnt(11)
    v_and_b32_dpp v48, v33, v4 row_newbcast:8 row_mask:0xf bank_mask:0xf
    v_and_b32_dpp v49, v33, v5 row_newbcast:8 row_mask:0xf bank_mask:0xf
    v_and_b32_dpp v50, v33, v6 row_newbcast:8 row_mask:0xf bank_mask:0xf
    v_and_b32_dpp v51, v33, v7 row_newbcast:8 row_mask:0xf bank_mask:0xf
    v_mfma_f32_16x16x32_bf16 v[40:43], v[52:55], a[92:95], v[40:43]
    buffer_load_dwordx4 a[144:147], v1, s[16:19], s28 offen offset:512 nt
    s_waitcnt vmcnt(11)
    v_and_b32_dpp v52, v33, v4 row_newbcast:9 row_mask:0xf bank_mask:0xf
    v_and_b32_dpp v53, v33, v5 row_newbcast:9 row_mask:0xf bank_mask:0xf
    v_and_b32_dpp v54, v33, v6 row_newbcast:9 row_mask:0xf bank_mask:0xf
    v_and_b32_dpp v55, v33, v7 row_newbcast:9 row_mask:0xf bank_mask:0xf
    v_mfma_f32_16x16x32_bf16 v[40:43], v[48:51], a[96:99], v[40:43]
    buffer_load_dwordx4 a[148:151], v1, s[16:19], s28 offen offset:640 nt
    s_waitcnt vmcnt(11)
    v_and_b32_dpp v48, v33, v4 row_newbcast:10 row_mask:0xf bank_mask:0xf
    v_and_b32_dpp v49, v33, v5 row_newbcast:10 row_mask:0xf bank_mask:0xf
    v_and_b32_dpp v50, v33, v6 row_newbcast:10 row_mask:0xf bank_mask:0xf
    v_and_b32_dpp v51, v33, v7 row_newbcast:10 row_mask:0xf bank_mask:0xf
    v_mfma_f32_16x16x32_bf16 v[40:43], v[52:55], a[100:103], v[40:43]
    buffer_load_dwordx4 a[152:155], v1, s[16:19], s28 offen offset:768 nt
    s_waitcnt vmcnt(11)
    v_and_b32_dpp v52, v33, v4 row_newbcast:11 row_mask:0xf bank_mask:0xf
    v_and_b32_dpp v53, v33, v5 row_newbcast:11 row_mask:0xf bank_mask:0xf
    v_and_b32_dpp v54, v33, v6 row_newbcast:11 row_mask:0xf bank_mask:0xf
    v_and_b32_dpp v55, v33, v7 row_newbcast:11 row_mask:0xf bank_mask:0xf
    v_mfma_f32_16x16x32_bf16 v[40:43], v[48:51], a[104:107], v[40:43]
    buffer_load_dwordx4 a[156:159], v1, s[16:19], s28 offen offset:896 nt
    s_waitcnt vmcnt(11)
    v_and_b32_dpp v48, v33, v4 row_newbcast:12 row_mask:0xf bank_mask:0xf
    v_and_b32_dpp v49, v33, v5 row_newbcast:12 row_mask:0xf bank_mask:0xf
    v_and_b32_dpp v50, v33, v6 row_newbcast:12 row_mask:0xf bank_mask:0xf
    v_and_b32_dpp v51, v33, v7 row_newbcast:12 row_mask:0xf bank_mask:0xf
    v_mfma_f32_16x16x32_bf16 v[40:43], v[52:55], a[108:111], v[40:43]
    buffer_load_dwordx4 a[160:163], v1, s[16:19], s29 offen offset:0 nt
    s_waitcnt vmcnt(11)
    v_and_b32_dpp v52, v33, v4 row_newbcast:13 row_mask:0xf bank_mask:0xf
    v_and_b32_dpp v53, v33, v5 row_newbcast:13 row_mask:0xf bank_mask:0xf
    v_and_b32_dpp v54, v33, v6 row_newbcast:13 row_mask:0xf bank_mask:0xf
    v_and_b32_dpp v55, v33, v7 row_newbcast:13 row_mask:0xf bank_mask:0xf
    v_mfma_f32_16x16x32_bf16 v[40:43], v[48:51], a[112:115], v[40:43]
    buffer_load_dwordx4 a[164:167], v1, s[16:19], s29 offen offset:128 nt
    s_waitcnt vmcnt(11)
    v_and_b32_dpp v48, v33, v4 row_newbcast:14 row_mask:0xf bank_mask:0xf
    v_and_b32_dpp v49, v33, v5 row_newbcast:14 row_mask:0xf bank_mask:0xf
    v_and_b32_dpp v50, v33, v6 row_newbcast:14 row_mask:0xf bank_mask:0xf
    v_and_b32_dpp v51, v33, v7 row_newbcast:14 row_mask:0xf bank_mask:0xf
    v_mfma_f32_16x16x32_bf16 v[40:43], v[52:55], a[116:119], v[40:43]
    buffer_load_dwordx4 a[168:171], v1, s[16:19], s29 offen offset:256 nt
    s_waitcnt vmcnt(11)
    v_and_b32_dpp v52, v33, v4 row_newbcast:15 row_mask:0xf bank_mask:0xf
    v_and_b32_dpp v53, v33, v5 row_newbcast:15 row_mask:0xf bank_mask:0xf
    v_and_b32_dpp v54, v33, v6 row_newbcast:15 row_mask:0xf bank_mask:0xf
    v_and_b32_dpp v55, v33, v7 row_newbcast:15 row_mask:0xf bank_mask:0xf
    v_mfma_f32_16x16x32_bf16 v[40:43], v[48:51], a[120:123], v[40:43]
    buffer_load_dwordx4 a[172:175], v1, s[16:19], s29 offen offset:384 nt
    v_mfma_f32_16x16x32_bf16 v[40:43], v[52:55], a[124:127], v[40:43]
    v_add_f32_dpp v37, v37, v37 quad_perm:[1,0,3,2] row_mask:0xf bank_mask:0xf
    s_nop 1
    v_add_f32_dpp v37, v37, v37 quad_perm:[2,3,0,1] row_mask:0xf bank_mask:0xf
    s_nop 1
    v_add_f32_dpp v37, v37, v37 row_ror:4 row_mask:0xf bank_mask:0xf
    s_nop 1
    v_add_f32_dpp v37, v37, v37 row_ror:8 row_mask:0xf bank_mask:0xf
    v_mov_b32 v48, v37
    s_nop 1
    v_permlane16_swap_b32 v37, v48
    v_add_f32 v37, v37, v48
    v_mov_b32 v48, v37
    s_nop 1
    v_permlane32_swap_b32 v37, v48
    v_add_f32 v37, v37, v48
    v_log_f32 v50, v37
    v_rcp_f32 v37, v37
    v_and_b32 v48, 0xf0, v2
    v_lshlrev_b32 v48, 1, v48
    v_lshrrev_b32 v49, 8, v2
    v_lshlrev_b32 v49, 4, v49
    v_add_u32 v48, v48, v49
    s_add_u32 s74, s69, 458752
    s_mov_b32 s82, 0x7060500
    s_mov_b32 s83, 0x7060501
    s_mov_b32 s84, 0x7060502
    s_mov_b32 s85, 0x7060503
    v_mul_f32 v50, 0x3f317218, v50
    v_add_f32 v50, v50, v36
    v_mul_f32 v40, v40, v37
    v_mul_f32 v41, v41, v37
    v_mul_f32 v42, v42, v37
    v_mul_f32 v43, v43, v37
    v_perm_b32 v40, v40, v50, s82
    v_perm_b32 v41, v41, v50, s83
    v_perm_b32 v42, v42, v50, s84
    v_perm_b32 v43, v43, v50, s85
    s_mov_b32 exec_lo, 0xffffffff
    s_mov_b32 exec_hi, 0x0
    buffer_store_dwordx4 v[40:43], v48, s[24:27], s74 offen sc1
    s_mov_b64 exec, -1
    s_waitcnt vmcnt(11)
    buffer_load_dwordx4 a[176:179], v1, s[16:19], s29 offen offset:512 nt
    s_waitcnt vmcnt(11)
    buffer_load_dwordx4 a[180:183], v1, s[16:19], s29 offen offset:640 nt
    s_waitcnt vmcnt(11)
    buffer_load_dwordx4 a[184:187], v1, s[16:19], s29 offen offset:768 nt
    s_waitcnt vmcnt(11)
    buffer_load_dwordx4 a[188:191], v1, s[16:19], s29 offen offset:896 nt
    s_waitcnt vmcnt(11)
    buffer_load_dwordx4 a[192:195], v1, s[16:19], s30 offen offset:0 nt
    s_waitcnt vmcnt(11)
    buffer_load_dwordx4 a[196:199], v1, s[16:19], s30 offen offset:128 nt
    s_waitcnt vmcnt(11)
    buffer_load_dwordx4 a[200:203], v1, s[16:19], s30 offen offset:256 nt
    s_waitcnt vmcnt(11)
    buffer_load_dwordx4 a[204:207], v1, s[16:19], s30 offen offset:384 nt
    s_waitcnt vmcnt(11)
    buffer_load_dwordx4 a[208:211], v1, s[16:19], s30 offen offset:512 nt
    s_waitcnt vmcnt(11)
    buffer_load_dwordx4 a[212:215], v1, s[16:19], s30 offen offset:640 nt
    s_waitcnt vmcnt(11)
    buffer_load_dwordx4 a[216:219], v1, s[16:19], s30 offen offset:768 nt
    s_waitcnt vmcnt(11)
    buffer_load_dwordx4 a[220:223], v1, s[16:19], s30 offen offset:896 nt
    s_waitcnt vmcnt(11)
    buffer_load_dwordx4 a[224:227], v1, s[16:19], s31 offen offset:0 nt
    s_waitcnt vmcnt(11)
    buffer_load_dwordx4 a[228:231], v1, s[16:19], s31 offen offset:128 nt
    s_waitcnt vmcnt(11)
    buffer_load_dwordx4 a[232:235], v1, s[16:19], s31 offen offset:256 nt
    s_waitcnt vmcnt(11)
    buffer_load_dwordx4 a[236:239], v1, s[16:19], s31 offen offset:384 nt
    s_waitcnt vmcnt(11)
    buffer_load_dwordx4 a[240:243], v1, s[16:19], s31 offen offset:512 nt
    s_waitcnt vmcnt(11)
    buffer_load_dwordx4 a[244:247], v1, s[16:19], s31 offen offset:640 nt
    s_waitcnt vmcnt(11)
    buffer_load_dwordx4 a[248:251], v1, s[16:19], s31 offen offset:768 nt
    s_waitcnt vmcnt(11)
    buffer_load_dwordx4 a[252:255], v1, s[16:19], s31 offen offset:896 nt
    s_waitcnt vmcnt(11)
    buffer_load_dwordx4 v[64:67], v1, s[16:19], s32 offen offset:0 nt
    s_waitcnt vmcnt(11)
    buffer_load_dwordx4 v[68:71], v1, s[16:19], s32 offen offset:128 nt
    s_waitcnt vmcnt(11)
    buffer_load_dwordx4 v[72:75], v1, s[16:19], s32 offen offset:256 nt
    s_waitcnt vmcnt(11)
    buffer_load_dwordx4 v[76:79], v1, s[16:19], s32 offen offset:384 nt
    s_waitcnt vmcnt(11)
    buffer_load_dwordx4 v[80:83], v1, s[16:19], s32 offen offset:512 nt
    s_waitcnt vmcnt(11)
    buffer_load_dwordx4 v[84:87], v1, s[16:19], s32 offen offset:640 nt
    s_waitcnt vmcnt(11)
    buffer_load_dwordx4 v[88:91], v1, s[16:19], s32 offen offset:768 nt
    s_waitcnt vmcnt(11)
    buffer_load_dwordx4 v[92:95], v1, s[16:19], s32 offen offset:896 nt
    s_waitcnt vmcnt(11)
    buffer_load_dwordx4 a[0:3], v1, s[16:19], s33 offen offset:0 nt
    s_waitcnt vmcnt(11)
    buffer_load_dwordx4 a[4:7], v1, s[16:19], s33 offen offset:128 nt
    s_waitcnt vmcnt(11)
    buffer_load_dwordx4 a[8:11], v1, s[16:19], s33 offen offset:256 nt
    s_waitcnt vmcnt(11)
    buffer_load_dwordx4 a[12:15], v1, s[16:19], s33 offen offset:384 nt
    s_waitcnt vmcnt(11)
    buffer_load_dwordx4 a[16:19], v1, s[16:19], s33 offen offset:512 nt
    s_waitcnt vmcnt(11)
    buffer_load_dwordx4 a[20:23], v1, s[16:19], s33 offen offset:640 nt
    s_waitcnt vmcnt(11)
    buffer_load_dwordx4 a[24:27], v1, s[16:19], s33 offen offset:768 nt
    s_waitcnt vmcnt(11)
    buffer_load_dwordx4 a[28:31], v1, s[16:19], s33 offen offset:896 nt
    s_waitcnt vmcnt(11)
    buffer_load_dwordx4 v[96:99], v1, s[16:19], s34 offen offset:0 nt
    s_waitcnt vmcnt(11)
    buffer_load_dwordx4 v[100:103], v1, s[16:19], s34 offen offset:128 nt
    s_waitcnt vmcnt(11)
    buffer_load_dwordx4 v[160:163], v1, s[16:19], s34 offen offset:256 nt
    s_waitcnt vmcnt(11)
    buffer_load_dwordx4 v[192:195], v1, s[16:19], s34 offen offset:384 nt
    s_waitcnt vmcnt(11)
    buffer_load_dwordx4 v[164:167], v1, s[16:19], s34 offen offset:512 nt
    s_waitcnt vmcnt(11)
    buffer_load_dwordx4 v[196:199], v1, s[16:19], s34 offen offset:640 nt
    s_waitcnt vmcnt(11)
    buffer_load_dwordx4 v[168:171], v1, s[16:19], s34 offen offset:768 nt
    s_waitcnt vmcnt(11)
    buffer_load_dwordx4 v[200:203], v1, s[16:19], s34 offen offset:896 nt
    s_waitcnt vmcnt(11)
    buffer_load_dwordx4 v[172:175], v1, s[16:19], s35 offen offset:0 nt
    s_waitcnt vmcnt(11)
    buffer_load_dwordx4 v[204:207], v1, s[16:19], s35 offen offset:128 nt
    s_waitcnt vmcnt(11)
    buffer_load_dwordx4 v[176:179], v1, s[16:19], s35 offen offset:256 nt
    s_waitcnt vmcnt(11)
    buffer_load_dwordx4 v[208:211], v1, s[16:19], s35 offen offset:384 nt
    s_waitcnt vmcnt(11)
    buffer_load_dwordx4 v[180:183], v1, s[16:19], s35 offen offset:512 nt
    s_waitcnt vmcnt(11)
    buffer_load_dwordx4 v[212:215], v1, s[16:19], s35 offen offset:640 nt
    s_waitcnt vmcnt(11)
    buffer_load_dwordx4 v[128:131], v1, s[16:19], s35 offen offset:768 nt
    s_waitcnt vmcnt(11)
    buffer_load_dwordx4 v[132:135], v1, s[16:19], s35 offen offset:896 nt
    s_waitcnt vmcnt(11)
    buffer_load_dwordx4 v[184:187], v1, s[16:19], s36 offen offset:0 nt
    s_waitcnt vmcnt(11)
    buffer_load_dwordx4 v[216:219], v1, s[16:19], s36 offen offset:128 nt
    s_waitcnt vmcnt(11)
    buffer_load_dwordx4 v[136:139], v1, s[16:19], s36 offen offset:256 nt
    s_waitcnt vmcnt(11)
    buffer_load_dwordx4 v[140:143], v1, s[16:19], s36 offen offset:384 nt
    s_waitcnt vmcnt(11)
    buffer_load_dwordx4 v[144:147], v1, s[16:19], s36 offen offset:512 nt
    s_waitcnt vmcnt(11)
    buffer_load_dwordx4 v[188:191], v1, s[16:19], s36 offen offset:640 nt
    s_waitcnt vmcnt(11)
    buffer_load_dwordx4 v[220:223], v1, s[16:19], s36 offen offset:768 nt
    s_waitcnt vmcnt(11)
    buffer_load_dwordx4 v[148:151], v1, s[16:19], s36 offen offset:896 nt
    s_waitcnt vmcnt(11)
    buffer_load_dwordx4 v[152:155], v1, s[16:19], s38 offen offset:0 nt
    s_waitcnt vmcnt(11)
    buffer_load_dwordx4 v[156:159], v1, s[16:19], s38 offen offset:128 nt
    s_waitcnt vmcnt(11)
    buffer_load_dwordx4 v[224:227], v1, s[16:19], s38 offen offset:256 nt
    s_waitcnt vmcnt(11)
    buffer_load_dwordx4 a[32:35], v1, s[16:19], s38 offen offset:384 nt
    s_waitcnt vmcnt(11)
    buffer_load_dwordx4 v[228:231], v1, s[16:19], s38 offen offset:512 nt
    s_waitcnt vmcnt(11)
    buffer_load_dwordx4 a[36:39], v1, s[16:19], s38 offen offset:640 nt
    s_waitcnt vmcnt(11)
    buffer_load_dwordx4 v[232:235], v1, s[16:19], s38 offen offset:768 nt
    s_waitcnt vmcnt(11)
    buffer_load_dwordx4 a[40:43], v1, s[16:19], s38 offen offset:896 nt
    s_waitcnt vmcnt(11)
    buffer_load_dwordx4 v[236:239], v2, s[20:23], s28 offen offset:0 nt
    s_waitcnt vmcnt(11)
    buffer_load_dwordx4 a[44:47], v2, s[20:23], s28 offen offset:1024 nt
    s_waitcnt vmcnt(11)
    buffer_load_dwordx4 v[240:243], v2, s[20:23], s28 offen offset:2048 nt
    s_waitcnt vmcnt(11)
    buffer_load_dwordx4 a[48:51], v2, s[20:23], s28 offen offset:3072 nt
    s_waitcnt vmcnt(11)
    buffer_load_dwordx4 v[244:247], v3, s[20:23], s28 offen offset:0 nt
    s_waitcnt vmcnt(11)
    buffer_load_dwordx4 a[52:55], v3, s[20:23], s28 offen offset:1024 nt
    s_waitcnt vmcnt(11)
    buffer_load_dwordx4 v[248:251], v3, s[20:23], s28 offen offset:2048 nt
    s_waitcnt vmcnt(11)
    buffer_load_dwordx4 a[56:59], v3, s[20:23], s28 offen offset:3072 nt
    s_waitcnt vmcnt(11)
    buffer_load_dwordx4 v[252:255], v2, s[20:23], s29 offen offset:0 nt
    s_waitcnt vmcnt(11)
    buffer_load_dwordx4 a[60:63], v2, s[20:23], s29 offen offset:1024 nt
    s_waitcnt vmcnt(11)
    buffer_load_dwordx4 v[104:107], v2, s[20:23], s29 offen offset:2048 nt
    s_waitcnt vmcnt(11)
    buffer_load_dwordx4 v[108:111], v2, s[20:23], s29 offen offset:3072 nt
    s_waitcnt vmcnt(11)
    buffer_load_dwordx4 v[112:115], v3, s[20:23], s29 offen offset:0 nt
    s_waitcnt vmcnt(11)
    buffer_load_dwordx4 v[116:119], v3, s[20:23], s29 offen offset:1024 nt
    s_waitcnt vmcnt(11)
    buffer_load_dwordx4 v[120:123], v3, s[20:23], s29 offen offset:2048 nt
    s_waitcnt vmcnt(11)
    buffer_load_dwordx4 v[124:127], v3, s[20:23], s29 offen offset:3072 nt
    s_waitcnt vmcnt(11)
    buffer_load_dwordx4 a[96:99], v2, s[20:23], s30 offen offset:0 nt
    s_waitcnt vmcnt(11)
    buffer_load_dwordx4 a[100:103], v2, s[20:23], s30 offen offset:1024 nt
    s_waitcnt vmcnt(11)
    buffer_load_dwordx4 a[104:107], v2, s[20:23], s30 offen offset:2048 nt
    s_waitcnt vmcnt(11)
    buffer_load_dwordx4 a[108:111], v2, s[20:23], s30 offen offset:3072 nt
    s_waitcnt vmcnt(11)
    buffer_load_dwordx4 a[112:115], v3, s[20:23], s30 offen offset:0 nt
    s_waitcnt vmcnt(11)
    buffer_load_dwordx4 a[116:119], v3, s[20:23], s30 offen offset:1024 nt
    s_waitcnt vmcnt(11)
    buffer_load_dwordx4 a[120:123], v3, s[20:23], s30 offen offset:2048 nt
    s_waitcnt vmcnt(11)
    buffer_load_dwordx4 a[124:127], v3, s[20:23], s30 offen offset:3072 nt
    v_mov_b32 v16, -1
    v_mov_b32 v17, -1
    v_mov_b32 v18, -1
    v_mov_b32 v19, -1
    v_mov_b32 v20, -1
    v_mov_b32 v21, -1
    v_mov_b32 v22, -1
    v_mov_b32 v23, -1
    s_mov_b32 s73, 0
    s_nop 0
L_pl_15:
    s_add_u32 s74, s71, 24576
    buffer_load_dwordx4 v[16:19], v39, s[24:27], s74 offen sc1
    buffer_load_dwordx4 v[20:23], v39, s[24:27], s74 offen offset:128 sc1
    s_waitcnt vmcnt(0)
    v_max3_u32 v38, v16, v17, v18
    v_max3_u32 v38, v38, v19, v20
    v_max3_u32 v38, v38, v21, v22
    v_max_u32 v38, v38, v23
    v_cmp_eq_u32 vcc, -1, v38
    s_add_u32 s73, s73, 1
    s_cmp_gt_u32 s73, 60000
    s_nop 1
    s_cbranch_scc1 L_pd_16
    s_cbranch_vccnz L_pl_15
L_pd_16:
    v_mfma_f32_16x16x32_bf16 v[48:51], v[16:19], a[128:131], 0
    v_mfma_f32_16x16x32_bf16 v[52:55], v[16:19], a[136:139], 0
    v_mfma_f32_16x16x32_bf16 v[48:51], v[20:23], a[132:135], v[48:51]
    v_mfma_f32_16x16x32_bf16 v[52:55], v[20:23], a[140:143], v[52:55]
    buffer_load_dwordx4 a[128:131], v2, s[20:23], s38 offen offset:0 nt
    buffer_load_dwordx4 a[132:135], v2, s[20:23], s38 offen offset:1024 nt
    buffer_load_dwordx4 a[136:139], v2, s[20:23], s38 offen offset:2048 nt
    buffer_load_dwordx4 a[140:143], v2, s[20:23], s38 offen offset:3072 nt
    v_mfma_f32_16x16x32_bf16 v[56:59], v[16:19], a[144:147], 0
    v_mfma_f32_16x16x32_bf16 v[60:63], v[16:19], a[152:155], 0
    v_mfma_f32_16x16x32_bf16 v[56:59], v[20:23], a[148:151], v[56:59]
    v_mfma_f32_16x16x32_bf16 v[60:63], v[20:23], a[156:159], v[60:63]
    v_add_f32_dpp v29, v49, v48 row_ror:8 row_mask:0x1 bank_mask:0x3
    s_nop 1
    v_add_f32_dpp v29, v53, v52 row_ror:8 row_mask:0x2 bank_mask:0x3
    buffer_load_dwordx4 a[144:147], v3, s[20:23], s38 offen offset:0 nt
    buffer_load_dwordx4 a[148:151], v3, s[20:23], s38 offen offset:1024 nt
    buffer_load_dwordx4 a[152:155], v3, s[20:23], s38 offen offset:2048 nt
    buffer_load_dwordx4 a[156:159], v3, s[20:23], s38 offen offset:3072 nt
    v_mfma_f32_16x16x32_bf16 v[48:51], v[16:19], a[160:163], 0
    v_mfma_f32_16x16x32_bf16 v[52:55], v[16:19], a[168:171], 0
    v_mfma_f32_16x16x32_bf16 v[48:51], v[20:23], a[164:167], v[48:51]
    v_mfma_f32_16x16x32_bf16 v[52:55], v[20:23], a[172:175], v[52:55]
    v_add_f32_dpp v29, v57, v56 row_ror:8 row_mask:0x4 bank_mask:0x3
    s_nop 1
    v_add_f32_dpp v29, v61, v60 row_ror:8 row_mask:0x8 bank_mask:0x3
    v_mfma_f32_16x16x32_bf16 v[56:59], v[16:19], a[176:179], 0
    v_mfma_f32_16x16x32_bf16 v[60:63], v[16:19], a[184:187], 0
    v_mfma_f32_16x16x32_bf16 v[56:59], v[20:23], a[180:183], v[56:59]
    v_mfma_f32_16x16x32_bf16 v[60:63], v[20:23], a[188:191], v[60:63]
    v_add_f32_dpp v29, v48, v49 row_ror:8 row_mask:0x1 bank_mask:0xc
    s_nop 1
    v_add_f32_dpp v29, v52, v53 row_ror:8 row_mask:0x2 bank_mask:0xc
    v_mfma_f32_16x16x32_bf16 v[48:51], v[16:19], a[192:195], 0
    v_mfma_f32_16x16x32_bf16 v[52:55], v[16:19], a[200:203], 0
    v_mfma_f32_16x16x32_bf16 v[48:51], v[20:23], a[196:199], v[48:51]
    v_mfma_f32_16x16x32_bf16 v[52:55], v[20:23], a[204:207], v[52:55]
    v_add_f32_dpp v29, v56, v57 row_ror:8 row_mask:0x4 bank_mask:0xc
    s_nop 1
    v_add_f32_dpp v29, v60, v61 row_ror:8 row_mask:0x8 bank_mask:0xc
    v_mfma_f32_16x16x32_bf16 v[56:59], v[16:19], a[208:211], 0
    v_mfma_f32_16x16x32_bf16 v[60:63], v[16:19], a[216:219], 0
    v_mfma_f32_16x16x32_bf16 v[56:59], v[20:23], a[212:215], v[56:59]
    v_mfma_f32_16x16x32_bf16 v[60:63], v[20:23], a[220:223], v[60:63]
    v_add_f32_dpp v30, v49, v48 row_ror:8 row_mask:0x1 bank_mask:0x3
    s_nop 1
    v_add_f32_dpp v30, v53, v52 row_ror:8 row_mask:0x2 bank_mask:0x3
    v_mfma_f32_16x16x32_bf16 v[48:51], v[16:19], a[224:227], 0
    v_mfma_f32_16x16x32_bf16 v[52:55], v[16:19], a[232:235], 0
    v_mfma_f32_16x16x32_bf16 v[48:51], v[20:23], a[228:231], v[48:51]
    v_mfma_f32_16x16x32_bf16 v[52:55], v[20:23], a[236:239], v[52:55]
    v_add_f32_dpp v30, v57, v56 row_ror:8 row_mask:0x4 bank_mask:0x3
    s_nop 1
    v_add_f32_dpp v30, v61, v60 row_ror:8 row_mask:0x8 bank_mask:0x3
    v_mfma_f32_16x16x32_bf16 v[56:59], v[16:19], a[240:243], 0
    v_mfma_f32_16x16x32_bf16 v[60:63], v[16:19], a[248:251], 0
    v_mfma_f32_16x16x32_bf16 v[56:59], v[20:23], a[244:247], v[56:59]
    v_mfma_f32_16x16x32_bf16 v[60:63], v[20:23], a[252:255], v[60:63]
    v_add_f32_dpp v30, v48, v49 row_ror:8 row_mask:0x1 bank_mask:0xc
    s_nop 1
    v_add_f32_dpp v30, v52, v53 row_ror:8 row_mask:0x2 bank_mask:0xc
    v_mfma_f32_16x16x32_bf16 v[48:51], v[16:19], v[64:67], 0
    v_mfma_f32_16x16x32_bf16 v[52:55], v[16:19], v[72:75], 0
    v_mfma_f32_16x16x32_bf16 v[48:51], v[20:23], v[68:71], v[48:51]
    v_mfma_f32_16x16x32_bf16 v[52:55], v[20:23], v[76:79], v[52:55]
    v_add_f32_dpp v30, v56, v57 row_ror:8 row_mask:0x4 bank_mask:0xc
    s_nop 1
    v_add_f32_dpp v30, v60, v61 row_ror:8 row_mask:0x8 bank_mask:0xc
    v_mfma_f32_16x16x32_bf16 v[56:59], v[16:19], v[80:83], 0
    v_mfma_f32_16x16x32_bf16 v[60:63], v[16:19], v[88:91], 0
    v_mfma_f32_16x16x32_bf16 v[56:59], v[20:23], v[84:87], v[56:59]
    v_mfma_f32_16x16x32_bf16 v[60:63], v[20:23], v[92:95], v[60:63]
    v_add_f32_dpp v31, v49, v48 row_ror:8 row_mask:0x1 bank_mask:0x3
    s_nop 1
    v_add_f32_dpp v31, v53, v52 row_ror:8 row_mask:0x2 bank_mask:0x3
    v_mfma_f32_16x16x32_bf16 v[48:51], v[16:19], a[0:3], 0
    v_mfma_f32_16x16x32_bf16 v[52:55], v[16:19], a[8:11], 0
    v_mfma_f32_16x16x32_bf16 v[48:51], v[20:23], a[4:7], v[48:51]
    v_mfma_f32_16x16x32_bf16 v[52:55], v[20:23], a[12:15], v[52:55]
    v_add_f32_dpp v31, v57, v56 row_ror:8 row_mask:0x4 bank_mask:0x3
    s_nop 1
    v_add_f32_dpp v31, v61, v60 row_ror:8 row_mask:0x8 bank_mask:0x3
    v_mfma_f32_16x16x32_bf16 v[56:59], v[16:19], a[16:19], 0
    v_mfma_f32_16x16x32_bf16 v[60:63], v[16:19], a[24:27], 0
    v_mfma_f32_16x16x32_bf16 v[56:59], v[20:23], a[20:23], v[56:59]
    v_mfma_f32_16x16x32_bf16 v[60:63], v[20:23], a[28:31], v[60:63]
    v_add_f32_dpp v31, v48, v49 row_ror:8 row_mask:0x1 bank_mask:0xc
    s_nop 1
    v_add_f32_dpp v31, v52, v53 row_ror:8 row_mask:0x2 bank_mask:0xc
    v_mfma_f32_16x16x32_bf16 v[48:51], v[16:19], v[96:99], 0
    v_mfma_f32_16x16x32_bf16 v[52:55], v[16:19], v[160:163], 0
    v_mfma_f32_16x16x32_bf16 v[48:51], v[20:23], v[100:103], v[48:51]
    v_mfma_f32_16x16x32_bf16 v[52:55], v[20:23], v[192:195], v[52:55]
    v_add_f32_dpp v31, v56, v57 row_ror:8 row_mask:0x4 bank_mask:0xc
    s_nop 1
    v_add_f32_dpp v31, v60, v61 row_ror:8 row_mask:0x8 bank_mask:0xc
    v_mfma_f32_16x16x32_bf16 v[56:59], v[16:19], v[164:167], 0
    v_mfma_f32_16x16x32_bf16 v[60:63], v[16:19], v[168:171], 0
    v_mfma_f32_16x16x32_bf16 v[56:59], v[20:23], v[196:199], v[56:59]
    v_mfma_f32_16x16x32_bf16 v[60:63], v[20:23], v[200:203], v[60:63]
    v_add_f32_dpp v32, v49, v48 row_ror:8 row_mask:0x1 bank_mask:0x3
    s_nop 1
    v_add_f32_dpp v32, v53, v52 row_ror:8 row_mask:0x2 bank_mask:0x3
    v_mfma_f32_16x16x32_bf16 v[48:51], v[16:19], v[172:175], 0
    v_mfma_f32_16x16x32_bf16 v[52:55], v[16:19], v[176:179], 0
    v_mfma_f32_16x16x32_bf16 v[48:51], v[20:23], v[204:207], v[48:51]
    v_mfma_f32_16x16x32_bf16 v[52:55], v[20:23], v[208:211], v[52:55]
    v_add_f32_dpp v32, v57, v56 row_ror:8 row_mask:0x4 bank_mask:0x3
    s_nop 1
    v_add_f32_dpp v32, v61, v60 row_ror:8 row_mask:0x8 bank_mask:0x3
    v_mfma_f32_16x16x32_bf16 v[56:59], v[16:19], v[180:183], 0
    v_mfma_f32_16x16x32_bf16 v[60:63], v[16:19], v[128:131], 0
    v_mfma_f32_16x16x32_bf16 v[56:59], v[20:23], v[212:215], v[56:59]
    v_mfma_f32_16x16x32_bf16 v[60:63], v[20:23], v[132:135], v[60:63]
    v_add_f32_dpp v32, v48, v49 row_ror:8 row_mask:0x1 bank_mask:0xc
    s_nop 1
    v_add_f32_dpp v32, v52, v53 row_ror:8 row_mask:0x2 bank_mask:0xc
    v_mfma_f32_16x16x32_bf16 v[48:51], v[16:19], v[184:187], 0
    v_mfma_f32_16x16x32_bf16 v[52:55], v[16:19], v[136:139], 0
    v_mfma_f32_16x16x32_bf16 v[48:51], v[20:23], v[216:219], v[48:51]
    v_mfma_f32_16x16x32_bf16 v[52:55], v[20:23], v[140:143], v[52:55]
    v_add_f32_dpp v32, v56, v57 row_ror:8 row_mask:0x4 bank_mask:0xc
    s_nop 1
    v_add_f32_dpp v32, v60, v61 row_ror:8 row_mask:0x8 bank_mask:0xc
    v_mfma_f32_16x16x32_bf16 v[56:59], v[16:19], v[144:147], 0
    v_mfma_f32_16x16x32_bf16 v[60:63], v[16:19], v[220:223], 0
    v_mfma_f32_16x16x32_bf16 v[56:59], v[20:23], v[188:191], v[56:59]
    v_mfma_f32_16x16x32_bf16 v[60:63], v[20:23], v[148:151], v[60:63]
    v_add_f32_dpp v33, v49, v48 row_ror:8 row_mask:0x1 bank_mask:0x3
    s_nop 1
    v_add_f32_dpp v33, v53, v52 row_ror:8 row_mask:0x2 bank_mask:0x3
    v_mfma_f32_16x16x32_bf16 v[48:51], v[16:19], v[152:155], 0
    v_mfma_f32_16x16x32_bf16 v[52:55], v[16:19], v[224:227], 0
    v_mfma_f32_16x16x32_bf16 v[48:51], v[20:23], v[156:159], v[48:51]
    v_mfma_f32_16x16x32_bf16 v[52:55], v[20:23], a[32:35], v[52:55]
    v_add_f32_dpp v33, v57, v56 row_ror:8 row_mask:0x4 bank_mask:0x3
    s_nop 1
    v_add_f32_dpp v33, v61, v60 row_ror:8 row_mask:0x8 bank_mask:0x3
    v_mfma_f32_16x16x32_bf16 v[56:59], v[16:19], v[228:231], 0
    v_mfma_f32_16x16x32_bf16 v[60:63], v[16:19], v[232:235], 0
    v_mfma_f32_16x16x32_bf16 v[56:59], v[20:23], a[36:39], v[56:59]
    v_mfma_f32_16x16x32_bf16 v[60:63], v[20:23], a[40:43], v[60:63]
    v_add_f32_dpp v33, v48, v49 row_ror:8 row_mask:0x1 bank_mask:0xc
    s_nop 1
    v_add_f32_dpp v33, v52, v53 row_ror:8 row_mask:0x2 bank_mask:0xc
    s_nop 2
    v_add_f32_dpp v33, v56, v57 row_ror:8 row_mask:0x4 bank_mask:0xc
    s_nop 1
    v_add_f32_dpp v33, v60, v61 row_ror:8 row_mask:0x8 bank_mask:0xc
    v_cvt_pk_bf16_f32 v48, v29, v30
    v_lshlrev_b32 v29, 16, v48
    v_and_b32 v30, 0xffff0000, v48
    v_mul_f32 v29, 0x3db504f3, v29
    v_mul_f32 v30, 0x3db504f3, v30
    v_cvt_pk_bf16_f32 v48, v29, v30
    v_lshlrev_b32 v29, 16, v48
    v_and_b32 v30, 0xffff0000, v48
    v_cvt_pk_bf16_f32 v48, v31, v32
    v_lshlrev_b32 v31, 16, v48
    v_and_b32 v32, 0xffff0000, v48
    v_mul_f32 v31, 0x3db504f3, v31
    v_mul_f32 v32, 0x3db504f3, v32
    v_cvt_pk_bf16_f32 v48, v31, v32
    v_lshlrev_b32 v31, 16, v48
    v_and_b32 v32, 0xffff0000, v48
    v_cvt_pk_bf16_f32 v48, v33, v33
    v_lshlrev_b32 v33, 16, v48
    v_mul_f32 v33, 0x3db504f3, v33
    v_cvt_pk_bf16_f32 v48, v33, v33
    v_lshlrev_b32 v33, 16, v48
    v_mov_b32 v48, 0xff800000
    v_cndmask_b32 v33, v33, v48, s[66:67]
    v_max_f32 v36, v29, v30
    v_max3_f32 v36, v36, v31, v32
    v_max_f32 v36, v36, v33
    s_nop 1
    v_max_f32_dpp v36, v36, v36 quad_perm:[1,0,3,2] row_mask:0xf bank_mask:0xf
    s_nop 1
    v_max_f32_dpp v36, v36, v36 quad_perm:[2,3,0,1] row_mask:0xf bank_mask:0xf
    s_nop 1
    v_max_f32_dpp v36, v36, v36 row_ror:4 row_mask:0xf bank_mask:0xf
    s_nop 1
    v_max_f32_dpp v36, v36, v36 row_ror:8 row_mask:0xf bank_mask:0xf
    v_mov_b32 v48, v36
    s_nop 1
    v_permlane16_swap_b32 v36, v48
    v_max_f32 v36, v36, v48
    v_mov_b32 v48, v36
    s_nop 1
    v_permlane32_swap_b32 v36, v48
    v_max_f32 v36, v36, v48
    v_sub_f32 v29, v29, v36
    v_mul_f32 v29, 0x3fb8aa3b, v29
    v_exp_f32 v29, v29
    v_sub_f32 v30, v30, v36
    v_mul_f32 v30, 0x3fb8aa3b, v30
    v_exp_f32 v30, v30
    v_sub_f32 v31, v31, v36
    v_mul_f32 v31, 0x3fb8aa3b, v31
    v_exp_f32 v31, v31
    v_sub_f32 v32, v32, v36
    v_mul_f32 v32, 0x3fb8aa3b, v32
    v_exp_f32 v32, v32
    v_sub_f32 v33, v33, v36
    v_mul_f32 v33, 0x3fb8aa3b, v33
    v_exp_f32 v33, v33
    v_add_f32 v37, v29, v30
    v_add_f32 v48, v31, v32
    v_add_f32 v37, v37, v33
    v_add_f32 v37, v37, v48
    v_cvt_pk_bf16_f32 v29, v29, v29
    v_cvt_pk_bf16_f32 v30, v30, v30
    v_cvt_pk_bf16_f32 v31, v31, v31
    v_cvt_pk_bf16_f32 v32, v32, v32
    v_cvt_pk_bf16_f32 v33, v33, v33
    v_mov_b32 v8, v29
    v_mov_b32 v13, v29
    v_mov_b32 v9, v30
    v_mov_b32 v14, v30
    v_mov_b32 v10, v31
    v_mov_b32 v15, v31
    v_mov_b32 v11, v32
    v_mov_b32 v16, v32
    v_mov_b32 v12, v33
    v_mov_b32 v17, v33
    v_mov_b32_dpp v8, v29 row_shr:4 row_mask:0xf bank_mask:0xa
    v_mov_b32_dpp v13, v29 row_shl:4 row_mask:0xf bank_mask:0x5
    v_mov_b32_dpp v9, v30 row_shr:4 row_mask:0xf bank_mask:0xa
    v_mov_b32_dpp v14, v30 row_shl:4 row_mask:0xf bank_mask:0x5
    v_mov_b32_dpp v10, v31 row_shr:4 row_mask:0xf bank_mask:0xa
    v_mov_b32_dpp v15, v31 row_shl:4 row_mask:0xf bank_mask:0x5
    v_mov_b32_dpp v11, v32 row_shr:4 row_mask:0xf bank_mask:0xa
    v_mov_b32_dpp v16, v32 row_shl:4 row_mask:0xf bank_mask:0x5
    v_mov_b32_dpp v12, v33 row_shr:4 row_mask:0xf bank_mask:0xa
    v_mov_b32_dpp v17, v33 row_shl:4 row_mask:0xf bank_mask:0x5
    ds_read_b128 v[224:227], v0 offset:8192
    ds_read_b128 a[32:35], v0 offset:9216
    ds_read_b128 v[228:231], v0 offset:10240
    ds_read_b128 a[36:39], v0 offset:0
    ds_read_b128 v[232:235], v0 offset:13312
    ds_read_b128 a[40:43], v0 offset:1024
    v_and_b32_dpp v48, v14, v4 quad_perm:[1,1,1,1] row_mask:0xf bank_mask:0xf
    v_and_b32_dpp v49, v14, v5 quad_perm:[1,1,1,1] row_mask:0xf bank_mask:0xf
    v_and_b32_dpp v50, v14, v6 quad_perm:[1,1,1,1] row_mask:0xf bank_mask:0xf
    v_and_b32_dpp v51, v14, v7 quad_perm:[1,1,1,1] row_mask:0xf bank_mask:0xf
    v_and_b32_dpp v52, v8, v4 quad_perm:[0,0,0,0] row_mask:0xf bank_mask:0xf
    v_and_b32_dpp v53, v8, v5 quad_perm:[0,0,0,0] row_mask:0xf bank_mask:0xf
    v_and_b32_dpp v54, v8, v6 quad_perm:[0,0,0,0] row_mask:0xf bank_mask:0xf
    v_and_b32_dpp v55, v8, v7 quad_perm:[0,0,0,0] row_mask:0xf bank_mask:0xf
    v_mfma_f32_16x16x32_bf16 v[44:47], v[48:51], a[116:119], 0
    s_waitcnt lgkmcnt(5)
    v_mfma_f32_16x16x32_bf16 v[20:23], v[48:51], v[224:227], 0
    ds_read_b128 v[224:227], v0 offset:6144
    v_and_b32_dpp v48, v14, v4 quad_perm:[2,2,2,2] row_mask:0xf bank_mask:0xf
    v_and_b32_dpp v49, v14, v5 quad_perm:[2,2,2,2] row_mask:0xf bank_mask:0xf
    v_and_b32_dpp v50, v14, v6 quad_perm:[2,2,2,2] row_mask:0xf bank_mask:0xf
    v_and_b32_dpp v51, v14, v7 quad_perm:[2,2,2,2] row_mask:0xf bank_mask:0xf
    v_mfma_f32_16x16x32_bf16 v[44:47], v[52:55], v[236:239], v[44:47]
    v_mfma_f32_16x16x32_bf16 v[20:23], v[52:55], v[252:255], v[20:23]
    v_and_b32_dpp v52, v14, v4 quad_perm:[3,3,3,3] row_mask:0xf bank_mask:0xf
    v_and_b32_dpp v53, v14, v5 quad_perm:[3,3,3,3] row_mask:0xf bank_mask:0xf
    v_and_b32_dpp v54, v14, v6 quad_perm:[3,3,3,3] row_mask:0xf bank_mask:0xf
    v_and_b32_dpp v55, v14, v7 quad_perm:[3,3,3,3] row_mask:0xf bank_mask:0xf
    v_mfma_f32_16x16x32_bf16 v[44:47], v[48:51], a[120:123], v[44:47]
    s_waitcnt lgkmcnt(5)
    v_mfma_f32_16x16x32_bf16 v[20:23], v[48:51], a[32:35], v[20:23]
    ds_read_b128 a[32:35], v0 offset:2048
    v_and_b32_dpp v48, v8, v4 quad_perm:[1,1,1,1] row_mask:0xf bank_mask:0xf
    v_and_b32_dpp v49, v8, v5 quad_perm:[1,1,1,1] row_mask:0xf bank_mask:0xf
    v_and_b32_dpp v50, v8, v6 quad_perm:[1,1,1,1] row_mask:0xf bank_mask:0xf
    v_and_b32_dpp v51, v8, v7 quad_perm:[1,1,1,1] row_mask:0xf bank_mask:0xf
    v_mfma_f32_16x16x32_bf16 v[44:47], v[52:55], a[124:127], v[44:47]
    s_waitcnt lgkmcnt(5)
    v_mfma_f32_16x16x32_bf16 v[20:23], v[52:55], v[228:231], v[20:23]
    ds_read_b128 v[228:231], v0 offset:14336
    v_and_b32_dpp v52, v10, v4 quad_perm:[0,0,0,0] row_mask:0xf bank_mask:0xf
    v_and_b32_dpp v53, v10, v5 quad_perm:[0,0,0,0] row_mask:0xf bank_mask:0xf
    v_and_b32_dpp v54, v10, v6 quad_perm:[0,0,0,0] row_mask:0xf bank_mask:0xf
    v_and_b32_dpp v55, v10, v7 quad_perm:[0,0,0,0] row_mask:0xf bank_mask:0xf
    v_mfma_f32_16x16x32_bf16 v[44:47], v[48:51], a[44:47], v[44:47]
    v_mfma_f32_16x16x32_bf16 v[20:23], v[48:51], a[60:63], v[20:23]
    v_and_b32_dpp v48, v8, v4 quad_perm:[2,2,2,2] row_mask:0xf bank_mask:0xf
    v_and_b32_dpp v49, v8, v5 quad_perm:[2,2,2,2] row_mask:0xf bank_mask:0xf
    v_and_b32_dpp v50, v8, v6 quad_perm:[2,2,2,2] row_mask:0xf bank_mask:0xf
    v_and_b32_dpp v51, v8, v7 quad_perm:[2,2,2,2] row_mask:0xf bank_mask:0xf
    s_waitcnt lgkmcnt(5)
    v_mfma_f32_16x16x32_bf16 v[44:47], v[52:55], a[36:39], v[44:47]
    s_waitcnt lgkmcnt(4)
    v_mfma_f32_16x16x32_bf16 v[20:23], v[52:55], v[232:235], v[20:23]
    ds_read_b128 a[36:39], v0 offset:3072
    ds_read_b128 v[232:235], v0 offset:7168
    v_and_b32_dpp v52, v10, v4 quad_perm:[1,1,1,1] row_mask:0xf bank_mask:0xf
    v_and_b32_dpp v53, v10, v5 quad_perm:[1,1,1,1] row_mask:0xf bank_mask:0xf
    v_and_b32_dpp v54, v10, v6 quad_perm:[1,1,1,1] row_mask:0xf bank_mask:0xf
    v_and_b32_dpp v55, v10, v7 quad_perm:[1,1,1,1] row_mask:0xf bank_mask:0xf
    v_mfma_f32_16x16x32_bf16 v[44:47], v[48:51], v[240:243], v[44:47]
    v_mfma_f32_16x16x32_bf16 v[20:23], v[48:51], v[104:107], v[20:23]
    v_and_b32_dpp v48, v10, v4 quad_perm:[2,2,2,2] row_mask:0xf bank_mask:0xf
    v_and_b32_dpp v49, v10, v5 quad_perm:[2,2,2,2] row_mask:0xf bank_mask:0xf
    v_and_b32_dpp v50, v10, v6 quad_perm:[2,2,2,2] row_mask:0xf bank_mask:0xf
    v_and_b32_dpp v51, v10, v7 quad_perm:[2,2,2,2] row_mask:0xf bank_mask:0xf
    s_waitcnt lgkmcnt(5)
    v_mfma_f32_16x16x32_bf16 v[44:47], v[52:55], a[40:43], v[44:47]
    s_waitcnt lgkmcnt(4)
    v_mfma_f32_16x16x32_bf16 v[20:23], v[52:55], v[224:227], v[20:23]
    ds_read_b128 a[40:43], v0 offset:11264
    ds_read_b128 v[224:227], v0 offset:15360
    v_and_b32_dpp v52, v8, v4 quad_perm:[3,3,3,3] row_mask:0xf bank_mask:0xf
    v_and_b32_dpp v53, v8, v5 quad_perm:[3,3,3,3] row_mask:0xf bank_mask:0xf
    v_and_b32_dpp v54, v8, v6 quad_perm:[3,3,3,3] row_mask:0xf bank_mask:0xf
    v_and_b32_dpp v55, v8, v7 quad_perm:[3,3,3,3] row_mask:0xf bank_mask:0xf
    s_waitcnt lgkmcnt(5)
    v_mfma_f32_16x16x32_bf16 v[44:47], v[48:51], a[32:35], v[44:47]
    s_waitcnt lgkmcnt(4)
    v_mfma_f32_16x16x32_bf16 v[20:23], v[48:51], v[228:231], v[20:23]
    ds_read_b128 a[32:35], v0 offset:4096
    ds_read_b128 v[228:231], v0 offset:16384
    v_and_b32_dpp v48, v10, v4 quad_perm:[3,3,3,3] row_mask:0xf bank_mask:0xf
    v_and_b32_dpp v49, v10, v5 quad_perm:[3,3,3,3] row_mask:0xf bank_mask:0xf
    v_and_b32_dpp v50, v10, v6 quad_perm:[3,3,3,3] row_mask:0xf bank_mask:0xf
    v_and_b32_dpp v51, v10, v7 quad_perm:[3,3,3,3] row_mask:0xf bank_mask:0xf
    v_mfma_f32_16x16x32_bf16 v[44:47], v[52:55], a[48:51], v[44:47]
    v_mfma_f32_16x16x32_bf16 v[20:23], v[52:55], v[108:111], v[20:23]
    v_and_b32_dpp v52, v13, v4 quad_perm:[0,0,0,0] row_mask:0xf bank_mask:0xf
    v_and_b32_dpp v53, v13, v5 quad_perm:[0,0,0,0] row_mask:0xf bank_mask:0xf
    v_and_b32_dpp v54, v13, v6 quad_perm:[0,0,0,0] row_mask:0xf bank_mask:0xf
    v_and_b32_dpp v55, v13, v7 quad_perm:[0,0,0,0] row_mask:0xf bank_mask:0xf
    s_waitcnt lgkmcnt(5)
    v_mfma_f32_16x16x32_bf16 v[44:47], v[48:51], a[36:39], v[44:47]
    s_waitcnt lgkmcnt(4)
    v_mfma_f32_16x16x32_bf16 v[20:23], v[48:51], v[232:235], v[20:23]
    ds_read_b128 a[36:39], v0 offset:12288
    ds_read_b128 v[232:235], v0 offset:24576
    v_and_b32_dpp v48, v15, v4 quad_perm:[0,0,0,0] row_mask:0xf bank_mask:0xf
    v_and_b32_dpp v49, v15, v5 quad_perm:[0,0,0,0] row_mask:0xf bank_mask:0xf
    v_and_b32_dpp v50, v15, v6 quad_perm:[0,0,0,0] row_mask:0xf bank_mask:0xf
    v_and_b32_dpp v51, v15, v7 quad_perm:[0,0,0,0] row_mask:0xf bank_mask:0xf
    v_mfma_f32_16x16x32_bf16 v[44:47], v[52:55], v[244:247], v[44:47]
    v_mfma_f32_16x16x32_bf16 v[20:23], v[52:55], v[112:115], v[20:23]
    v_and_b32_dpp v52, v15, v4 quad_perm:[1,1,1,1] row_mask:0xf bank_mask:0xf
    v_and_b32_dpp v53, v15, v5 quad_perm:[1,1,1,1] row_mask:0xf bank_mask:0xf
    v_and_b32_dpp v54, v15, v6 quad_perm:[1,1,1,1] row_mask:0xf bank_mask:0xf
    v_and_b32_dpp v55, v15, v7 quad_perm:[1,1,1,1] row_mask:0xf bank_mask:0xf
    s_waitcnt lgkmcnt(5)
    v_mfma_f32_16x16x32_bf16 v[44:47], v[48:51], a[40:43], v[44:47]
    s_waitcnt lgkmcnt(4)
    v_mfma_f32_16x16x32_bf16 v[20:23], v[48:51], v[224:227], v[20:23]
    ds_read_b128 a[40:43], v0 offset:5120
    ds_read_b128 v[224:227], v0 offset:17408
    v_and_b32_dpp v48, v13, v4 quad_perm:[1,1,1,1] row_mask:0xf bank_mask:0xf
    v_and_b32_dpp v49, v13, v5 quad_perm:[1,1,1,1] row_mask:0xf bank_mask:0xf
    v_and_b32_dpp v50, v13, v6 quad_perm:[1,1,1,1] row_mask:0xf bank_mask:0xf
    v_and_b32_dpp v51, v13, v7 quad_perm:[1,1,1,1] row_mask:0xf bank_mask:0xf
    s_waitcnt lgkmcnt(5)
    v_mfma_f32_16x16x32_bf16 v[44:47], v[52:55], a[32:35], v[44:47]
    s_waitcnt lgkmcnt(4)
    v_mfma_f32_16x16x32_bf16 v[20:23], v[52:55], v[228:231], v[20:23]
    ds_read_b128 a[32:35], v0 offset:25600
    ds_read_b128 v[228:231], v0 offset:29696
    v_and_b32_dpp v52, v15, v4 quad_perm:[2,2,2,2] row_mask:0xf bank_mask:0xf
    v_and_b32_dpp v53, v15, v5 quad_perm:[2,2,2,2] row_mask:0xf bank_mask:0xf
    v_and_b32_dpp v54, v15, v6 quad_perm:[2,2,2,2] row_mask:0xf bank_mask:0xf
    v_and_b32_dpp v55, v15, v7 quad_perm:[2,2,2,2] row_mask:0xf bank_mask:0xf
    v_mfma_f32_16x16x32_bf16 v[44:47], v[48:51], a[52:55], v[44:47]
    v_mfma_f32_16x16x32_bf16 v[20:23], v[48:51], v[116:119], v[20:23]
    v_and_b32_dpp v48, v13, v4 quad_perm:[2,2,2,2] row_mask:0xf bank_mask:0xf
    v_and_b32_dpp v49, v13, v5 quad_perm:[2,2,2,2] row_mask:0xf bank_mask:0xf
    v_and_b32_dpp v50, v13, v6 quad_perm:[2,2,2,2] row_mask:0xf bank_mask:0xf
    v_and_b32_dpp v51, v13, v7 quad_perm:[2,2,2,2] row_mask:0xf bank_mask:0xf
    s_waitcnt lgkmcnt(5)
    v_mfma_f32_16x16x32_bf16 v[44:47], v[52:55], a[36:39], v[44:47]
    s_waitcnt lgkmcnt(4)
    v_mfma_f32_16x16x32_bf16 v[20:23], v[52:55], v[232:235], v[20:23]
    ds_read_b128 a[36:39], v0 offset:18432
    ds_read_b128 v[232:235], v0 offset:22528
    v_and_b32_dpp v52, v15, v4 quad_perm:[3,3,3,3] row_mask:0xf bank_mask:0xf
    v_and_b32_dpp v53, v15, v5 quad_perm:[3,3,3,3] row_mask:0xf bank_mask:0xf
    v_and_b32_dpp v54, v15, v6 quad_perm:[3,3,3,3] row_mask:0xf bank_mask:0xf
    v_and_b32_dpp v55, v15, v7 quad_perm:[3,3,3,3] row_mask:0xf bank_mask:0xf
    v_mfma_f32_16x16x32_bf16 v[44:47], v[48:51], v[248:251], v[44:47]
    v_mfma_f32_16x16x32_bf16 v[20:23], v[48:51], v[120:123], v[20:23]
    v_and_b32_dpp v48, v11, v4 quad_perm:[0,0,0,0] row_mask:0xf bank_mask:0xf
    v_and_b32_dpp v49, v11, v5 quad_perm:[0,0,0,0] row_mask:0xf bank_mask:0xf
    v_and_b32_dpp v50, v11, v6 quad_perm:[0,0,0,0] row_mask:0xf bank_mask:0xf
    v_and_b32_dpp v51, v11, v7 quad_perm:[0,0,0,0] row_mask:0xf bank_mask:0xf
    s_waitcnt lgkmcnt(5)
    v_mfma_f32_16x16x32_bf16 v[44:47], v[52:55], a[40:43], v[44:47]
    s_waitcnt lgkmcnt(4)
    v_mfma_f32_16x16x32_bf16 v[20:23], v[52:55], v[224:227], v[20:23]
    ds_read_b128 a[40:43], v0 offset:26624
    ds_read_b128 v[224:227], v0 offset:30720
    v_and_b32_dpp v52, v13, v4 quad_perm:[3,3,3,3] row_mask:0xf bank_mask:0xf
    v_and_b32_dpp v53, v13, v5 quad_perm:[3,3,3,3] row_mask:0xf bank_mask:0xf
    v_and_b32_dpp v54, v13, v6 quad_perm:[3,3,3,3] row_mask:0xf bank_mask:0xf
    v_and_b32_dpp v55, v13, v7 quad_perm:[3,3,3,3] row_mask:0xf bank_mask:0xf
    s_waitcnt lgkmcnt(5)
    v_mfma_f32_16x16x32_bf16 v[44:47], v[48:51], a[32:35], v[44:47]
    s_waitcnt lgkmcnt(4)
    v_mfma_f32_16x16x32_bf16 v[20:23], v[48:51], v[228:231], v[20:23]
    ds_read_b128 a[32:35], v0 offset:19456
    ds_read_b128 v[228:231], v0 offset:23552
    v_and_b32_dpp v48, v11, v4 quad_perm:[1,1,1,1] row_mask:0xf bank_mask:0xf
    v_and_b32_dpp v49, v11, v5 quad_perm:[1,1,1,1] row_mask:0xf bank_mask:0xf
    v_and_b32_dpp v50, v11, v6 quad_perm:[1,1,1,1] row_mask:0xf bank_mask:0xf
    v_and_b32_dpp v51, v11, v7 quad_perm:[1,1,1,1] row_mask:0xf bank_mask:0xf
    v_mfma_f32_16x16x32_bf16 v[44:47], v[52:55], a[56:59], v[44:47]
    v_mfma_f32_16x16x32_bf16 v[20:23], v[52:55], v[124:127], v[20:23]
    v_and_b32_dpp v52, v9, v4 quad_perm:[0,0,0,0] row_mask:0xf bank_mask:0xf
    v_and_b32_dpp v53, v9, v5 quad_perm:[0,0,0,0] row_mask:0xf bank_mask:0xf
    v_and_b32_dpp v54, v9, v6 quad_perm:[0,0,0,0] row_mask:0xf bank_mask:0xf
    v_and_b32_dpp v55, v9, v7 quad_perm:[0,0,0,0] row_mask:0xf bank_mask:0xf
    s_waitcnt lgkmcnt(5)
    v_mfma_f32_16x16x32_bf16 v[44:47], v[48:51], a[36:39], v[44:47]
    s_waitcnt lgkmcnt(4)
    v_mfma_f32_16x16x32_bf16 v[20:23], v[48:51], v[232:235], v[20:23]
    ds_read_b128 a[36:39], v0 offset:27648
    ds_read_b128 v[232:235], v0 offset:31744
    v_and_b32_dpp v48, v11, v4 quad_perm:[2,2,2,2] row_mask:0xf bank_mask:0xf
    v_and_b32_dpp v49, v11, v5 quad_perm:[2,2,2,2] row_mask:0xf bank_mask:0xf
    v_and_b32_dpp v50, v11, v6 quad_perm:[2,2,2,2] row_mask:0xf bank_mask:0xf
    v_and_b32_dpp v51, v11, v7 quad_perm:[2,2,2,2] row_mask:0xf bank_mask:0xf
    v_mfma_f32_16x16x32_bf16 v[44:47], v[52:55], a[96:99], v[44:47]
    v_mfma_f32_16x16x32_bf16 v[20:23], v[52:55], a[64:67], v[20:23]
    v_and_b32_dpp v52, v9, v4 quad_perm:[1,1,1,1] row_mask:0xf bank_mask:0xf
    v_and_b32_dpp v53, v9, v5 quad_perm:[1,1,1,1] row_mask:0xf bank_mask:0xf
    v_and_b32_dpp v54, v9, v6 quad_perm:[1,1,1,1] row_mask:0xf bank_mask:0xf
    v_and_b32_dpp v55, v9, v7 quad_perm:[1,1,1,1] row_mask:0xf bank_mask:0xf
    s_waitcnt lgkmcnt(5)
    v_mfma_f32_16x16x32_bf16 v[44:47], v[48:51], a[40:43], v[44:47]
    s_waitcnt lgkmcnt(4)
    v_mfma_f32_16x16x32_bf16 v[20:23], v[48:51], v[224:227], v[20:23]
    ds_read_b128 a[40:43], v0 offset:20480
    ds_read_b128 v[224:227], v0 offset:32768
    v_and_b32_dpp v48, v11, v4 quad_perm:[3,3,3,3] row_mask:0xf bank_mask:0xf
    v_and_b32_dpp v49, v11, v5 quad_perm:[3,3,3,3] row_mask:0xf bank_mask:0xf
    v_and_b32_dpp v50, v11, v6 quad_perm:[3,3,3,3] row_mask:0xf bank_mask:0xf
    v_and_b32_dpp v51, v11, v7 quad_perm:[3,3,3,3] row_mask:0xf bank_mask:0xf
    v_mfma_f32_16x16x32_bf16 v[44:47], v[52:55], a[100:103], v[44:47]
    v_mfma_f32_16x16x32_bf16 v[20:23], v[52:55], a[68:71], v[20:23]
    v_and_b32_dpp v52, v16, v4 quad_perm:[0,0,0,0] row_mask:0xf bank_mask:0xf
    v_and_b32_dpp v53, v16, v5 quad_perm:[0,0,0,0] row_mask:0xf bank_mask:0xf
    v_and_b32_dpp v54, v16, v6 quad_perm:[0,0,0,0] row_mask:0xf bank_mask:0xf
    v_and_b32_dpp v55, v16, v7 quad_perm:[0,0,0,0] row_mask:0xf bank_mask:0xf
    s_waitcnt lgkmcnt(5)
    v_mfma_f32_16x16x32_bf16 v[44:47], v[48:51], a[32:35], v[44:47]
    s_waitcnt lgkmcnt(4)
    v_mfma_f32_16x16x32_bf16 v[20:23], v[48:51], v[228:231], v[20:23]
    ds_read_b128 a[32:35], v0 offset:28672
    ds_read_b128 v[228:231], v0 offset:33792
    v_and_b32_dpp v48, v9, v4 quad_perm:[2,2,2,2] row_mask:0xf bank_mask:0xf
    v_and_b32_dpp v49, v9, v5 quad_perm:[2,2,2,2] row_mask:0xf bank_mask:0xf
    v_and_b32_dpp v50, v9, v6 quad_perm:[2,2,2,2] row_mask:0xf bank_mask:0xf
    v_and_b32_dpp v51, v9, v7 quad_perm:[2,2,2,2] row_mask:0xf bank_mask:0xf
    s_waitcnt lgkmcnt(5)
    v_mfma_f32_16x16x32_bf16 v[44:47], v[52:55], a[36:39], v[44:47]
    s_waitcnt lgkmcnt(4)
    v_mfma_f32_16x16x32_bf16 v[20:23], v[52:55], v[232:235], v[20:23]
    ds_read_b128 a[36:39], v0 offset:21504
    ds_read_b128 v[232:235], v0 offset:34816
    v_and_b32_dpp v52, v16, v4 quad_perm:[1,1,1,1] row_mask:0xf bank_mask:0xf
    v_and_b32_dpp v53, v16, v5 quad_perm:[1,1,1,1] row_mask:0xf bank_mask:0xf
    v_and_b32_dpp v54, v16, v6 quad_perm:[1,1,1,1] row_mask:0xf bank_mask:0xf
    v_and_b32_dpp v55, v16, v7 quad_perm:[1,1,1,1] row_mask:0xf bank_mask:0xf
    v_mfma_f32_16x16x32_bf16 v[44:47], v[48:51], a[104:107], v[44:47]
    v_mfma_f32_16x16x32_bf16 v[20:23], v[48:51], a[72:75], v[20:23]
    v_and_b32_dpp v48, v9, v4 quad_perm:[3,3,3,3] row_mask:0xf bank_mask:0xf
    v_and_b32_dpp v49, v9, v5 quad_perm:[3,3,3,3] row_mask:0xf bank_mask:0xf
    v_and_b32_dpp v50, v9, v6 quad_perm:[3,3,3,3] row_mask:0xf bank_mask:0xf
    v_and_b32_dpp v51, v9, v7 quad_perm:[3,3,3,3] row_mask:0xf bank_mask:0xf
    s_waitcnt lgkmcnt(5)
    v_mfma_f32_16x16x32_bf16 v[44:47], v[52:55], a[40:43], v[44:47]
    s_waitcnt lgkmcnt(4)
    v_mfma_f32_16x16x32_bf16 v[20:23], v[52:55], v[224:227], v[20:23]
    ds_read_b128 a[40:43], v0 offset:35840
    ds_read_b128 v[224:227], v0 offset:36864
    v_and_b32_dpp v52, v16, v4 quad_perm:[2,2,2,2] row_mask:0xf bank_mask:0xf
    v_and_b32_dpp v53, v16, v5 quad_perm:[2,2,2,2] row_mask:0xf bank_mask:0xf
    v_and_b32_dpp v54, v16, v6 quad_perm:[2,2,2,2] row_mask:0xf bank_mask:0xf
    v_and_b32_dpp v55, v16, v7 quad_perm:[2,2,2,2] row_mask:0xf bank_mask:0xf
    v_mfma_f32_16x16x32_bf16 v[44:47], v[48:51], a[108:111], v[44:47]
    v_mfma_f32_16x16x32_bf16 v[20:23], v[48:51], a[76:79], v[20:23]
    v_and_b32_dpp v48, v16, v4 quad_perm:[3,3,3,3] row_mask:0xf bank_mask:0xf
    v_and_b32_dpp v49, v16, v5 quad_perm:[3,3,3,3] row_mask:0xf bank_mask:0xf
    v_and_b32_dpp v50, v16, v6 quad_perm:[3,3,3,3] row_mask:0xf bank_mask:0xf
    v_and_b32_dpp v51, v16, v7 quad_perm:[3,3,3,3] row_mask:0xf bank_mask:0xf
    s_waitcnt lgkmcnt(5)
    v_mfma_f32_16x16x32_bf16 v[44:47], v[52:55], a[32:35], v[44:47]
    s_waitcnt lgkmcnt(4)
    v_mfma_f32_16x16x32_bf16 v[20:23], v[52:55], v[228:231], v[20:23]
    ds_read_b128 a[32:35], v0 offset:37888
    ds_read_b128 v[228:231], v0 offset:38912
    v_and_b32_dpp v52, v14, v4 quad_perm:[0,0,0,0] row_mask:0xf bank_mask:0xf
    v_and_b32_dpp v53, v14, v5 quad_perm:[0,0,0,0] row_mask:0xf bank_mask:0xf
    v_and_b32_dpp v54, v14, v6 quad_perm:[0,0,0,0] row_mask:0xf bank_mask:0xf
    v_and_b32_dpp v55, v14, v7 quad_perm:[0,0,0,0] row_mask:0xf bank_mask:0xf
    s_waitcnt lgkmcnt(5)
    v_mfma_f32_16x16x32_bf16 v[44:47], v[48:51], a[36:39], v[44:47]
    s_waitcnt lgkmcnt(4)
    v_mfma_f32_16x16x32_bf16 v[20:23], v[48:51], v[232:235], v[20:23]
    ds_read_b128 a[36:39], v0 offset:39936
    v_and_b32_dpp v48, v12, v4 quad_perm:[0,0,0,0] row_mask:0xf bank_mask:0xf
    v_and_b32_dpp v49, v12, v5 quad_perm:[0,0,0,0] row_mask:0xf bank_mask:0xf
    v_and_b32_dpp v50, v12, v6 quad_perm:[0,0,0,0] row_mask:0xf bank_mask:0xf
    v_and_b32_dpp v51, v12, v7 quad_perm:[0,0,0,0] row_mask:0xf bank_mask:0xf
    v_mfma_f32_16x16x32_bf16 v[44:47], v[52:55], a[112:115], v[44:47]
    v_mfma_f32_16x16x32_bf16 v[20:23], v[52:55], a[80:83], v[20:23]
    v_and_b32_dpp v52, v12, v4 quad_perm:[1,1,1,1] row_mask:0xf bank_mask:0xf
    v_and_b32_dpp v53, v12, v5 quad_perm:[1,1,1,1] row_mask:0xf bank_mask:0xf
    v_and_b32_dpp v54, v12, v6 quad_perm:[1,1,1,1] row_mask:0xf bank_mask:0xf
    v_and_b32_dpp v55, v12, v7 quad_perm:[1,1,1,1] row_mask:0xf bank_mask:0xf
    s_waitcnt lgkmcnt(4)
    v_mfma_f32_16x16x32_bf16 v[44:47], v[48:51], a[40:43], v[44:47]
    s_waitcnt vmcnt(7)
    v_mfma_f32_16x16x32_bf16 v[20:23], v[48:51], a[128:131], v[20:23]
    v_and_b32_dpp v48, v12, v4 quad_perm:[2,2,2,2] row_mask:0xf bank_mask:0xf
    v_and_b32_dpp v49, v12, v5 quad_perm:[2,2,2,2] row_mask:0xf bank_mask:0xf
    v_and_b32_dpp v50, v12, v6 quad_perm:[2,2,2,2] row_mask:0xf bank_mask:0xf
    v_and_b32_dpp v51, v12, v7 quad_perm:[2,2,2,2] row_mask:0xf bank_mask:0xf
    s_waitcnt lgkmcnt(3)
    v_mfma_f32_16x16x32_bf16 v[44:47], v[52:55], v[224:227], v[44:47]
    s_waitcnt vmcnt(6)
    v_mfma_f32_16x16x32_bf16 v[20:23], v[52:55], a[132:135], v[20:23]
    v_and_b32_dpp v52, v12, v4 quad_perm:[3,3,3,3] row_mask:0xf bank_mask:0xf
    v_and_b32_dpp v53, v12, v5 quad_perm:[3,3,3,3] row_mask:0xf bank_mask:0xf
    v_and_b32_dpp v54, v12, v6 quad_perm:[3,3,3,3] row_mask:0xf bank_mask:0xf
    v_and_b32_dpp v55, v12, v7 quad_perm:[3,3,3,3] row_mask:0xf bank_mask:0xf
    s_waitcnt lgkmcnt(2)
    v_mfma_f32_16x16x32_bf16 v[44:47], v[48:51], a[32:35], v[44:47]
    s_waitcnt vmcnt(5)
    v_mfma_f32_16x16x32_bf16 v[20:23], v[48:51], a[136:139], v[20:23]
    v_and_b32_dpp v48, v17, v4 quad_perm:[0,0,0,0] row_mask:0xf bank_mask:0xf
    v_and_b32_dpp v49, v17, v5 quad_perm:[0,0,0,0] row_mask:0xf bank_mask:0xf
    v_and_b32_dpp v50, v17, v6 quad_perm:[0,0,0,0] row_mask:0xf bank_mask:0xf
    v_and_b32_dpp v51, v17, v7 quad_perm:[0,0,0,0] row_mask:0xf bank_mask:0xf
    s_waitcnt lgkmcnt(1)
    v_mfma_f32_16x16x32_bf16 v[44:47], v[52:55], v[228:231], v[44:47]
    s_waitcnt vmcnt(4)
    v_mfma_f32_16x16x32_bf16 v[20:23], v[52:55], a[140:143], v[20:23]
    v_and_b32_dpp v52, v17, v4 quad_perm:[1,1,1,1] row_mask:0xf bank_mask:0xf
    v_and_b32_dpp v53, v17, v5 quad_perm:[1,1,1,1] row_mask:0xf bank_mask:0xf
    v_and_b32_dpp v54, v17, v6 quad_perm:[1,1,1,1] row_mask:0xf bank_mask:0xf
    v_and_b32_dpp v55, v17, v7 quad_perm:[1,1,1,1] row_mask:0xf bank_mask:0xf
    s_waitcnt lgkmcnt(0)
    v_mfma_f32_16x16x32_bf16 v[44:47], v[48:51], a[36:39], v[44:47]
    s_waitcnt vmcnt(3)
    v_mfma_f32_16x16x32_bf16 v[20:23], v[48:51], a[144:147], v[20:23]
    v_and_b32_dpp v48, v17, v4 quad_perm:[2,2,2,2] row_mask:0xf bank_mask:0xf
    v_and_b32_dpp v49, v17, v5 quad_perm:[2,2,2,2] row_mask:0xf bank_mask:0xf
    v_and_b32_dpp v50, v17, v6 quad_perm:[2,2,2,2] row_mask:0xf bank_mask:0xf
    v_and_b32_dpp v51, v17, v7 quad_perm:[2,2,2,2] row_mask:0xf bank_mask:0xf
    v_mfma_f32_16x16x32_bf16 v[44:47], v[52:55], a[84:87], v[44:47]
    s_waitcnt vmcnt(2)
    v_mfma_f32_16x16x32_bf16 v[20:23], v[52:55], a[148:151], v[20:23]
    v_and_b32_dpp v52, v17, v4 quad_perm:[3,3,3,3] row_mask:0xf bank_mask:0xf
    v_and_b32_dpp v53, v17, v5 quad_perm:[3,3,3,3] row_mask:0xf bank_mask:0xf
    v_and_b32_dpp v54, v17, v6 quad_perm:[3,3,3,3] row_mask:0xf bank_mask:0xf
    v_and_b32_dpp v55, v17, v7 quad_perm:[3,3,3,3] row_mask:0xf bank_mask:0xf
    v_mfma_f32_16x16x32_bf16 v[44:47], v[48:51], a[88:91], v[44:47]
    s_waitcnt vmcnt(1)
    v_mfma_f32_16x16x32_bf16 v[20:23], v[48:51], a[152:155], v[20:23]
    v_mfma_f32_16x16x32_bf16 v[44:47], v[52:55], a[92:95], v[44:47]
    s_waitcnt vmcnt(0)
    v_mfma_f32_16x16x32_bf16 v[20:23], v[52:55], a[156:159], v[20:23]
    s_nop 7
    v_mov_b32 v48, v20
    v_mov_b32 v49, v21
    v_mov_b32 v50, v22
    v_mov_b32 v51, v23
    v_permlane32_swap_b32 v48, v20
    v_permlane32_swap_b32 v49, v21
    v_permlane32_swap_b32 v50, v22
    v_permlane32_swap_b32 v51, v23
    v_add_f32 v44, v44, v20
    v_add_f32 v45, v45, v21
    v_add_f32 v46, v46, v22
    v_add_f32 v47, v47, v23
    v_add_f32_dpp v37, v37, v37 quad_perm:[1,0,3,2] row_mask:0xf bank_mask:0xf
    s_nop 1
    v_add_f32_dpp v37, v37, v37 quad_perm:[2,3,0,1] row_mask:0xf bank_mask:0xf
    s_nop 1
    v_add_f32_dpp v37, v37, v37 row_ror:4 row_mask:0xf bank_mask:0xf
    s_nop 1
    v_add_f32_dpp v37, v37, v37 row_ror:8 row_mask:0xf bank_mask:0xf
    v_mov_b32 v48, v37
    s_nop 1
    v_permlane16_swap_b32 v37, v48
    v_add_f32 v37, v37, v48
    v_mov_b32 v48, v37
    s_nop 1
    v_permlane32_swap_b32 v37, v48
    v_add_f32 v37, v37, v48
    v_log_f32 v50, v37
    v_rcp_f32 v37, v37
    v_and_b32 v48, 0xf0, v2
    v_lshlrev_b32 v48, 1, v48
    v_lshrrev_b32 v49, 8, v2
    v_lshlrev_b32 v49, 4, v49
    v_add_u32 v48, v48, v49
    s_add_u32 s74, s69, 1376256
    s_mov_b32 s82, 0x7060500
    s_mov_b32 s83, 0x7060501
    s_mov_b32 s84, 0x7060502
    s_mov_b32 s85, 0x7060503
    v_mul_f32 v50, 0x3f317218, v50
    v_add_f32 v50, v50, v36
    v_mul_f32 v44, v44, v37
    v_mul_f32 v45, v45, v37
    v_mul_f32 v46, v46, v37
    v_mul_f32 v47, v47, v37
    v_perm_b32 v44, v44, v50, s82
    v_perm_b32 v45, v45, v50, s83
    v_perm_b32 v46, v46, v50, s84
    v_perm_b32 v47, v47, v50, s85
    s_mov_b32 exec_lo, 0xffffffff
    s_mov_b32 exec_hi, 0x0
    buffer_store_dwordx4 v[44:47], v48, s[24:27], s74 offen sc1
    s_mov_b64 exec, -1
    s_branch L_fin
L_chain:
    s_getpc_b64 s[80:81]
L_pc:
    s_sub_u32 s80, s80, L_pc-interleave_layers__gqa_block_cached__dense_activation_silu__decode_kernel
    s_subb_u32 s81, s81, 0
    s_sub_u32 s82, s2, 224
    s_lshr_b32 s82, s82, 3
    s_lshl_b32 s82, s82, 2
    s_add_u32 s82, s82, s3
    s_lshl_b32 s82, s82, 12
    v_lshlrev_b32 v62, 6, v0
    v_add_u32 v62, s82, v62
    v_min_u32 v62, L_end-interleave_layers__gqa_block_cached__dense_activation_silu__decode_kernel, v62
    v_mov_b32 v61, s81
    v_add_co_u32 v60, vcc, s80, v62
    s_nop 1
    v_addc_co_u32 v61, vcc, 0, v61, vcc
    global_load_dword v62, v[60:61], off
    s_sub_u32 s62, s2, 224
    s_cmp_ge_u32 s62, 22
    s_cselect_b32 s69, 1, 0
    v_lshlrev_b32 v15, 4, v0
    v_lshrrev_b32 v1, 4, v0
    v_and_b32 v2, 15, v0
    s_waitcnt lgkmcnt(0)
    s_mov_b32 s24, s60
    s_mov_b32 s25, s61
    s_mov_b32 s26, 2260992
    s_mov_b32 s27, 0x20000
    s_mul_i32 s39, s3, 33792
    s_add_u32 s39, s39, 26624
    v_mov_b32 v20, -1
    v_mov_b32 v21, -1
    v_mov_b32 v22, -1
    v_mov_b32 v23, -1
    s_cmp_lg_u32 s3, 0
    s_cbranch_scc1 L_c_noq
    v_mul_u32_u24 v24, 8192, v1
    v_lshlrev_b32 v25, 4, v2
    v_add_u32 v24, v24, v25
    s_lshl_b32 s75, s62, 8
    s_add_u32 s75, s75, 2195456
    buffer_store_dwordx4 v[20:23], v24, s[24:27], s75 offen sc1
    s_nop 1
L_c_noq:
    s_mov_b32 s8, s40
    s_mov_b32 s9, s41
    s_mov_b32 s10, 2560
    s_mov_b32 s11, 0x20000
    v_and_b32 v24, 0xf0, v15
    buffer_load_dwordx4 v[160:163], v15, s[8:11], 0 offen offset:0
    buffer_load_dwordx4 v[164:167], v24, s[8:11], 0 offen offset:1024
    buffer_load_dwordx4 v[152:155], v15, s[8:11], 0 offen offset:1280
    buffer_load_dwordx4 v[156:159], v24, s[8:11], 0 offen offset:2304
    s_mov_b32 s8, s46
    s_mov_b32 s9, s47
    s_mov_b32 s10, 5242880
    s_mov_b32 s11, 0x20000
    v_lshlrev_b32 v16, 13, v1
    v_lshlrev_b32 v17, 4, v2
    v_add_u32 v16, v16, v17
    s_mul_i32 s74, s3, 1310720
    s_lshl_b32 s75, s62, 8
    s_add_u32 s74, s74, s75
    buffer_load_dwordx4 a[0:3], v16, s[8:11], s74 offen offset:0 nt
    s_add_u32 s74, s74, 32768
    buffer_load_dwordx4 a[4:7], v16, s[8:11], s74 offen offset:0 nt
    s_add_u32 s74, s74, 32768
    buffer_load_dwordx4 a[8:11], v16, s[8:11], s74 offen offset:0 nt
    s_add_u32 s74, s74, 32768
    buffer_load_dwordx4 a[12:15], v16, s[8:11], s74 offen offset:0 nt
    s_add_u32 s74, s74, 32768
    buffer_load_dwordx4 a[16:19], v16, s[8:11], s74 offen offset:0 nt
    s_add_u32 s74, s74, 32768
    buffer_load_dwordx4 a[20:23], v16, s[8:11], s74 offen offset:0 nt
    s_add_u32 s74, s74, 32768
    buffer_load_dwordx4 a[24:27], v16, s[8:11], s74 offen offset:0 nt
    s_add_u32 s74, s74, 32768
    buffer_load_dwordx4 a[28:31], v16, s[8:11], s74 offen offset:0 nt
    s_add_u32 s74, s74, 32768
    s_cmp_lg_u32 s3, 0
    s_cbranch_scc1 L_c_noarrA
    s_waitcnt vmcnt(12)
    s_mov_b64 exec, 1
    v_mov_b32 v26, 0
    v_mov_b32 v27, 1
    global_atomic_add v26, v27, s[58:59] sc1
    s_mov_b64 exec, -1
L_c_noarrA:
    s_barrier
    buffer_load_dwordx4 a[32:35], v16, s[8:11], s74 offen offset:0 nt
    s_add_u32 s74, s74, 32768
    buffer_load_dwordx4 a[36:39], v16, s[8:11], s74 offen offset:0 nt
    s_add_u32 s74, s74, 32768
    buffer_load_dwordx4 a[40:43], v16, s[8:11], s74 offen offset:0 nt
    s_add_u32 s74, s74, 32768
    buffer_load_dwordx4 a[44:47], v16, s[8:11], s74 offen offset:0 nt
    s_add_u32 s74, s74, 32768
    buffer_load_dwordx4 a[48:51], v16, s[8:11], s74 offen offset:0 nt
    s_add_u32 s74, s74, 32768
    buffer_load_dwordx4 a[52:55], v16, s[8:11], s74 offen offset:0 nt
    s_add_u32 s74, s74, 32768
    buffer_load_dwordx4 a[56:59], v16, s[8:11], s74 offen offset:0 nt
    s_add_u32 s74, s74, 32768
    buffer_load_dwordx4 a[60:63], v16, s[8:11], s74 offen offset:0 nt
    s_add_u32 s74, s74, 32768
    buffer_load_dwordx4 a[64:67], v16, s[8:11], s74 offen offset:0 nt
    s_add_u32 s74, s74, 32768
    buffer_load_dwordx4 a[68:71], v16, s[8:11], s74 offen offset:0 nt
    s_add_u32 s74, s74, 32768
    buffer_load_dwordx4 a[72:75], v16, s[8:11], s74 offen offset:0 nt
    s_add_u32 s74, s74, 32768
    buffer_load_dwordx4 a[76:79], v16, s[8:11], s74 offen offset:0 nt
    s_add_u32 s74, s74, 32768
    buffer_load_dwordx4 a[80:83], v16, s[8:11], s74 offen offset:0 nt
    s_add_u32 s74, s74, 32768
    buffer_load_dwordx4 a[84:87], v16, s[8:11], s74 offen offset:0 nt
    s_add_u32 s74, s74, 32768
    buffer_load_dwordx4 a[88:91], v16, s[8:11], s74 offen offset:0 nt
    s_add_u32 s74, s74, 32768
    buffer_load_dwordx4 a[92:95], v16, s[8:11], s74 offen offset:0 nt
    s_add_u32 s74, s74, 32768
    buffer_load_dwordx4 a[96:99], v16, s[8:11], s74 offen offset:0 nt
    s_add_u32 s74, s74, 32768
    buffer_load_dwordx4 a[100:103], v16, s[8:11], s74 offen offset:0 nt
    s_add_u32 s74, s74, 32768
    buffer_load_dwordx4 a[104:107], v16, s[8:11], s74 offen offset:0 nt
    s_add_u32 s74, s74, 32768
    buffer_load_dwordx4 a[108:111], v16, s[8:11], s74 offen offset:0 nt
    s_add_u32 s74, s74, 32768
    buffer_load_dwordx4 a[112:115], v16, s[8:11], s74 offen offset:0 nt
    s_add_u32 s74, s74, 32768
    buffer_load_dwordx4 a[116:119], v16, s[8:11], s74 offen offset:0 nt
    s_add_u32 s74, s74, 32768
    buffer_load_dwordx4 a[120:123], v16, s[8:11], s74 offen offset:0 nt
    s_add_u32 s74, s74, 32768
    buffer_load_dwordx4 a[124:127], v16, s[8:11], s74 offen offset:0 nt
    s_add_u32 s74, s74, 32768
    buffer_load_dwordx4 a[128:131], v16, s[8:11], s74 offen offset:0 nt
    s_add_u32 s74, s74, 32768
    buffer_load_dwordx4 a[132:135], v16, s[8:11], s74 offen offset:0 nt
    s_add_u32 s74, s74, 32768
    buffer_load_dwordx4 a[136:139], v16, s[8:11], s74 offen offset:0 nt
    s_add_u32 s74, s74, 32768
    buffer_load_dwordx4 a[140:143], v16, s[8:11], s74 offen offset:0 nt
    s_add_u32 s74, s74, 32768
    buffer_load_dwordx4 a[144:147], v16, s[8:11], s74 offen offset:0 nt
    s_add_u32 s74, s74, 32768
    buffer_load_dwordx4 a[148:151], v16, s[8:11], s74 offen offset:0 nt
    s_add_u32 s74, s74, 32768
    buffer_load_dwordx4 a[152:155], v16, s[8:11], s74 offen offset:0 nt
    s_add_u32 s74, s74, 32768
    buffer_load_dwordx4 a[156:159], v16, s[8:11], s74 offen offset:0 nt
    s_mov_b32 s8, s48
    s_mov_b32 s9, s49
    s_mov_b32 s10, 5242880
    s_mov_b32 s11, 0x20000
    v_mul_u32_u24 v3, 1280, v1
    v_lshlrev_b32 v12, 4, v2
    v_add_u32 v3, v3, v12
    s_lshl_b32 s36, s62, 2
    s_add_u32 s36, s36, s3
    s_mul_i32 s36, s36, 40960
    v_mov_b32 v12, 0
    global_load_dword v12, v12, s[58:59] sc1
    buffer_load_dwordx4 a[160:163], v3, s[8:11], s36 offen offset:0 nt
    buffer_load_dwordx4 a[164:167], v3, s[8:11], s36 offen offset:256 nt
    buffer_load_dwordx4 a[168:171], v3, s[8:11], s36 offen offset:512 nt
    buffer_load_dwordx4 a[172:175], v3, s[8:11], s36 offen offset:768 nt
    buffer_load_dwordx4 a[176:179], v3, s[8:11], s36 offen offset:1024 nt
    s_add_u32 s36, s36, 5120
    buffer_load_dwordx4 a[180:183], v3, s[8:11], s36 offen offset:0 nt
    buffer_load_dwordx4 a[184:187], v3, s[8:11], s36 offen offset:256 nt
    buffer_load_dwordx4 a[188:191], v3, s[8:11], s36 offen offset:512 nt
    v_and_b32 v28, 1, v0
    v_mov_b32 v29, 0xffff
    v_mov_b32 v30, 0xffff0000
    v_cmp_eq_u32 vcc, 1, v28
    s_nop 1
    v_cndmask_b32 v29, v29, v30, vcc
    v_lshrrev_b32 v28, 1, v2
    v_cmp_eq_u32 vcc, 0, v28
    s_nop 1
    v_cndmask_b32 v4, 0, v29, vcc
    v_cmp_eq_u32 vcc, 1, v28
    s_nop 1
    v_cndmask_b32 v5, 0, v29, vcc
    v_cmp_eq_u32 vcc, 2, v28
    s_nop 1
    v_cndmask_b32 v6, 0, v29, vcc
    v_cmp_eq_u32 vcc, 3, v28
    s_nop 1
    v_cndmask_b32 v7, 0, v29, vcc
    v_and_b32 v28, 3, v28
    v_cmp_eq_u32 vcc, 0, v28
    s_nop 1
    v_cndmask_b32 v8, 0, v29, vcc
    v_cmp_eq_u32 vcc, 1, v28
    s_nop 1
    v_cndmask_b32 v9, 0, v29, vcc
    v_cmp_eq_u32 vcc, 2, v28
    s_nop 1
    v_cndmask_b32 v10, 0, v29, vcc
    v_cmp_eq_u32 vcc, 3, v28
    s_nop 1
    v_cndmask_b32 v11, 0, v29, vcc
    v_and_b32 v28, 7, v2
    v_lshlrev_b32 v13, 5, v28
    v_and_b32 v28, 1, v1
    v_lshlrev_b32 v28, 4, v28
    v_add_u32 v13, v13, v28
    v_lshrrev_b32 v28, 1, v1
    v_lshlrev_b32 v28, 8, v28
    v_add_u32 v13, v13, v28
    s_lshl_b32 s74, s3, 9
    v_add_u32 v13, s74, v13
    v_add_u32 v14, s39, v15
    s_mul_i32 s68, s3, 1280
    s_mov_b32 s63, 0
    s_mov_b64 s[70:71], -1
    s_mov_b32 s72, 0
L_c_loop:
    s_cmp_ge_u32 s63, 2
    s_cbranch_scc1 L_c_inst
    s_mov_b32 s65, s63
    s_mov_b32 s66, 1
    s_mov_b32 s28, 0
    s_cmp_eq_u32 s63, 0
    s_cbranch_scc0 L_c_x01
    s_waitcnt vmcnt(51)
    s_branch L_c_s4
L_c_x01:
    v_mov_b32 v160, v152
    v_mov_b32 v161, v153
    v_mov_b32 v162, v154
    v_mov_b32 v163, v155
    v_mov_b32 v164, v156
    v_mov_b32 v165, v157
    v_mov_b32 v166, v158
    v_mov_b32 v167, v159
    s_nop 0
    s_branch L_c_s4
L_c_inst:
    s_and_b32 s66, s63, 1
    s_sub_u32 s65, s63, 2
    s_lshr_b32 s65, s65, 1
    s_lshl_b32 s64, s66, 1
    s_add_u32 s64, s64, s65
    s_mul_i32 s29, s64, 458752
    s_mul_i32 s74, s62, 14336
    s_add_u32 s29, s29, s74
    s_lshl_b32 s74, s3, 7
    s_add_u32 s29, s29, s74
    v_lshrrev_b32 v42, 3, v0
    v_lshlrev_b32 v40, 9, v42
    v_and_b32 v41, 7, v0
    v_lshlrev_b32 v41, 4, v41
    v_add_u32 v40, v40, v41
    v_and_b32 v41, 0x7ff, v40
    s_add_u32 s31, s29, 4096
    s_add_u32 s32, s29, 8192
    s_add_u32 s33, s29, 12288
    s_mov_b32 s82, 0x0c0c0400
    v_mov_b32 v128, -1
    v_mov_b32 v129, -1
    v_mov_b32 v130, -1
    v_mov_b32 v131, -1
    v_mov_b32 v132, -1
    v_mov_b32 v133, -1
    v_mov_b32 v134, -1
    v_mov_b32 v135, -1
    v_mov_b32 v136, -1
    v_mov_b32 v137, -1
    v_mov_b32 v138, -1
    v_mov_b32 v139, -1
    v_mov_b32 v140, -1
    v_mov_b32 v141, -1
    v_mov_b32 v142, -1
    v_mov_b32 v143, -1
    s_mov_b32 s73, 0
    s_nop 0
L_pl_17:
    buffer_load_dwordx4 v[128:131], v40, s[24:27], s29 offen sc1
    buffer_load_dwordx4 v[132:135], v40, s[24:27], s31 offen sc1
    buffer_load_dwordx4 v[136:139], v40, s[24:27], s32 offen sc1
    buffer_load_dwordx4 v[140:143], v41, s[24:27], s33 offen sc1
    s_waitcnt vmcnt(0)
    v_max3_u32 v43, v128, v129, v130
    v_max3_u32 v43, v43, v131, v132
    v_max3_u32 v43, v43, v133, v134
    v_max3_u32 v43, v43, v135, v136
    v_max3_u32 v43, v43, v137, v138
    v_max3_u32 v43, v43, v139, v140
    v_max3_u32 v43, v43, v141, v142
    v_max_u32 v43, v43, v143
    v_cmp_eq_u32 vcc, -1, v43
    s_add_u32 s73, s73, 1
    s_cmp_gt_u32 s73, 60000
    s_nop 1
    s_cbranch_scc1 L_pd_18
    s_cbranch_vccnz L_pl_17
L_pd_18:
    v_perm_b32 v36, v129, v128, s82
    v_perm_b32 v32, v131, v130, s82
    v_perm_b32 v37, v133, v132, s82
    v_perm_b32 v33, v135, v134, s82
    v_perm_b32 v38, v137, v136, s82
    v_perm_b32 v34, v139, v138, s82
    v_perm_b32 v39, v141, v140, s82
    v_perm_b32 v35, v143, v142, s82
    v_lshl_or_b32 v36, v32, 16, v36
    v_lshl_or_b32 v37, v33, 16, v37
    v_lshl_or_b32 v38, v34, 16, v38
    v_lshl_or_b32 v39, v35, 16, v39
    s_mov_b32 exec_lo, 0x0
    s_mov_b32 exec_hi, 0xffffffff
    v_mov_b32 v39, 0xff800000
    s_mov_b64 exec, -1
    v_max_f32 v43, v36, v37
    v_max3_f32 v43, v43, v38, v39
    s_nop 1
    v_max_f32_dpp v43, v43, v43 row_ror:8 row_mask:0xf bank_mask:0xf
    v_mov_b32 v44, v43
    s_nop 1
    v_permlane16_swap_b32 v43, v44
    v_max_f32 v43, v43, v44
    v_mov_b32 v44, v43
    s_nop 1
    v_permlane32_swap_b32 v43, v44
    v_max_f32 v43, v43, v44
    v_sub_f32 v32, v36, v43
    v_mul_f32 v32, 0x3fb8aa3b, v32
    v_exp_f32 v32, v32
    v_sub_f32 v33, v37, v43
    v_mul_f32 v33, 0x3fb8aa3b, v33
    v_exp_f32 v33, v33
    v_sub_f32 v34, v38, v43
    v_mul_f32 v34, 0x3fb8aa3b, v34
    v_exp_f32 v34, v34
    v_sub_f32 v35, v39, v43
    v_mul_f32 v35, 0x3fb8aa3b, v35
    v_exp_f32 v35, v35
    v_add_f32 v45, v32, v33
    v_add_f32 v44, v34, v35
    v_add_f32 v45, v45, v44
    v_mul_f32 v16, v32, v128
    v_fmac_f32 v16, v33, v132
    v_fmac_f32 v16, v34, v136
    v_fmac_f32 v16, v35, v140
    v_mul_f32 v17, v32, v129
    v_fmac_f32 v17, v33, v133
    v_fmac_f32 v17, v34, v137
    v_fmac_f32 v17, v35, v141
    v_mul_f32 v18, v32, v130
    v_fmac_f32 v18, v33, v134
    v_fmac_f32 v18, v34, v138
    v_fmac_f32 v18, v35, v142
    v_mul_f32 v19, v32, v131
    v_fmac_f32 v19, v33, v135
    v_fmac_f32 v19, v34, v139
    v_fmac_f32 v19, v35, v143
    v_add_f32_dpp v45, v45, v45 row_ror:8 row_mask:0xf bank_mask:0xf
    v_mov_b32 v44, v45
    s_nop 1
    v_permlane16_swap_b32 v45, v44
    v_add_f32 v45, v45, v44
    v_mov_b32 v44, v45
    s_nop 1
    v_permlane32_swap_b32 v45, v44
    v_add_f32 v45, v45, v44
    v_add_f32_dpp v16, v16, v16 row_ror:8 row_mask:0xf bank_mask:0xf
    v_add_f32_dpp v17, v17, v17 row_ror:8 row_mask:0xf bank_mask:0xf
    v_add_f32_dpp v18, v18, v18 row_ror:8 row_mask:0xf bank_mask:0xf
    v_add_f32_dpp v19, v19, v19 row_ror:8 row_mask:0xf bank_mask:0xf
    v_mov_b32 v20, v16
    v_mov_b32 v21, v17
    v_mov_b32 v22, v18
    v_mov_b32 v23, v19
    v_permlane16_swap_b32 v16, v20
    v_permlane16_swap_b32 v17, v21
    v_permlane16_swap_b32 v18, v22
    v_permlane16_swap_b32 v19, v23
    v_add_f32 v16, v16, v20
    v_add_f32 v17, v17, v21
    v_add_f32 v18, v18, v22
    v_add_f32 v19, v19, v23
    v_mov_b32 v20, v16
    v_mov_b32 v21, v17
    v_mov_b32 v22, v18
    v_mov_b32 v23, v19
    v_permlane32_swap_b32 v16, v20
    v_permlane32_swap_b32 v17, v21
    v_permlane32_swap_b32 v18, v22
    v_permlane32_swap_b32 v19, v23
    v_rcp_f32 v45, v45
    v_add_f32 v16, v16, v20
    v_add_f32 v17, v17, v21
    v_add_f32 v18, v18, v22
    v_add_f32 v19, v19, v23
    v_mov_b32 v24, v16
    s_nop 1
    v_mov_b32_dpp v24, v17 quad_perm:[0,1,2,3] row_mask:0x2 bank_mask:0xf
    s_nop 1
    v_mov_b32_dpp v24, v18 quad_perm:[0,1,2,3] row_mask:0x4 bank_mask:0xf
    s_nop 1
    v_mov_b32_dpp v24, v19 quad_perm:[0,1,2,3] row_mask:0x8 bank_mask:0xf
    v_mul_f32 v24, v24, v45
    v_cvt_pk_bf16_f32 v24, v24, v24
    s_nop 1
    v_and_b32_dpp v56, v24, v4 row_newbcast:0 row_mask:0xf bank_mask:0xf
    v_and_b32_dpp v57, v24, v5 row_newbcast:0 row_mask:0xf bank_mask:0xf
    v_and_b32_dpp v58, v24, v6 row_newbcast:0 row_mask:0xf bank_mask:0xf
    v_and_b32_dpp v59, v24, v7 row_newbcast:0 row_mask:0xf bank_mask:0xf
    s_nop 1
    v_mfma_f32_16x16x32_bf16 v[28:31], v[56:59], a[160:163], 0
    v_mfma_f32_16x16x32_bf16 v[32:35], v[56:59], a[164:167], 0
    v_mfma_f32_16x16x32_bf16 v[36:39], v[56:59], a[168:171], 0
    v_mfma_f32_16x16x32_bf16 v[40:43], v[56:59], a[172:175], 0
    v_mfma_f32_16x16x32_bf16 v[44:47], v[56:59], a[176:179], 0
    v_and_b32_dpp v60, v24, v4 row_newbcast:1 row_mask:0xf bank_mask:0xf
    v_and_b32_dpp v61, v24, v5 row_newbcast:1 row_mask:0xf bank_mask:0xf
    v_and_b32_dpp v62, v24, v6 row_newbcast:1 row_mask:0xf bank_mask:0xf
    v_and_b32_dpp v63, v24, v7 row_newbcast:1 row_mask:0xf bank_mask:0xf
    s_nop 1
    v_mfma_f32_16x16x32_bf16 v[28:31], v[60:63], a[180:183], v[28:31]
    v_mfma_f32_16x16x32_bf16 v[32:35], v[60:63], a[184:187], v[32:35]
    v_mfma_f32_16x16x32_bf16 v[36:39], v[60:63], a[188:191], v[36:39]
    v_mfma_f32_16x16x32_bf16 v[40:43], v[60:63], a[192:195], v[40:43]
    v_mfma_f32_16x16x32_bf16 v[44:47], v[60:63], a[196:199], v[44:47]
    v_and_b32_dpp v56, v24, v4 row_newbcast:2 row_mask:0xf bank_mask:0xf
    v_and_b32_dpp v57, v24, v5 row_newbcast:2 row_mask:0xf bank_mask:0xf
    v_and_b32_dpp v58, v24, v6 row_newbcast:2 row_mask:0xf bank_mask:0xf
    v_and_b32_dpp v59, v24, v7 row_newbcast:2 row_mask:0xf bank_mask:0xf
    s_nop 1
    v_mfma_f32_16x16x32_bf16 v[28:31], v[56:59], a[200:203], v[28:31]
    v_mfma_f32_16x16x32_bf16 v[32:35], v[56:59], a[204:207], v[32:35]
    v_mfma_f32_16x16x32_bf16 v[36:39], v[56:59], a[208:211], v[36:39]
    v_mfma_f32_16x16x32_bf16 v[40:43], v[56:59], a[212:215], v[40:43]
    v_mfma_f32_16x16x32_bf16 v[44:47], v[56:59], a[216:219], v[44:47]
    v_and_b32_dpp v60, v24, v4 row_newbcast:3 row_mask:0xf bank_mask:0xf
    v_and_b32_dpp v61, v24, v5 row_newbcast:3 row_mask:0xf bank_mask:0xf
    v_and_b32_dpp v62, v24, v6 row_newbcast:3 row_mask:0xf bank_mask:0xf
    v_and_b32_dpp v63, v24, v7 row_newbcast:3 row_mask:0xf bank_mask:0xf
    s_nop 1
    v_mfma_f32_16x16x32_bf16 v[28:31], v[60:63], a[220:223], v[28:31]
    v_mfma_f32_16x16x32_bf16 v[32:35], v[60:63], a[224:227], v[32:35]
    v_mfma_f32_16x16x32_bf16 v[36:39], v[60:63], a[228:231], v[36:39]
    v_mfma_f32_16x16x32_bf16 v[40:43], v[60:63], a[232:235], v[40:43]
    v_mfma_f32_16x16x32_bf16 v[44:47], v[60:63], a[236:239], v[44:47]
    v_and_b32_dpp v56, v24, v4 row_newbcast:4 row_mask:0xf bank_mask:0xf
    v_and_b32_dpp v57, v24, v5 row_newbcast:4 row_mask:0xf bank_mask:0xf
    v_and_b32_dpp v58, v24, v6 row_newbcast:4 row_mask:0xf bank_mask:0xf
    v_and_b32_dpp v59, v24, v7 row_newbcast:4 row_mask:0xf bank_mask:0xf
    s_nop 1
    v_mfma_f32_16x16x32_bf16 v[28:31], v[56:59], a[240:243], v[28:31]
    v_mfma_f32_16x16x32_bf16 v[32:35], v[56:59], a[244:247], v[32:35]
    v_mfma_f32_16x16x32_bf16 v[36:39], v[56:59], a[248:251], v[36:39]
    v_mfma_f32_16x16x32_bf16 v[40:43], v[56:59], a[252:255], v[40:43]
    v_mfma_f32_16x16x32_bf16 v[44:47], v[56:59], v[64:67], v[44:47]
    v_and_b32_dpp v60, v24, v4 row_newbcast:5 row_mask:0xf bank_mask:0xf
    v_and_b32_dpp v61, v24, v5 row_newbcast:5 row_mask:0xf bank_mask:0xf
    v_and_b32_dpp v62, v24, v6 row_newbcast:5 row_mask:0xf bank_mask:0xf
    v_and_b32_dpp v63, v24, v7 row_newbcast:5 row_mask:0xf bank_mask:0xf
    s_nop 1
    v_mfma_f32_16x16x32_bf16 v[28:31], v[60:63], v[68:71], v[28:31]
    v_mfma_f32_16x16x32_bf16 v[32:35], v[60:63], v[72:75], v[32:35]
    v_mfma_f32_16x16x32_bf16 v[36:39], v[60:63], v[76:79], v[36:39]
    v_mfma_f32_16x16x32_bf16 v[40:43], v[60:63], v[80:83], v[40:43]
    v_mfma_f32_16x16x32_bf16 v[44:47], v[60:63], v[84:87], v[44:47]
    v_and_b32_dpp v56, v24, v4 row_newbcast:6 row_mask:0xf bank_mask:0xf
    v_and_b32_dpp v57, v24, v5 row_newbcast:6 row_mask:0xf bank_mask:0xf
    v_and_b32_dpp v58, v24, v6 row_newbcast:6 row_mask:0xf bank_mask:0xf
    v_and_b32_dpp v59, v24, v7 row_newbcast:6 row_mask:0xf bank_mask:0xf
    s_nop 1
    v_mfma_f32_16x16x32_bf16 v[28:31], v[56:59], v[88:91], v[28:31]
    v_mfma_f32_16x16x32_bf16 v[32:35], v[56:59], v[92:95], v[32:35]
    v_mfma_f32_16x16x32_bf16 v[36:39], v[56:59], v[96:99], v[36:39]
    v_mfma_f32_16x16x32_bf16 v[40:43], v[56:59], v[100:103], v[40:43]
    v_mfma_f32_16x16x32_bf16 v[44:47], v[56:59], v[104:107], v[44:47]
    v_and_b32_dpp v60, v24, v4 row_newbcast:7 row_mask:0xf bank_mask:0xf
    v_and_b32_dpp v61, v24, v5 row_newbcast:7 row_mask:0xf bank_mask:0xf
    v_and_b32_dpp v62, v24, v6 row_newbcast:7 row_mask:0xf bank_mask:0xf
    v_and_b32_dpp v63, v24, v7 row_newbcast:7 row_mask:0xf bank_mask:0xf
    s_nop 1
    v_mfma_f32_16x16x32_bf16 v[28:31], v[60:63], v[108:111], v[28:31]
    v_mfma_f32_16x16x32_bf16 v[32:35], v[60:63], v[112:115], v[32:35]
    v_mfma_f32_16x16x32_bf16 v[36:39], v[60:63], v[116:119], v[36:39]
    v_mfma_f32_16x16x32_bf16 v[40:43], v[60:63], v[120:123], v[40:43]
    v_mfma_f32_16x16x32_bf16 v[44:47], v[60:63], v[124:127], v[44:47]
    v_and_b32 v16, 0xf0, v15
    v_lshlrev_b32 v16, 1, v16
    v_and_b32 v17, 16, v0
    v_add_u32 v16, v16, v17
    s_mul_i32 s74, s3, 2560
    v_add_u32 v16, s74, v16
    s_mov_b32 exec_lo, 0xffffffff
    s_mov_b32 exec_hi, 0x0
    ds_write_b128 v16, v[28:31] offset:5632
    ds_write_b128 v16, v[32:35] offset:6144
    ds_write_b128 v16, v[36:39] offset:6656
    ds_write_b128 v16, v[40:43] offset:7168
    ds_write_b128 v16, v[44:47] offset:7680
    s_mov_b64 exec, -1
    s_waitcnt lgkmcnt(0)
    s_barrier
    s_mul_i32 s74, s3, 640
    v_add_u32 v16, s74, v15
    s_mov_b32 exec_lo, 0xffffffff
    s_mov_b32 exec_hi, 0xff
    ds_read_b128 v[20:23], v16 offset:5632
    ds_read_b128 v[24:27], v16 offset:8192
    ds_read_b128 v[28:31], v16 offset:10752
    ds_read_b128 v[32:35], v16 offset:13312
    s_mul_i32 s75, s64, 81920
    s_mul_i32 s76, s62, 2560
    s_add_u32 s75, s75, s76
    s_add_u32 s75, s75, 1867776
    s_waitcnt lgkmcnt(0)
    v_add_f32 v20, v20, v24
    v_add_f32 v28, v28, v32
    v_add_f32 v21, v21, v25
    v_add_f32 v29, v29, v33
    v_add_f32 v22, v22, v26
    v_add_f32 v30, v30, v34
    v_add_f32 v23, v23, v27
    v_add_f32 v31, v31, v35
    v_add_f32 v20, v20, v28
    v_add_f32 v21, v21, v29
    v_add_f32 v22, v22, v30
    v_add_f32 v23, v23, v31
    buffer_store_dwordx4 v[20:23], v16, s[24:27], s75 offen sc1
    s_mov_b64 exec, -1
    s_mul_i32 s34, s64, 1280
    s_add_u32 s34, s34, 2228224
    s_cmp_eq_u32 s69, 1
    s_cbranch_scc1 L_c_s3
    v_and_b32 v24, 0xf0, v15
    v_mov_b32 v152, -1
    v_mov_b32 v153, -1
    v_mov_b32 v154, -1
    v_mov_b32 v155, -1
    v_mov_b32 v156, -1
    v_mov_b32 v157, -1
    v_mov_b32 v158, -1
    v_mov_b32 v159, -1
    s_mov_b32 s73, 0
    s_nop 0
L_pl_19:
    buffer_load_dwordx4 v[152:155], v15, s[24:27], s34 offen sc1
    buffer_load_dwordx4 v[156:159], v24, s[24:27], s34 offen offset:1024 sc1
    s_waitcnt vmcnt(0)
    v_max3_u32 v25, v152, v153, v154
    v_max3_u32 v25, v25, v155, v156
    v_max3_u32 v25, v25, v157, v158
    v_max_u32 v25, v25, v159
    v_cmp_eq_u32 vcc, -1, v25
    s_add_u32 s73, s73, 1
    s_cmp_gt_u32 s73, 60000
    s_nop 1
    s_cbranch_scc1 L_pd_20
    s_cbranch_vccnz L_pl_19
L_pd_20:
    v_lshlrev_b32 v24, 16, v152
    v_and_b32 v25, 0xffff0000, v152
    v_lshlrev_b32 v26, 16, v153
    v_and_b32 v27, 0xffff0000, v153
    v_lshlrev_b32 v28, 16, v154
    v_and_b32 v29, 0xffff0000, v154
    v_lshlrev_b32 v30, 16, v155
    v_and_b32 v31, 0xffff0000, v155
    v_mov_b32 v32, 0
    v_mov_b32 v33, 0
    v_mov_b32 v34, 0
    v_mov_b32 v35, 0
    v_mov_b32 v36, 0
    v_mov_b32 v37, 0
    v_mov_b32 v38, 0
    v_mov_b32 v39, 0
    s_mov_b32 exec_lo, 0xffff
    s_mov_b32 exec_hi, 0x0
    v_lshlrev_b32 v32, 16, v156
    v_and_b32 v33, 0xffff0000, v156
    v_lshlrev_b32 v34, 16, v157
    v_and_b32 v35, 0xffff0000, v157
    v_lshlrev_b32 v36, 16, v158
    v_and_b32 v37, 0xffff0000, v158
    v_lshlrev_b32 v38, 16, v159
    v_and_b32 v39, 0xffff0000, v159
    s_mov_b64 exec, -1
    v_pk_add_f32 v[40:41], v[24:25], v[26:27]
    v_pk_add_f32 v[42:43], v[28:29], v[30:31]
    v_pk_add_f32 v[40:41], v[40:41], v[32:33]
    v_pk_add_f32 v[42:43], v[42:43], v[34:35]
    v_pk_add_f32 v[40:41], v[40:41], v[36:37]
    v_pk_add_f32 v[42:43], v[42:43], v[38:39]
    v_pk_add_f32 v[40:41], v[40:41], v[42:43]
    v_add_f32 v44, v40, v41
    s_nop 1
    v_add_f32_dpp v44, v44, v44 quad_perm:[1,0,3,2] row_mask:0xf bank_mask:0xf
    s_nop 1
    v_add_f32_dpp v44, v44, v44 quad_perm:[2,3,0,1] row_mask:0xf bank_mask:0xf
    s_nop 1
    v_add_f32_dpp v44, v44, v44 row_ror:4 row_mask:0xf bank_mask:0xf
    s_nop 1
    v_add_f32_dpp v44, v44, v44 row_ror:8 row_mask:0xf bank_mask:0xf
    v_mov_b32 v40, v44
    s_nop 1
    v_permlane16_swap_b32 v44, v40
    v_add_f32 v44, v44, v40
    v_mov_b32 v40, v44
    s_nop 1
    v_permlane32_swap_b32 v44, v40
    v_add_f32 v44, v44, v40
    v_mul_f32 v44, 0x3acccccd, v44
    v_sub_f32 v46, 0, v44
    v_sub_f32 v47, 0, v44
    v_mov_b32 v40, 0
    v_mov_b32 v41, 0
    v_mov_b32 v42, 0
    v_mov_b32 v43, 0
    v_pk_add_f32 v[48:49], v[24:25], v[46:47]
    v_pk_fma_f32 v[40:41], v[48:49], v[48:49], v[40:41]
    v_pk_add_f32 v[50:51], v[26:27], v[46:47]
    v_pk_fma_f32 v[42:43], v[50:51], v[50:51], v[42:43]
    v_pk_add_f32 v[48:49], v[28:29], v[46:47]
    v_pk_fma_f32 v[40:41], v[48:49], v[48:49], v[40:41]
    v_pk_add_f32 v[50:51], v[30:31], v[46:47]
    v_pk_fma_f32 v[42:43], v[50:51], v[50:51], v[42:43]
    s_mov_b32 exec_lo, 0xffff
    s_mov_b32 exec_hi, 0x0
    v_pk_add_f32 v[48:49], v[32:33], v[46:47]
    v_pk_fma_f32 v[40:41], v[48:49], v[48:49], v[40:41]
    v_pk_add_f32 v[50:51], v[34:35], v[46:47]
    v_pk_fma_f32 v[42:43], v[50:51], v[50:51], v[42:43]
    v_pk_add_f32 v[48:49], v[36:37], v[46:47]
    v_pk_fma_f32 v[40:41], v[48:49], v[48:49], v[40:41]
    v_pk_add_f32 v[50:51], v[38:39], v[46:47]
    v_pk_fma_f32 v[42:43], v[50:51], v[50:51], v[42:43]
    s_mov_b64 exec, -1
    v_pk_add_f32 v[40:41], v[40:41], v[42:43]
    v_add_f32 v45, v40, v41
    s_nop 1
    v_add_f32_dpp v45, v45, v45 quad_perm:[1,0,3,2] row_mask:0xf bank_mask:0xf
    s_nop 1
    v_add_f32_dpp v45, v45, v45 quad_perm:[2,3,0,1] row_mask:0xf bank_mask:0xf
    s_nop 1
    v_add_f32_dpp v45, v45, v45 row_ror:4 row_mask:0xf bank_mask:0xf
    s_nop 1
    v_add_f32_dpp v45, v45, v45 row_ror:8 row_mask:0xf bank_mask:0xf
    v_mov_b32 v40, v45
    s_nop 1
    v_permlane16_swap_b32 v45, v40
    v_add_f32 v45, v45, v40
    v_mov_b32 v40, v45
    s_nop 1
    v_permlane32_swap_b32 v45, v40
    v_add_f32 v45, v45, v40
    v_mul_f32 v45, 0x3acccccd, v45
    v_cvt_pk_bf16_f32 v45, v45, v45
    v_and_b32 v45, 0xffff0000, v45
    v_add_f32 v45, 0x3727c5ac, v45
    v_cvt_pk_bf16_f32 v45, v45, v45
    v_and_b32 v45, 0xffff0000, v45
    v_sqrt_f32 v45, v45
    s_nop 0
    v_cvt_pk_bf16_f32 v45, v45, v45
    v_and_b32 v45, 0xffff0000, v45
    v_rcp_f32 v40, v45
    v_cvt_pk_bf16_f32 v44, v44, v44
    v_and_b32 v44, 0xffff0000, v44
    v_mov_b32 v41, v40
    v_sub_f32 v46, 0, v44
    v_sub_f32 v47, 0, v44
    v_pk_add_f32 v[24:25], v[24:25], v[46:47]
    v_pk_add_f32 v[26:27], v[26:27], v[46:47]
    v_pk_add_f32 v[28:29], v[28:29], v[46:47]
    v_pk_add_f32 v[30:31], v[30:31], v[46:47]
    v_pk_add_f32 v[32:33], v[32:33], v[46:47]
    v_pk_add_f32 v[34:35], v[34:35], v[46:47]
    v_pk_add_f32 v[36:37], v[36:37], v[46:47]
    v_pk_add_f32 v[38:39], v[38:39], v[46:47]
    v_cvt_pk_bf16_f32 v16, v24, v25
    v_cvt_pk_bf16_f32 v17, v26, v27
    v_cvt_pk_bf16_f32 v18, v28, v29
    v_cvt_pk_bf16_f32 v19, v30, v31
    v_cvt_pk_bf16_f32 v20, v32, v33
    v_cvt_pk_bf16_f32 v21, v34, v35
    v_cvt_pk_bf16_f32 v22, v36, v37
    v_cvt_pk_bf16_f32 v23, v38, v39
    v_lshlrev_b32 v24, 16, v16
    v_and_b32 v25, 0xffff0000, v16
    v_lshlrev_b32 v26, 16, v17
    v_and_b32 v27, 0xffff0000, v17
    v_lshlrev_b32 v28, 16, v18
    v_and_b32 v29, 0xffff0000, v18
    v_lshlrev_b32 v30, 16, v19
    v_and_b32 v31, 0xffff0000, v19
    v_lshlrev_b32 v32, 16, v20
    v_and_b32 v33, 0xffff0000, v20
    v_lshlrev_b32 v34, 16, v21
    v_and_b32 v35, 0xffff0000, v21
    v_lshlrev_b32 v36, 16, v22
    v_and_b32 v37, 0xffff0000, v22
    v_lshlrev_b32 v38, 16, v23
    v_and_b32 v39, 0xffff0000, v23
    v_pk_mul_f32 v[24:25], v[24:25], v[40:41]
    v_pk_mul_f32 v[26:27], v[26:27], v[40:41]
    v_pk_mul_f32 v[28:29], v[28:29], v[40:41]
    v_pk_mul_f32 v[30:31], v[30:31], v[40:41]
    v_pk_mul_f32 v[32:33], v[32:33], v[40:41]
    v_pk_mul_f32 v[34:35], v[34:35], v[40:41]
    v_pk_mul_f32 v[36:37], v[36:37], v[40:41]
    v_pk_mul_f32 v[38:39], v[38:39], v[40:41]
    v_cvt_pk_bf16_f32 v16, v24, v25
    v_cvt_pk_bf16_f32 v17, v26, v27
    v_cvt_pk_bf16_f32 v18, v28, v29
    v_cvt_pk_bf16_f32 v19, v30, v31
    v_cvt_pk_bf16_f32 v20, v32, v33
    v_cvt_pk_bf16_f32 v21, v34, v35
    v_cvt_pk_bf16_f32 v22, v36, v37
    v_cvt_pk_bf16_f32 v23, v38, v39
    v_add_u32 v40, s68, v15
    ds_write_b128 v40, v[16:19]
    s_mov_b32 exec_lo, 0xffff
    s_mov_b32 exec_hi, 0x0
    ds_write_b128 v40, v[20:23] offset:1024
    s_mov_b64 exec, -1
    v_and_b32 v16, 3, v0
    v_lshlrev_b32 v16, 4, v16
    v_bfe_u32 v17, v0, 3, 1
    v_lshlrev_b32 v17, 3, v17
    v_add_u32 v16, v16, v17
    v_lshrrev_b32 v17, 4, v0
    v_lshlrev_b32 v17, 1, v17
    v_add_u32 v16, v16, v17
    s_mul_i32 s74, s3, 320
    s_add_u32 s74, s74, s68
    v_add_u32 v16, s74, v16
    s_waitcnt lgkmcnt(0)
    ds_read_u16 v20, v16 offset:0
    ds_read_u16 v21, v16 offset:64
    ds_read_u16 v22, v16 offset:128
    ds_read_u16 v23, v16 offset:192
    ds_read_u16 v24, v16 offset:256
    s_waitcnt lgkmcnt(4)
    v_lshl_or_b32 v20, v20, 16, v20
    s_waitcnt lgkmcnt(3)
    v_lshl_or_b32 v21, v21, 16, v21
    s_waitcnt lgkmcnt(2)
    v_lshl_or_b32 v22, v22, 16, v22
    s_waitcnt lgkmcnt(1)
    v_lshl_or_b32 v23, v23, 16, v23
    s_waitcnt lgkmcnt(0)
    v_lshl_or_b32 v24, v24, 16, v24
    v_and_b32_dpp v56, v20, v8 quad_perm:[0,0,0,0] row_mask:0xf bank_mask:0xf
    v_and_b32_dpp v57, v20, v9 quad_perm:[0,0,0,0] row_mask:0xf bank_mask:0xf
    v_and_b32_dpp v58, v20, v10 quad_perm:[0,0,0,0] row_mask:0xf bank_mask:0xf
    v_and_b32_dpp v59, v20, v11 quad_perm:[0,0,0,0] row_mask:0xf bank_mask:0xf
    s_nop 1
    v_mfma_f32_16x16x32_bf16 v[28:31], v[56:59], v[168:171], 0
    v_and_b32_dpp v60, v20, v8 quad_perm:[1,1,1,1] row_mask:0xf bank_mask:0xf
    v_and_b32_dpp v61, v20, v9 quad_perm:[1,1,1,1] row_mask:0xf bank_mask:0xf
    v_and_b32_dpp v62, v20, v10 quad_perm:[1,1,1,1] row_mask:0xf bank_mask:0xf
    v_and_b32_dpp v63, v20, v11 quad_perm:[1,1,1,1] row_mask:0xf bank_mask:0xf
    s_nop 1
    v_mfma_f32_16x16x32_bf16 v[32:35], v[60:63], v[172:175], 0
    v_and_b32_dpp v56, v20, v8 quad_perm:[2,2,2,2] row_mask:0xf bank_mask:0xf
    v_and_b32_dpp v57, v20, v9 quad_perm:[2,2,2,2] row_mask:0xf bank_mask:0xf
    v_and_b32_dpp v58, v20, v10 quad_perm:[2,2,2,2] row_mask:0xf bank_mask:0xf
    v_and_b32_dpp v59, v20, v11 quad_perm:[2,2,2,2] row_mask:0xf bank_mask:0xf
    s_nop 1
    v_mfma_f32_16x16x32_bf16 v[28:31], v[56:59], v[176:179], v[28:31]
    v_and_b32_dpp v60, v20, v8 quad_perm:[3,3,3,3] row_mask:0xf bank_mask:0xf
    v_and_b32_dpp v61, v20, v9 quad_perm:[3,3,3,3] row_mask:0xf bank_mask:0xf
    v_and_b32_dpp v62, v20, v10 quad_perm:[3,3,3,3] row_mask:0xf bank_mask:0xf
    v_and_b32_dpp v63, v20, v11 quad_perm:[3,3,3,3] row_mask:0xf bank_mask:0xf
    s_nop 1
    v_mfma_f32_16x16x32_bf16 v[32:35], v[60:63], v[180:183], v[32:35]
    v_and_b32_dpp v56, v21, v8 quad_perm:[0,0,0,0] row_mask:0xf bank_mask:0xf
    v_and_b32_dpp v57, v21, v9 quad_perm:[0,0,0,0] row_mask:0xf bank_mask:0xf
    v_and_b32_dpp v58, v21, v10 quad_perm:[0,0,0,0] row_mask:0xf bank_mask:0xf
    v_and_b32_dpp v59, v21, v11 quad_perm:[0,0,0,0] row_mask:0xf bank_mask:0xf
    s_nop 1
    v_mfma_f32_16x16x32_bf16 v[28:31], v[56:59], v[184:187], v[28:31]
    v_and_b32_dpp v60, v21, v8 quad_perm:[1,1,1,1] row_mask:0xf bank_mask:0xf
    v_and_b32_dpp v61, v21, v9 quad_perm:[1,1,1,1] row_mask:0xf bank_mask:0xf
    v_and_b32_dpp v62, v21, v10 quad_perm:[1,1,1,1] row_mask:0xf bank_mask:0xf
    v_and_b32_dpp v63, v21, v11 quad_perm:[1,1,1,1] row_mask:0xf bank_mask:0xf
    s_nop 1
    v_mfma_f32_16x16x32_bf16 v[32:35], v[60:63], v[188:191], v[32:35]
    v_and_b32_dpp v56, v21, v8 quad_perm:[2,2,2,2] row_mask:0xf bank_mask:0xf
    v_and_b32_dpp v57, v21, v9 quad_perm:[2,2,2,2] row_mask:0xf bank_mask:0xf
    v_and_b32_dpp v58, v21, v10 quad_perm:[2,2,2,2] row_mask:0xf bank_mask:0xf
    v_and_b32_dpp v59, v21, v11 quad_perm:[2,2,2,2] row_mask:0xf bank_mask:0xf
    s_nop 1
    v_mfma_f32_16x16x32_bf16 v[28:31], v[56:59], v[192:195], v[28:31]
    v_and_b32_dpp v60, v21, v8 quad_perm:[3,3,3,3] row_mask:0xf bank_mask:0xf
    v_and_b32_dpp v61, v21, v9 quad_perm:[3,3,3,3] row_mask:0xf bank_mask:0xf
    v_and_b32_dpp v62, v21, v10 quad_perm:[3,3,3,3] row_mask:0xf bank_mask:0xf
    v_and_b32_dpp v63, v21, v11 quad_perm:[3,3,3,3] row_mask:0xf bank_mask:0xf
    s_nop 1
    v_mfma_f32_16x16x32_bf16 v[32:35], v[60:63], v[196:199], v[32:35]
    v_and_b32_dpp v56, v22, v8 quad_perm:[0,0,0,0] row_mask:0xf bank_mask:0xf
    v_and_b32_dpp v57, v22, v9 quad_perm:[0,0,0,0] row_mask:0xf bank_mask:0xf
    v_and_b32_dpp v58, v22, v10 quad_perm:[0,0,0,0] row_mask:0xf bank_mask:0xf
    v_and_b32_dpp v59, v22, v11 quad_perm:[0,0,0,0] row_mask:0xf bank_mask:0xf
    s_nop 1
    v_mfma_f32_16x16x32_bf16 v[28:31], v[56:59], v[200:203], v[28:31]
    v_and_b32_dpp v60, v22, v8 quad_perm:[1,1,1,1] row_mask:0xf bank_mask:0xf
    v_and_b32_dpp v61, v22, v9 quad_perm:[1,1,1,1] row_mask:0xf bank_mask:0xf
    v_and_b32_dpp v62, v22, v10 quad_perm:[1,1,1,1] row_mask:0xf bank_mask:0xf
    v_and_b32_dpp v63, v22, v11 quad_perm:[1,1,1,1] row_mask:0xf bank_mask:0xf
    s_nop 1
    v_mfma_f32_16x16x32_bf16 v[32:35], v[60:63], v[204:207], v[32:35]
    v_and_b32_dpp v56, v22, v8 quad_perm:[2,2,2,2] row_mask:0xf bank_mask:0xf
    v_and_b32_dpp v57, v22, v9 quad_perm:[2,2,2,2] row_mask:0xf bank_mask:0xf
    v_and_b32_dpp v58, v22, v10 quad_perm:[2,2,2,2] row_mask:0xf bank_mask:0xf
    v_and_b32_dpp v59, v22, v11 quad_perm:[2,2,2,2] row_mask:0xf bank_mask:0xf
    s_nop 1
    v_mfma_f32_16x16x32_bf16 v[28:31], v[56:59], v[208:211], v[28:31]
    v_and_b32_dpp v60, v22, v8 quad_perm:[3,3,3,3] row_mask:0xf bank_mask:0xf
    v_and_b32_dpp v61, v22, v9 quad_perm:[3,3,3,3] row_mask:0xf bank_mask:0xf
    v_and_b32_dpp v62, v22, v10 quad_perm:[3,3,3,3] row_mask:0xf bank_mask:0xf
    v_and_b32_dpp v63, v22, v11 quad_perm:[3,3,3,3] row_mask:0xf bank_mask:0xf
    s_nop 1
    v_mfma_f32_16x16x32_bf16 v[32:35], v[60:63], v[212:215], v[32:35]
    v_and_b32_dpp v56, v23, v8 quad_perm:[0,0,0,0] row_mask:0xf bank_mask:0xf
    v_and_b32_dpp v57, v23, v9 quad_perm:[0,0,0,0] row_mask:0xf bank_mask:0xf
    v_and_b32_dpp v58, v23, v10 quad_perm:[0,0,0,0] row_mask:0xf bank_mask:0xf
    v_and_b32_dpp v59, v23, v11 quad_perm:[0,0,0,0] row_mask:0xf bank_mask:0xf
    s_nop 1
    v_mfma_f32_16x16x32_bf16 v[28:31], v[56:59], v[216:219], v[28:31]
    v_and_b32_dpp v60, v23, v8 quad_perm:[1,1,1,1] row_mask:0xf bank_mask:0xf
    v_and_b32_dpp v61, v23, v9 quad_perm:[1,1,1,1] row_mask:0xf bank_mask:0xf
    v_and_b32_dpp v62, v23, v10 quad_perm:[1,1,1,1] row_mask:0xf bank_mask:0xf
    v_and_b32_dpp v63, v23, v11 quad_perm:[1,1,1,1] row_mask:0xf bank_mask:0xf
    s_nop 1
    v_mfma_f32_16x16x32_bf16 v[32:35], v[60:63], v[220:223], v[32:35]
    v_and_b32_dpp v56, v23, v8 quad_perm:[2,2,2,2] row_mask:0xf bank_mask:0xf
    v_and_b32_dpp v57, v23, v9 quad_perm:[2,2,2,2] row_mask:0xf bank_mask:0xf
    v_and_b32_dpp v58, v23, v10 quad_perm:[2,2,2,2] row_mask:0xf bank_mask:0xf
    v_and_b32_dpp v59, v23, v11 quad_perm:[2,2,2,2] row_mask:0xf bank_mask:0xf
    s_nop 1
    v_mfma_f32_16x16x32_bf16 v[28:31], v[56:59], v[224:227], v[28:31]
    v_and_b32_dpp v60, v23, v8 quad_perm:[3,3,3,3] row_mask:0xf bank_mask:0xf
    v_and_b32_dpp v61, v23, v9 quad_perm:[3,3,3,3] row_mask:0xf bank_mask:0xf
    v_and_b32_dpp v62, v23, v10 quad_perm:[3,3,3,3] row_mask:0xf bank_mask:0xf
    v_and_b32_dpp v63, v23, v11 quad_perm:[3,3,3,3] row_mask:0xf bank_mask:0xf
    s_nop 1
    v_mfma_f32_16x16x32_bf16 v[32:35], v[60:63], v[228:231], v[32:35]
    v_and_b32_dpp v56, v24, v8 quad_perm:[0,0,0,0] row_mask:0xf bank_mask:0xf
    v_and_b32_dpp v57, v24, v9 quad_perm:[0,0,0,0] row_mask:0xf bank_mask:0xf
    v_and_b32_dpp v58, v24, v10 quad_perm:[0,0,0,0] row_mask:0xf bank_mask:0xf
    v_and_b32_dpp v59, v24, v11 quad_perm:[0,0,0,0] row_mask:0xf bank_mask:0xf
    s_nop 1
    v_mfma_f32_16x16x32_bf16 v[28:31], v[56:59], v[232:235], v[28:31]
    v_and_b32_dpp v60, v24, v8 quad_perm:[1,1,1,1] row_mask:0xf bank_mask:0xf
    v_and_b32_dpp v61, v24, v9 quad_perm:[1,1,1,1] row_mask:0xf bank_mask:0xf
    v_and_b32_dpp v62, v24, v10 quad_perm:[1,1,1,1] row_mask:0xf bank_mask:0xf
    v_and_b32_dpp v63, v24, v11 quad_perm:[1,1,1,1] row_mask:0xf bank_mask:0xf
    s_nop 1
    v_mfma_f32_16x16x32_bf16 v[32:35], v[60:63], v[236:239], v[32:35]
    v_and_b32_dpp v56, v24, v8 quad_perm:[2,2,2,2] row_mask:0xf bank_mask:0xf
    v_and_b32_dpp v57, v24, v9 quad_perm:[2,2,2,2] row_mask:0xf bank_mask:0xf
    v_and_b32_dpp v58, v24, v10 quad_perm:[2,2,2,2] row_mask:0xf bank_mask:0xf
    v_and_b32_dpp v59, v24, v11 quad_perm:[2,2,2,2] row_mask:0xf bank_mask:0xf
    s_nop 1
    v_mfma_f32_16x16x32_bf16 v[28:31], v[56:59], v[240:243], v[28:31]
    v_and_b32_dpp v60, v24, v8 quad_perm:[3,3,3,3] row_mask:0xf bank_mask:0xf
    v_and_b32_dpp v61, v24, v9 quad_perm:[3,3,3,3] row_mask:0xf bank_mask:0xf
    v_and_b32_dpp v62, v24, v10 quad_perm:[3,3,3,3] row_mask:0xf bank_mask:0xf
    v_and_b32_dpp v63, v24, v11 quad_perm:[3,3,3,3] row_mask:0xf bank_mask:0xf
    s_nop 1
    v_mfma_f32_16x16x32_bf16 v[32:35], v[60:63], v[244:247], v[32:35]
    s_cmp_lt_u32 s62, 5
    s_nop 5
    s_cbranch_scc0 L_c_s2_nob
    ds_read_b128 v[44:47], v14 offset:0
    ds_read_b128 v[48:51], v14 offset:1024
    ds_read_b128 v[52:55], v14 offset:2048
    v_and_b32_dpp v56, v20, v8 quad_perm:[0,0,0,0] row_mask:0xf bank_mask:0xf
    v_and_b32_dpp v57, v20, v9 quad_perm:[0,0,0,0] row_mask:0xf bank_mask:0xf
    v_and_b32_dpp v58, v20, v10 quad_perm:[0,0,0,0] row_mask:0xf bank_mask:0xf
    v_and_b32_dpp v59, v20, v11 quad_perm:[0,0,0,0] row_mask:0xf bank_mask:0xf
    s_nop 1
    v_mfma_f32_16x16x32_bf16 v[36:39], v[56:59], v[248:251], 0
    v_and_b32_dpp v60, v20, v8 quad_perm:[1,1,1,1] row_mask:0xf bank_mask:0xf
    v_and_b32_dpp v61, v20, v9 quad_perm:[1,1,1,1] row_mask:0xf bank_mask:0xf
    v_and_b32_dpp v62, v20, v10 quad_perm:[1,1,1,1] row_mask:0xf bank_mask:0xf
    v_and_b32_dpp v63, v20, v11 quad_perm:[1,1,1,1] row_mask:0xf bank_mask:0xf
    s_nop 1
    v_mfma_f32_16x16x32_bf16 v[40:43], v[60:63], v[252:255], 0
    v_and_b32_dpp v56, v20, v8 quad_perm:[2,2,2,2] row_mask:0xf bank_mask:0xf
    v_and_b32_dpp v57, v20, v9 quad_perm:[2,2,2,2] row_mask:0xf bank_mask:0xf
    v_and_b32_dpp v58, v20, v10 quad_perm:[2,2,2,2] row_mask:0xf bank_mask:0xf
    v_and_b32_dpp v59, v20, v11 quad_perm:[2,2,2,2] row_mask:0xf bank_mask:0xf
    s_waitcnt lgkmcnt(2)
    s_nop 0
    v_mfma_f32_16x16x32_bf16 v[36:39], v[56:59], v[44:47], v[36:39]
    v_and_b32_dpp v60, v20, v8 quad_perm:[3,3,3,3] row_mask:0xf bank_mask:0xf
    v_and_b32_dpp v61, v20, v9 quad_perm:[3,3,3,3] row_mask:0xf bank_mask:0xf
    v_and_b32_dpp v62, v20, v10 quad_perm:[3,3,3,3] row_mask:0xf bank_mask:0xf
    v_and_b32_dpp v63, v20, v11 quad_perm:[3,3,3,3] row_mask:0xf bank_mask:0xf
    ds_read_b128 v[44:47], v14 offset:3072
    s_waitcnt lgkmcnt(2)
    v_mfma_f32_16x16x32_bf16 v[40:43], v[60:63], v[48:51], v[40:43]
    v_and_b32_dpp v56, v21, v8 quad_perm:[0,0,0,0] row_mask:0xf bank_mask:0xf
    v_and_b32_dpp v57, v21, v9 quad_perm:[0,0,0,0] row_mask:0xf bank_mask:0xf
    v_and_b32_dpp v58, v21, v10 quad_perm:[0,0,0,0] row_mask:0xf bank_mask:0xf
    v_and_b32_dpp v59, v21, v11 quad_perm:[0,0,0,0] row_mask:0xf bank_mask:0xf
    ds_read_b128 v[48:51], v14 offset:4096
    s_waitcnt lgkmcnt(2)
    v_mfma_f32_16x16x32_bf16 v[36:39], v[56:59], v[52:55], v[36:39]
    v_and_b32_dpp v60, v21, v8 quad_perm:[1,1,1,1] row_mask:0xf bank_mask:0xf
    v_and_b32_dpp v61, v21, v9 quad_perm:[1,1,1,1] row_mask:0xf bank_mask:0xf
    v_and_b32_dpp v62, v21, v10 quad_perm:[1,1,1,1] row_mask:0xf bank_mask:0xf
    v_and_b32_dpp v63, v21, v11 quad_perm:[1,1,1,1] row_mask:0xf bank_mask:0xf
    ds_read_b128 v[52:55], v14 offset:5120
    s_waitcnt lgkmcnt(2)
    v_mfma_f32_16x16x32_bf16 v[40:43], v[60:63], v[44:47], v[40:43]
    v_and_b32_dpp v56, v21, v8 quad_perm:[2,2,2,2] row_mask:0xf bank_mask:0xf
    v_and_b32_dpp v57, v21, v9 quad_perm:[2,2,2,2] row_mask:0xf bank_mask:0xf
    v_and_b32_dpp v58, v21, v10 quad_perm:[2,2,2,2] row_mask:0xf bank_mask:0xf
    v_and_b32_dpp v59, v21, v11 quad_perm:[2,2,2,2] row_mask:0xf bank_mask:0xf
    ds_read_b128 v[44:47], v14 offset:6144
    s_waitcnt lgkmcnt(2)
    v_mfma_f32_16x16x32_bf16 v[36:39], v[56:59], v[48:51], v[36:39]
    v_and_b32_dpp v60, v21, v8 quad_perm:[3,3,3,3] row_mask:0xf bank_mask:0xf
    v_and_b32_dpp v61, v21, v9 quad_perm:[3,3,3,3] row_mask:0xf bank_mask:0xf
    v_and_b32_dpp v62, v21, v10 quad_perm:[3,3,3,3] row_mask:0xf bank_mask:0xf
    v_and_b32_dpp v63, v21, v11 quad_perm:[3,3,3,3] row_mask:0xf bank_mask:0xf
    ds_read_b128 v[48:51], v14 offset:7168
    s_waitcnt lgkmcnt(2)
    v_mfma_f32_16x16x32_bf16 v[40:43], v[60:63], v[52:55], v[40:43]
    v_and_b32_dpp v56, v22, v8 quad_perm:[0,0,0,0] row_mask:0xf bank_mask:0xf
    v_and_b32_dpp v57, v22, v9 quad_perm:[0,0,0,0] row_mask:0xf bank_mask:0xf
    v_and_b32_dpp v58, v22, v10 quad_perm:[0,0,0,0] row_mask:0xf bank_mask:0xf
    v_and_b32_dpp v59, v22, v11 quad_perm:[0,0,0,0] row_mask:0xf bank_mask:0xf
    ds_read_b128 v[52:55], v14 offset:8192
    s_waitcnt lgkmcnt(2)
    v_mfma_f32_16x16x32_bf16 v[36:39], v[56:59], v[44:47], v[36:39]
    v_and_b32_dpp v60, v22, v8 quad_perm:[1,1,1,1] row_mask:0xf bank_mask:0xf
    v_and_b32_dpp v61, v22, v9 quad_perm:[1,1,1,1] row_mask:0xf bank_mask:0xf
    v_and_b32_dpp v62, v22, v10 quad_perm:[1,1,1,1] row_mask:0xf bank_mask:0xf
    v_and_b32_dpp v63, v22, v11 quad_perm:[1,1,1,1] row_mask:0xf bank_mask:0xf
    ds_read_b128 v[44:47], v14 offset:9216
    s_waitcnt lgkmcnt(2)
    v_mfma_f32_16x16x32_bf16 v[40:43], v[60:63], v[48:51], v[40:43]
    v_and_b32_dpp v56, v22, v8 quad_perm:[2,2,2,2] row_mask:0xf bank_mask:0xf
    v_and_b32_dpp v57, v22, v9 quad_perm:[2,2,2,2] row_mask:0xf bank_mask:0xf
    v_and_b32_dpp v58, v22, v10 quad_perm:[2,2,2,2] row_mask:0xf bank_mask:0xf
    v_and_b32_dpp v59, v22, v11 quad_perm:[2,2,2,2] row_mask:0xf bank_mask:0xf
    ds_read_b128 v[48:51], v14 offset:10240
    s_waitcnt lgkmcnt(2)
    v_mfma_f32_16x16x32_bf16 v[36:39], v[56:59], v[52:55], v[36:39]
    v_and_b32_dpp v60, v22, v8 quad_perm:[3,3,3,3] row_mask:0xf bank_mask:0xf
    v_and_b32_dpp v61, v22, v9 quad_perm:[3,3,3,3] row_mask:0xf bank_mask:0xf
    v_and_b32_dpp v62, v22, v10 quad_perm:[3,3,3,3] row_mask:0xf bank_mask:0xf
    v_and_b32_dpp v63, v22, v11 quad_perm:[3,3,3,3] row_mask:0xf bank_mask:0xf
    ds_read_b128 v[52:55], v14 offset:11264
    s_waitcnt lgkmcnt(2)
    v_mfma_f32_16x16x32_bf16 v[40:43], v[60:63], v[44:47], v[40:43]
    v_and_b32_dpp v56, v23, v8 quad_perm:[0,0,0,0] row_mask:0xf bank_mask:0xf
    v_and_b32_dpp v57, v23, v9 quad_perm:[0,0,0,0] row_mask:0xf bank_mask:0xf
    v_and_b32_dpp v58, v23, v10 quad_perm:[0,0,0,0] row_mask:0xf bank_mask:0xf
    v_and_b32_dpp v59, v23, v11 quad_perm:[0,0,0,0] row_mask:0xf bank_mask:0xf
    ds_read_b128 v[44:47], v14 offset:12288
    s_waitcnt lgkmcnt(2)
    v_mfma_f32_16x16x32_bf16 v[36:39], v[56:59], v[48:51], v[36:39]
    v_and_b32_dpp v60, v23, v8 quad_perm:[1,1,1,1] row_mask:0xf bank_mask:0xf
    v_and_b32_dpp v61, v23, v9 quad_perm:[1,1,1,1] row_mask:0xf bank_mask:0xf
    v_and_b32_dpp v62, v23, v10 quad_perm:[1,1,1,1] row_mask:0xf bank_mask:0xf
    v_and_b32_dpp v63, v23, v11 quad_perm:[1,1,1,1] row_mask:0xf bank_mask:0xf
    ds_read_b128 v[48:51], v14 offset:13312
    s_waitcnt lgkmcnt(2)
    v_mfma_f32_16x16x32_bf16 v[40:43], v[60:63], v[52:55], v[40:43]
    v_and_b32_dpp v56, v23, v8 quad_perm:[2,2,2,2] row_mask:0xf bank_mask:0xf
    v_and_b32_dpp v57, v23, v9 quad_perm:[2,2,2,2] row_mask:0xf bank_mask:0xf
    v_and_b32_dpp v58, v23, v10 quad_perm:[2,2,2,2] row_mask:0xf bank_mask:0xf
    v_and_b32_dpp v59, v23, v11 quad_perm:[2,2,2,2] row_mask:0xf bank_mask:0xf
    ds_read_b128 v[52:55], v14 offset:14336
    s_waitcnt lgkmcnt(2)
    v_mfma_f32_16x16x32_bf16 v[36:39], v[56:59], v[44:47], v[36:39]
    v_and_b32_dpp v60, v23, v8 quad_perm:[3,3,3,3] row_mask:0xf bank_mask:0xf
    v_and_b32_dpp v61, v23, v9 quad_perm:[3,3,3,3] row_mask:0xf bank_mask:0xf
    v_and_b32_dpp v62, v23, v10 quad_perm:[3,3,3,3] row_mask:0xf bank_mask:0xf
    v_and_b32_dpp v63, v23, v11 quad_perm:[3,3,3,3] row_mask:0xf bank_mask:0xf
    ds_read_b128 v[44:47], v14 offset:15360
    s_waitcnt lgkmcnt(2)
    v_mfma_f32_16x16x32_bf16 v[40:43], v[60:63], v[48:51], v[40:43]
    v_and_b32_dpp v56, v24, v8 quad_perm:[0,0,0,0] row_mask:0xf bank_mask:0xf
    v_and_b32_dpp v57, v24, v9 quad_perm:[0,0,0,0] row_mask:0xf bank_mask:0xf
    v_and_b32_dpp v58, v24, v10 quad_perm:[0,0,0,0] row_mask:0xf bank_mask:0xf
    v_and_b32_dpp v59, v24, v11 quad_perm:[0,0,0,0] row_mask:0xf bank_mask:0xf
    ds_read_b128 v[48:51], v14 offset:16384
    s_waitcnt lgkmcnt(2)
    v_mfma_f32_16x16x32_bf16 v[36:39], v[56:59], v[52:55], v[36:39]
    v_and_b32_dpp v60, v24, v8 quad_perm:[1,1,1,1] row_mask:0xf bank_mask:0xf
    v_and_b32_dpp v61, v24, v9 quad_perm:[1,1,1,1] row_mask:0xf bank_mask:0xf
    v_and_b32_dpp v62, v24, v10 quad_perm:[1,1,1,1] row_mask:0xf bank_mask:0xf
    v_and_b32_dpp v63, v24, v11 quad_perm:[1,1,1,1] row_mask:0xf bank_mask:0xf
    ds_read_b128 v[52:55], v14 offset:17408
    s_waitcnt lgkmcnt(2)
    v_mfma_f32_16x16x32_bf16 v[40:43], v[60:63], v[44:47], v[40:43]
    v_and_b32_dpp v56, v24, v8 quad_perm:[2,2,2,2] row_mask:0xf bank_mask:0xf
    v_and_b32_dpp v57, v24, v9 quad_perm:[2,2,2,2] row_mask:0xf bank_mask:0xf
    v_and_b32_dpp v58, v24, v10 quad_perm:[2,2,2,2] row_mask:0xf bank_mask:0xf
    v_and_b32_dpp v59, v24, v11 quad_perm:[2,2,2,2] row_mask:0xf bank_mask:0xf
    s_waitcnt lgkmcnt(1)
    s_nop 0
    v_mfma_f32_16x16x32_bf16 v[36:39], v[56:59], v[48:51], v[36:39]
    v_and_b32_dpp v60, v24, v8 quad_perm:[3,3,3,3] row_mask:0xf bank_mask:0xf
    v_and_b32_dpp v61, v24, v9 quad_perm:[3,3,3,3] row_mask:0xf bank_mask:0xf
    v_and_b32_dpp v62, v24, v10 quad_perm:[3,3,3,3] row_mask:0xf bank_mask:0xf
    v_and_b32_dpp v63, v24, v11 quad_perm:[3,3,3,3] row_mask:0xf bank_mask:0xf
    s_waitcnt lgkmcnt(0)
    s_nop 0
    v_mfma_f32_16x16x32_bf16 v[40:43], v[60:63], v[52:55], v[40:43]
    s_nop 7
    v_add_f32 v36, v36, v40
    v_add_f32 v37, v37, v41
    v_add_f32 v38, v38, v42
    v_add_f32 v39, v39, v43
    s_mov_b32 exec_lo, 0xff00ff
    s_mov_b32 exec_hi, 0xff00ff00
    ds_write_b128 v13, v[36:39] offset:17920
    s_mov_b64 exec, -1
L_c_s2_nob:
    v_add_f32 v28, v28, v32
    v_add_f32 v29, v29, v33
    v_add_f32 v30, v30, v34
    v_add_f32 v31, v31, v35
    s_mov_b32 exec_lo, 0xff00ff
    s_mov_b32 exec_hi, 0xff00ff00
    ds_write_b128 v13, v[28:31] offset:15872
    s_mov_b64 exec, -1
    s_waitcnt lgkmcnt(0)
    s_barrier
    s_cmp_ge_u32 s3, 2
    s_cbranch_scc1 L_c_s2_done
    s_cmp_lt_u32 s62, 5
    s_cselect_b32 s74, 2, 1
    s_cmp_ge_u32 s3, s74
    s_cbranch_scc1 L_c_s2_done
    s_lshl_b32 s74, s3, 11
    s_add_u32 s74, s74, 15872
    s_mov_b32 exec_lo, 0xffffffff
    s_mov_b32 exec_hi, 0x0
    v_lshlrev_b32 v16, 3, v0
    v_add_u32 v16, s74, v16
    ds_read_b64 v[20:21], v16 offset:0
    ds_read_b64 v[22:23], v16 offset:256
    ds_read_b64 v[24:25], v16 offset:512
    ds_read_b64 v[26:27], v16 offset:768
    ds_read_b64 v[28:29], v16 offset:1024
    ds_read_b64 v[30:31], v16 offset:1280
    ds_read_b64 v[32:33], v16 offset:1536
    ds_read_b64 v[34:35], v16 offset:1792
    s_waitcnt lgkmcnt(0)
    v_pk_add_f32 v[20:21], v[20:21], v[22:23]
    v_pk_add_f32 v[24:25], v[24:25], v[26:27]
    v_pk_add_f32 v[28:29], v[28:29], v[30:31]
    v_pk_add_f32 v[32:33], v[32:33], v[34:35]
    v_pk_add_f32 v[20:21], v[20:21], v[24:25]
    v_pk_add_f32 v[28:29], v[28:29], v[32:33]
    v_pk_add_f32 v[36:37], v[20:21], v[28:29]
    v_cvt_pk_bf16_f32 v36, v36, v36
    v_and_b32 v36, 0xffff0000, v36
    v_mul_f32 v38, 0xbfb8aa3b, v36
    v_exp_f32 v38, v38
    s_nop 0
    v_add_f32 v38, 1.0, v38
    v_rcp_f32 v38, v38
    s_nop 0
    v_mul_f32 v36, v36, v38
    v_cvt_pk_bf16_f32 v37, v37, v37
    v_and_b32 v37, 0xffff0000, v37
    v_mul_f32 v38, 0xbfb8aa3b, v37
    v_exp_f32 v38, v38
    s_nop 0
    v_add_f32 v38, 1.0, v38
    v_rcp_f32 v38, v38
    s_nop 0
    v_mul_f32 v37, v37, v38
    v_cvt_pk_bf16_f32 v36, v36, v37
    s_mul_i32 s74, s3, 22
    s_add_u32 s74, s74, s62
    s_lshl_b32 s74, s74, 7
    s_mul_i32 s75, s64, 3584
    s_add_u32 s74, s74, s75
    s_add_u32 s74, s74, 2233344
    v_lshlrev_b32 v16, 2, v0
    buffer_store_dword v36, v16, s[24:27], s74 offen sc1
    s_mov_b64 exec, -1
L_c_s2_done:
    s_branch L_c_s3_done
L_c_s3:
    s_sub_u32 s35, s62, 22
    s_lshl_b32 s35, s35, 7
    s_cmp_lg_u32 s3, 0
    s_cbranch_scc1 L_c_h2a_done
    v_mul_u32_u24 v16, 2560, v1
    v_lshlrev_b32 v17, 4, v2
    v_add_u32 v16, v16, v17
    s_mul_i32 s74, s64, 81920
    s_lshl_b32 s75, s35, 1
    s_add_u32 s74, s74, s75
    s_add_u32 s74, s74, 1867776
    s_add_u32 s75, s74, 10240
    s_add_u32 s76, s74, 20480
    s_add_u32 s77, s74, 30720
    s_add_u32 s78, s74, 40960
    s_add_u32 s79, s74, 51200
    s_add_u32 s80, s74, 61440
    s_add_u32 s81, s74, 71680
    v_lshlrev_b32 v17, 3, v2
    s_mul_i32 s82, s65, 1280
    s_add_u32 s82, s82, s35
    v_add_u32 v18, s82, v17
    ds_read_b64 v[28:29], v18 offset:24064
    v_mov_b32 v32, -1
    v_mov_b32 v33, -1
    v_mov_b32 v34, -1
    v_mov_b32 v35, -1
    v_mov_b32 v36, -1
    v_mov_b32 v37, -1
    v_mov_b32 v38, -1
    v_mov_b32 v39, -1
    v_mov_b32 v40, -1
    v_mov_b32 v41, -1
    v_mov_b32 v42, -1
    v_mov_b32 v43, -1
    v_mov_b32 v44, -1
    v_mov_b32 v45, -1
    v_mov_b32 v46, -1
    v_mov_b32 v47, -1
    v_mov_b32 v48, -1
    v_mov_b32 v49, -1
    v_mov_b32 v50, -1
    v_mov_b32 v51, -1
    v_mov_b32 v52, -1
    v_mov_b32 v53, -1
    v_mov_b32 v54, -1
    v_mov_b32 v55, -1
    v_mov_b32 v56, -1
    v_mov_b32 v57, -1
    v_mov_b32 v58, -1
    v_mov_b32 v59, -1
    v_mov_b32 v60, -1
    v_mov_b32 v61, -1
    v_mov_b32 v62, -1
    v_mov_b32 v63, -1
    s_mov_b32 s73, 0
    s_nop 0
L_pl_21:
    buffer_load_dwordx4 v[32:35], v16, s[24:27], s74 offen sc1
    buffer_load_dwordx4 v[36:39], v16, s[24:27], s75 offen sc1
    buffer_load_dwordx4 v[40:43], v16, s[24:27], s76 offen sc1
    buffer_load_dwordx4 v[44:47], v16, s[24:27], s77 offen sc1
    buffer_load_dwordx4 v[48:51], v16, s[24:27], s78 offen sc1
    buffer_load_dwordx4 v[52:55], v16, s[24:27], s79 offen sc1
    buffer_load_dwordx4 v[56:59], v16, s[24:27], s80 offen sc1
    buffer_load_dwordx4 v[60:63], v16, s[24:27], s81 offen sc1
    s_waitcnt vmcnt(0)
    v_max3_u32 v19, v32, v33, v34
    v_max3_u32 v19, v19, v35, v36
    v_max3_u32 v19, v19, v37, v38
    v_max3_u32 v19, v19, v39, v40
    v_max3_u32 v19, v19, v41, v42
    v_max3_u32 v19, v19, v43, v44
    v_max3_u32 v19, v19, v45, v46
    v_max3_u32 v19, v19, v47, v48
    v_max3_u32 v19, v19, v49, v50
    v_max3_u32 v19, v19, v51, v52
    v_max3_u32 v19, v19, v53, v54
    v_max3_u32 v19, v19, v55, v56
    v_max3_u32 v19, v19, v57, v58
    v_max3_u32 v19, v19, v59, v60
    v_max3_u32 v19, v19, v61, v62
    v_max_u32 v19, v19, v63
    v_cmp_eq_u32 vcc, -1, v19
    s_add_u32 s73, s73, 1
    s_cmp_gt_u32 s73, 60000
    s_nop 1
    s_cbranch_scc1 L_pd_22
    s_cbranch_vccnz L_pl_21
L_pd_22:
    s_waitcnt lgkmcnt(0)
    v_add_f32 v20, v32, v36
    v_add_f32 v24, v40, v44
    v_add_f32 v21, v33, v37
    v_add_f32 v25, v41, v45
    v_add_f32 v22, v34, v38
    v_add_f32 v26, v42, v46
    v_add_f32 v23, v35, v39
    v_add_f32 v27, v43, v47
    v_add_f32 v20, v20, v48
    v_add_f32 v24, v24, v56
    v_add_f32 v21, v21, v49
    v_add_f32 v25, v25, v57
    v_add_f32 v22, v22, v50
    v_add_f32 v26, v26, v58
    v_add_f32 v23, v23, v51
    v_add_f32 v27, v27, v59
    v_add_f32 v20, v20, v52
    v_add_f32 v24, v24, v60
    v_add_f32 v21, v21, v53
    v_add_f32 v25, v25, v61
    v_add_f32 v22, v22, v54
    v_add_f32 v26, v26, v62
    v_add_f32 v23, v23, v55
    v_add_f32 v27, v27, v63
    v_add_f32 v20, v20, v24
    v_add_f32 v21, v21, v25
    v_add_f32 v22, v22, v26
    v_add_f32 v23, v23, v27
    v_mov_b32 v24, v20
    v_mov_b32 v25, v21
    v_mov_b32 v26, v22
    v_mov_b32 v27, v23
    v_permlane16_swap_b32 v20, v24
    v_permlane16_swap_b32 v21, v25
    v_permlane16_swap_b32 v22, v26
    v_permlane16_swap_b32 v23, v27
    v_add_f32 v20, v20, v24
    v_add_f32 v21, v21, v25
    v_add_f32 v22, v22, v26
    v_add_f32 v23, v23, v27
    v_mov_b32 v24, v20
    v_mov_b32 v25, v21
    v_mov_b32 v26, v22
    v_mov_b32 v27, v23
    v_permlane32_swap_b32 v20, v24
    v_permlane32_swap_b32 v21, v25
    v_permlane32_swap_b32 v22, v26
    v_permlane32_swap_b32 v23, v27
    v_add_f32 v20, v20, v24
    v_add_f32 v21, v21, v25
    v_add_f32 v22, v22, v26
    v_add_f32 v23, v23, v27
    v_cvt_pk_bf16_f32 v24, v20, v21
    v_cvt_pk_bf16_f32 v25, v22, v23
    v_lshlrev_b32 v20, 16, v24
    v_and_b32 v21, 0xffff0000, v24
    v_lshlrev_b32 v22, 16, v28
    v_and_b32 v23, 0xffff0000, v28
    v_add_f32 v20, v20, v22
    v_add_f32 v21, v21, v23
    v_cvt_pk_bf16_f32 v26, v20, v21
    v_lshlrev_b32 v20, 16, v25
    v_and_b32 v21, 0xffff0000, v25
    v_lshlrev_b32 v22, 16, v29
    v_and_b32 v23, 0xffff0000, v29
    v_add_f32 v20, v20, v22
    v_add_f32 v21, v21, v23
    v_cvt_pk_bf16_f32 v27, v20, v21
    s_add_u32 s82, s34, s35
    s_mov_b32 exec_lo, 0xffff
    s_mov_b32 exec_hi, 0x0
    buffer_store_dwordx2 v[26:27], v17, s[24:27], s82 offen sc1
    s_and_b32 s82, s63, 1
    s_lshl_b32 s82, s82, 7
    v_add_u32 v17, s82, v17
    ds_write_b64 v17, v[26:27] offset:5120
    s_mov_b64 exec, -1
L_c_h2a_done:
    s_and_b32 s90, s63, 1
    s_lshl_b32 s90, s90, 7
    s_mov_b32 s91, 0
    s_cmp_eq_u32 s63, 3
    s_cbranch_scc1 L_c_s3_done
    s_cmp_eq_u32 s63, 4
    s_cbranch_scc0 L_c_s3_body
    s_mov_b32 s72, 1
    s_mov_b32 s64, 2
    s_mov_b32 s65, 0
    s_mov_b32 s66, 1
    s_mov_b32 s90, 128
    s_mov_b32 s91, 2048
L_c_s3_body:
    s_mul_i32 s74, s64, 3584
    s_mul_i32 s75, s3, 864
    s_add_u32 s74, s74, s75
    s_add_u32 s74, s74, 2233344
    v_min_u32 v24, 848, v15
    v_mov_b32 v152, -1
    v_mov_b32 v153, -1
    v_mov_b32 v154, -1
    v_mov_b32 v155, -1
    s_mov_b32 s73, 0
    s_nop 0
L_pl_23:
    buffer_load_dwordx4 v[152:155], v24, s[24:27], s74 offen sc1
    s_waitcnt vmcnt(0)
    v_max3_u32 v26, v152, v153, v154
    v_max_u32 v26, v26, v155
    v_cmp_eq_u32 vcc, -1, v26
    s_add_u32 s73, s73, 1
    s_cmp_gt_u32 s73, 60000
    s_nop 1
    s_cbranch_scc1 L_pd_24
    s_cbranch_vccnz L_pl_23
L_pd_24:
    v_add_u32 v24, s68, v24
    ds_write_b128 v24, v[152:155]
    v_and_b32 v16, 3, v0
    v_lshlrev_b32 v16, 4, v16
    v_bfe_u32 v17, v0, 3, 1
    v_lshlrev_b32 v17, 3, v17
    v_add_u32 v16, v16, v17
    v_lshrrev_b32 v17, 4, v0
    v_lshlrev_b32 v17, 1, v17
    v_add_u32 v16, v16, v17
    v_add_u32 v16, s68, v16
    s_waitcnt lgkmcnt(0)
    ds_read_u16 v20, v16 offset:0
    ds_read_u16 v21, v16 offset:64
    ds_read_u16 v22, v16 offset:128
    ds_read_u16 v23, v16 offset:192
    ds_read_u16 v24, v16 offset:256
    ds_read_u16 v25, v16 offset:320
    ds_read_u16 v26, v16 offset:384
    ds_read_u16 v27, v16 offset:448
    ds_read_u16 v28, v16 offset:512
    ds_read_u16 v29, v16 offset:576
    ds_read_u16 v30, v16 offset:640
    ds_read_u16 v31, v16 offset:704
    ds_read_u16 v32, v16 offset:768
    ds_read_u16 v33, v16 offset:832
    s_waitcnt lgkmcnt(13)
    v_lshl_or_b32 v20, v20, 16, v20
    s_waitcnt lgkmcnt(12)
    v_lshl_or_b32 v21, v21, 16, v21
    s_waitcnt lgkmcnt(11)
    v_lshl_or_b32 v22, v22, 16, v22
    s_waitcnt lgkmcnt(10)
    v_lshl_or_b32 v23, v23, 16, v23
    s_waitcnt lgkmcnt(9)
    v_lshl_or_b32 v24, v24, 16, v24
    s_waitcnt lgkmcnt(8)
    v_lshl_or_b32 v25, v25, 16, v25
    s_waitcnt lgkmcnt(7)
    v_lshl_or_b32 v26, v26, 16, v26
    s_waitcnt lgkmcnt(6)
    v_lshl_or_b32 v27, v27, 16, v27
    s_waitcnt lgkmcnt(5)
    v_lshl_or_b32 v28, v28, 16, v28
    s_waitcnt lgkmcnt(4)
    v_lshl_or_b32 v29, v29, 16, v29
    s_waitcnt lgkmcnt(3)
    v_lshl_or_b32 v30, v30, 16, v30
    s_waitcnt lgkmcnt(2)
    v_lshl_or_b32 v31, v31, 16, v31
    s_waitcnt lgkmcnt(1)
    v_lshl_or_b32 v32, v32, 16, v32
    s_waitcnt lgkmcnt(0)
    v_lshl_or_b32 v33, v33, 16, v33
    ds_read_b128 v[44:47], v14 offset:0
    ds_read_b128 v[48:51], v14 offset:1024
    ds_read_b128 v[52:55], v14 offset:2048
    v_and_b32_dpp v56, v20, v8 quad_perm:[0,0,0,0] row_mask:0xf bank_mask:0xf
    v_and_b32_dpp v57, v20, v9 quad_perm:[0,0,0,0] row_mask:0xf bank_mask:0xf
    v_and_b32_dpp v58, v20, v10 quad_perm:[0,0,0,0] row_mask:0xf bank_mask:0xf
    v_and_b32_dpp v59, v20, v11 quad_perm:[0,0,0,0] row_mask:0xf bank_mask:0xf
    s_nop 1
    v_mfma_f32_16x16x32_bf16 v[36:39], v[56:59], v[168:171], 0
    v_and_b32_dpp v60, v20, v8 quad_perm:[1,1,1,1] row_mask:0xf bank_mask:0xf
    v_and_b32_dpp v61, v20, v9 quad_perm:[1,1,1,1] row_mask:0xf bank_mask:0xf
    v_and_b32_dpp v62, v20, v10 quad_perm:[1,1,1,1] row_mask:0xf bank_mask:0xf
    v_and_b32_dpp v63, v20, v11 quad_perm:[1,1,1,1] row_mask:0xf bank_mask:0xf
    s_nop 1
    v_mfma_f32_16x16x32_bf16 v[40:43], v[60:63], v[172:175], 0
    v_and_b32_dpp v56, v25, v8 quad_perm:[2,2,2,2] row_mask:0xf bank_mask:0xf
    v_and_b32_dpp v57, v25, v9 quad_perm:[2,2,2,2] row_mask:0xf bank_mask:0xf
    v_and_b32_dpp v58, v25, v10 quad_perm:[2,2,2,2] row_mask:0xf bank_mask:0xf
    v_and_b32_dpp v59, v25, v11 quad_perm:[2,2,2,2] row_mask:0xf bank_mask:0xf
    s_waitcnt lgkmcnt(2)
    s_nop 0
    v_mfma_f32_16x16x32_bf16 v[36:39], v[56:59], v[44:47], v[36:39]
    v_and_b32_dpp v60, v25, v8 quad_perm:[3,3,3,3] row_mask:0xf bank_mask:0xf
    v_and_b32_dpp v61, v25, v9 quad_perm:[3,3,3,3] row_mask:0xf bank_mask:0xf
    v_and_b32_dpp v62, v25, v10 quad_perm:[3,3,3,3] row_mask:0xf bank_mask:0xf
    v_and_b32_dpp v63, v25, v11 quad_perm:[3,3,3,3] row_mask:0xf bank_mask:0xf
    ds_read_b128 v[44:47], v14 offset:3072
    s_waitcnt lgkmcnt(2)
    v_mfma_f32_16x16x32_bf16 v[40:43], v[60:63], v[48:51], v[40:43]
    v_and_b32_dpp v56, v26, v8 quad_perm:[0,0,0,0] row_mask:0xf bank_mask:0xf
    v_and_b32_dpp v57, v26, v9 quad_perm:[0,0,0,0] row_mask:0xf bank_mask:0xf
    v_and_b32_dpp v58, v26, v10 quad_perm:[0,0,0,0] row_mask:0xf bank_mask:0xf
    v_and_b32_dpp v59, v26, v11 quad_perm:[0,0,0,0] row_mask:0xf bank_mask:0xf
    ds_read_b128 v[48:51], v14 offset:4096
    s_waitcnt lgkmcnt(2)
    v_mfma_f32_16x16x32_bf16 v[36:39], v[56:59], v[52:55], v[36:39]
    v_and_b32_dpp v60, v20, v8 quad_perm:[2,2,2,2] row_mask:0xf bank_mask:0xf
    v_and_b32_dpp v61, v20, v9 quad_perm:[2,2,2,2] row_mask:0xf bank_mask:0xf
    v_and_b32_dpp v62, v20, v10 quad_perm:[2,2,2,2] row_mask:0xf bank_mask:0xf
    v_and_b32_dpp v63, v20, v11 quad_perm:[2,2,2,2] row_mask:0xf bank_mask:0xf
    ds_read_b128 v[52:55], v14 offset:5120
    s_nop 0
    v_mfma_f32_16x16x32_bf16 v[40:43], v[60:63], v[176:179], v[40:43]
    v_and_b32_dpp v56, v26, v8 quad_perm:[1,1,1,1] row_mask:0xf bank_mask:0xf
    v_and_b32_dpp v57, v26, v9 quad_perm:[1,1,1,1] row_mask:0xf bank_mask:0xf
    v_and_b32_dpp v58, v26, v10 quad_perm:[1,1,1,1] row_mask:0xf bank_mask:0xf
    v_and_b32_dpp v59, v26, v11 quad_perm:[1,1,1,1] row_mask:0xf bank_mask:0xf
    s_waitcnt lgkmcnt(2)
    s_nop 0
    v_mfma_f32_16x16x32_bf16 v[36:39], v[56:59], v[44:47], v[36:39]
    v_and_b32_dpp v60, v26, v8 quad_perm:[2,2,2,2] row_mask:0xf bank_mask:0xf
    v_and_b32_dpp v61, v26, v9 quad_perm:[2,2,2,2] row_mask:0xf bank_mask:0xf
    v_and_b32_dpp v62, v26, v10 quad_perm:[2,2,2,2] row_mask:0xf bank_mask:0xf
    v_and_b32_dpp v63, v26, v11 quad_perm:[2,2,2,2] row_mask:0xf bank_mask:0xf
    ds_read_b128 v[44:47], v14 offset:6144
    s_waitcnt lgkmcnt(2)
    v_mfma_f32_16x16x32_bf16 v[40:43], v[60:63], v[48:51], v[40:43]
    v_and_b32_dpp v56, v20, v8 quad_perm:[3,3,3,3] row_mask:0xf bank_mask:0xf
    v_and_b32_dpp v57, v20, v9 quad_perm:[3,3,3,3] row_mask:0xf bank_mask:0xf
    v_and_b32_dpp v58, v20, v10 quad_perm:[3,3,3,3] row_mask:0xf bank_mask:0xf
    v_and_b32_dpp v59, v20, v11 quad_perm:[3,3,3,3] row_mask:0xf bank_mask:0xf
    ds_read_b128 v[48:51], v14 offset:7168
    s_nop 0
    v_mfma_f32_16x16x32_bf16 v[36:39], v[56:59], v[180:183], v[36:39]
    v_and_b32_dpp v60, v26, v8 quad_perm:[3,3,3,3] row_mask:0xf bank_mask:0xf
    v_and_b32_dpp v61, v26, v9 quad_perm:[3,3,3,3] row_mask:0xf bank_mask:0xf
    v_and_b32_dpp v62, v26, v10 quad_perm:[3,3,3,3] row_mask:0xf bank_mask:0xf
    v_and_b32_dpp v63, v26, v11 quad_perm:[3,3,3,3] row_mask:0xf bank_mask:0xf
    s_waitcnt lgkmcnt(2)
    s_nop 0
    v_mfma_f32_16x16x32_bf16 v[40:43], v[60:63], v[52:55], v[40:43]
    v_and_b32_dpp v56, v21, v8 quad_perm:[0,0,0,0] row_mask:0xf bank_mask:0xf
    v_and_b32_dpp v57, v21, v9 quad_perm:[0,0,0,0] row_mask:0xf bank_mask:0xf
    v_and_b32_dpp v58, v21, v10 quad_perm:[0,0,0,0] row_mask:0xf bank_mask:0xf
    v_and_b32_dpp v59, v21, v11 quad_perm:[0,0,0,0] row_mask:0xf bank_mask:0xf
    ds_read_b128 v[52:55], v14 offset:8192
    s_nop 0
    v_mfma_f32_16x16x32_bf16 v[36:39], v[56:59], v[184:187], v[36:39]
    v_and_b32_dpp v60, v27, v8 quad_perm:[0,0,0,0] row_mask:0xf bank_mask:0xf
    v_and_b32_dpp v61, v27, v9 quad_perm:[0,0,0,0] row_mask:0xf bank_mask:0xf
    v_and_b32_dpp v62, v27, v10 quad_perm:[0,0,0,0] row_mask:0xf bank_mask:0xf
    v_and_b32_dpp v63, v27, v11 quad_perm:[0,0,0,0] row_mask:0xf bank_mask:0xf
    s_waitcnt lgkmcnt(2)
    s_nop 0
    v_mfma_f32_16x16x32_bf16 v[40:43], v[60:63], v[44:47], v[40:43]
    v_and_b32_dpp v56, v27, v8 quad_perm:[1,1,1,1] row_mask:0xf bank_mask:0xf
    v_and_b32_dpp v57, v27, v9 quad_perm:[1,1,1,1] row_mask:0xf bank_mask:0xf
    v_and_b32_dpp v58, v27, v10 quad_perm:[1,1,1,1] row_mask:0xf bank_mask:0xf
    v_and_b32_dpp v59, v27, v11 quad_perm:[1,1,1,1] row_mask:0xf bank_mask:0xf
    ds_read_b128 v[44:47], v14 offset:9216
    s_waitcnt lgkmcnt(2)
    v_mfma_f32_16x16x32_bf16 v[36:39], v[56:59], v[48:51], v[36:39]
    v_and_b32_dpp v60, v21, v8 quad_perm:[1,1,1,1] row_mask:0xf bank_mask:0xf
    v_and_b32_dpp v61, v21, v9 quad_perm:[1,1,1,1] row_mask:0xf bank_mask:0xf
    v_and_b32_dpp v62, v21, v10 quad_perm:[1,1,1,1] row_mask:0xf bank_mask:0xf
    v_and_b32_dpp v63, v21, v11 quad_perm:[1,1,1,1] row_mask:0xf bank_mask:0xf
    ds_read_b128 v[48:51], v14 offset:10240
    s_nop 0
    v_mfma_f32_16x16x32_bf16 v[40:43], v[60:63], v[188:191], v[40:43]
    v_and_b32_dpp v56, v27, v8 quad_perm:[2,2,2,2] row_mask:0xf bank_mask:0xf
    v_and_b32_dpp v57, v27, v9 quad_perm:[2,2,2,2] row_mask:0xf bank_mask:0xf
    v_and_b32_dpp v58, v27, v10 quad_perm:[2,2,2,2] row_mask:0xf bank_mask:0xf
    v_and_b32_dpp v59, v27, v11 quad_perm:[2,2,2,2] row_mask:0xf bank_mask:0xf
    s_waitcnt lgkmcnt(2)
    s_nop 0
    v_mfma_f32_16x16x32_bf16 v[36:39], v[56:59], v[52:55], v[36:39]
    v_and_b32_dpp v60, v21, v8 quad_perm:[2,2,2,2] row_mask:0xf bank_mask:0xf
    v_and_b32_dpp v61, v21, v9 quad_perm:[2,2,2,2] row_mask:0xf bank_mask:0xf
    v_and_b32_dpp v62, v21, v10 quad_perm:[2,2,2,2] row_mask:0xf bank_mask:0xf
    v_and_b32_dpp v63, v21, v11 quad_perm:[2,2,2,2] row_mask:0xf bank_mask:0xf
    ds_read_b128 v[52:55], v14 offset:11264
    s_nop 0
    v_mfma_f32_16x16x32_bf16 v[40:43], v[60:63], v[192:195], v[40:43]
    v_and_b32_dpp v56, v27, v8 quad_perm:[3,3,3,3] row_mask:0xf bank_mask:0xf
    v_and_b32_dpp v57, v27, v9 quad_perm:[3,3,3,3] row_mask:0xf bank_mask:0xf
    v_and_b32_dpp v58, v27, v10 quad_perm:[3,3,3,3] row_mask:0xf bank_mask:0xf
    v_and_b32_dpp v59, v27, v11 quad_perm:[3,3,3,3] row_mask:0xf bank_mask:0xf
    s_waitcnt lgkmcnt(2)
    s_nop 0
    v_mfma_f32_16x16x32_bf16 v[36:39], v[56:59], v[44:47], v[36:39]
    v_and_b32_dpp v60, v28, v8 quad_perm:[0,0,0,0] row_mask:0xf bank_mask:0xf
    v_and_b32_dpp v61, v28, v9 quad_perm:[0,0,0,0] row_mask:0xf bank_mask:0xf
    v_and_b32_dpp v62, v28, v10 quad_perm:[0,0,0,0] row_mask:0xf bank_mask:0xf
    v_and_b32_dpp v63, v28, v11 quad_perm:[0,0,0,0] row_mask:0xf bank_mask:0xf
    ds_read_b128 v[44:47], v14 offset:12288
    s_waitcnt lgkmcnt(2)
    v_mfma_f32_16x16x32_bf16 v[40:43], v[60:63], v[48:51], v[40:43]
    v_and_b32_dpp v56, v21, v8 quad_perm:[3,3,3,3] row_mask:0xf bank_mask:0xf
    v_and_b32_dpp v57, v21, v9 quad_perm:[3,3,3,3] row_mask:0xf bank_mask:0xf
    v_and_b32_dpp v58, v21, v10 quad_perm:[3,3,3,3] row_mask:0xf bank_mask:0xf
    v_and_b32_dpp v59, v21, v11 quad_perm:[3,3,3,3] row_mask:0xf bank_mask:0xf
    ds_read_b128 v[48:51], v14 offset:13312
    s_nop 0
    v_mfma_f32_16x16x32_bf16 v[36:39], v[56:59], v[196:199], v[36:39]
    v_and_b32_dpp v60, v28, v8 quad_perm:[1,1,1,1] row_mask:0xf bank_mask:0xf
    v_and_b32_dpp v61, v28, v9 quad_perm:[1,1,1,1] row_mask:0xf bank_mask:0xf
    v_and_b32_dpp v62, v28, v10 quad_perm:[1,1,1,1] row_mask:0xf bank_mask:0xf
    v_and_b32_dpp v63, v28, v11 quad_perm:[1,1,1,1] row_mask:0xf bank_mask:0xf
    s_waitcnt lgkmcnt(2)
    s_nop 0
    v_mfma_f32_16x16x32_bf16 v[40:43], v[60:63], v[52:55], v[40:43]
    v_and_b32_dpp v56, v22, v8 quad_perm:[0,0,0,0] row_mask:0xf bank_mask:0xf
    v_and_b32_dpp v57, v22, v9 quad_perm:[0,0,0,0] row_mask:0xf bank_mask:0xf
    v_and_b32_dpp v58, v22, v10 quad_perm:[0,0,0,0] row_mask:0xf bank_mask:0xf
    v_and_b32_dpp v59, v22, v11 quad_perm:[0,0,0,0] row_mask:0xf bank_mask:0xf
    ds_read_b128 v[52:55], v14 offset:14336
    s_nop 0
    v_mfma_f32_16x16x32_bf16 v[36:39], v[56:59], v[200:203], v[36:39]
    v_and_b32_dpp v60, v28, v8 quad_perm:[2,2,2,2] row_mask:0xf bank_mask:0xf
    v_and_b32_dpp v61, v28, v9 quad_perm:[2,2,2,2] row_mask:0xf bank_mask:0xf
    v_and_b32_dpp v62, v28, v10 quad_perm:[2,2,2,2] row_mask:0xf bank_mask:0xf
    v_and_b32_dpp v63, v28, v11 quad_perm:[2,2,2,2] row_mask:0xf bank_mask:0xf
    s_waitcnt lgkmcnt(2)
    s_nop 0
    v_mfma_f32_16x16x32_bf16 v[40:43], v[60:63], v[44:47], v[40:43]
    v_and_b32_dpp v56, v28, v8 quad_perm:[3,3,3,3] row_mask:0xf bank_mask:0xf
    v_and_b32_dpp v57, v28, v9 quad_perm:[3,3,3,3] row_mask:0xf bank_mask:0xf
    v_and_b32_dpp v58, v28, v10 quad_perm:[3,3,3,3] row_mask:0xf bank_mask:0xf
    v_and_b32_dpp v59, v28, v11 quad_perm:[3,3,3,3] row_mask:0xf bank_mask:0xf
    ds_read_b128 v[44:47], v14 offset:15360
    s_waitcnt lgkmcnt(2)
    v_mfma_f32_16x16x32_bf16 v[36:39], v[56:59], v[48:51], v[36:39]
    v_and_b32_dpp v60, v22, v8 quad_perm:[1,1,1,1] row_mask:0xf bank_mask:0xf
    v_and_b32_dpp v61, v22, v9 quad_perm:[1,1,1,1] row_mask:0xf bank_mask:0xf
    v_and_b32_dpp v62, v22, v10 quad_perm:[1,1,1,1] row_mask:0xf bank_mask:0xf
    v_and_b32_dpp v63, v22, v11 quad_perm:[1,1,1,1] row_mask:0xf bank_mask:0xf
    ds_read_b128 v[48:51], v14 offset:16384
    s_nop 0
    v_mfma_f32_16x16x32_bf16 v[40:43], v[60:63], v[204:207], v[40:43]
    v_and_b32_dpp v56, v29, v8 quad_perm:[0,0,0,0] row_mask:0xf bank_mask:0xf
    v_and_b32_dpp v57, v29, v9 quad_perm:[0,0,0,0] row_mask:0xf bank_mask:0xf
    v_and_b32_dpp v58, v29, v10 quad_perm:[0,0,0,0] row_mask:0xf bank_mask:0xf
    v_and_b32_dpp v59, v29, v11 quad_perm:[0,0,0,0] row_mask:0xf bank_mask:0xf
    s_waitcnt lgkmcnt(2)
    s_nop 0
    v_mfma_f32_16x16x32_bf16 v[36:39], v[56:59], v[52:55], v[36:39]
    v_and_b32_dpp v60, v22, v8 quad_perm:[2,2,2,2] row_mask:0xf bank_mask:0xf
    v_and_b32_dpp v61, v22, v9 quad_perm:[2,2,2,2] row_mask:0xf bank_mask:0xf
    v_and_b32_dpp v62, v22, v10 quad_perm:[2,2,2,2] row_mask:0xf bank_mask:0xf
    v_and_b32_dpp v63, v22, v11 quad_perm:[2,2,2,2] row_mask:0xf bank_mask:0xf
    ds_read_b128 v[52:55], v14 offset:17408
    s_nop 0
    v_mfma_f32_16x16x32_bf16 v[40:43], v[60:63], v[208:211], v[40:43]
    v_and_b32_dpp v56, v29, v8 quad_perm:[1,1,1,1] row_mask:0xf bank_mask:0xf
    v_and_b32_dpp v57, v29, v9 quad_perm:[1,1,1,1] row_mask:0xf bank_mask:0xf
    v_and_b32_dpp v58, v29, v10 quad_perm:[1,1,1,1] row_mask:0xf bank_mask:0xf
    v_and_b32_dpp v59, v29, v11 quad_perm:[1,1,1,1] row_mask:0xf bank_mask:0xf
    s_waitcnt lgkmcnt(2)
    s_nop 0
    v_mfma_f32_16x16x32_bf16 v[36:39], v[56:59], v[44:47], v[36:39]
    v_and_b32_dpp v60, v29, v8 quad_perm:[2,2,2,2] row_mask:0xf bank_mask:0xf
    v_and_b32_dpp v61, v29, v9 quad_perm:[2,2,2,2] row_mask:0xf bank_mask:0xf
    v_and_b32_dpp v62, v29, v10 quad_perm:[2,2,2,2] row_mask:0xf bank_mask:0xf
    v_and_b32_dpp v63, v29, v11 quad_perm:[2,2,2,2] row_mask:0xf bank_mask:0xf
    ds_read_b128 v[44:47], v14 offset:18432
    s_waitcnt lgkmcnt(2)
    v_mfma_f32_16x16x32_bf16 v[40:43], v[60:63], v[48:51], v[40:43]
    v_and_b32_dpp v56, v22, v8 quad_perm:[3,3,3,3] row_mask:0xf bank_mask:0xf
    v_and_b32_dpp v57, v22, v9 quad_perm:[3,3,3,3] row_mask:0xf bank_mask:0xf
    v_and_b32_dpp v58, v22, v10 quad_perm:[3,3,3,3] row_mask:0xf bank_mask:0xf
    v_and_b32_dpp v59, v22, v11 quad_perm:[3,3,3,3] row_mask:0xf bank_mask:0xf
    ds_read_b128 v[48:51], v14 offset:19456
    s_nop 0
    v_mfma_f32_16x16x32_bf16 v[36:39], v[56:59], v[212:215], v[36:39]
    v_and_b32_dpp v60, v29, v8 quad_perm:[3,3,3,3] row_mask:0xf bank_mask:0xf
    v_and_b32_dpp v61, v29, v9 quad_perm:[3,3,3,3] row_mask:0xf bank_mask:0xf
    v_and_b32_dpp v62, v29, v10 quad_perm:[3,3,3,3] row_mask:0xf bank_mask:0xf
    v_and_b32_dpp v63, v29, v11 quad_perm:[3,3,3,3] row_mask:0xf bank_mask:0xf
    s_waitcnt lgkmcnt(2)
    s_nop 0
    v_mfma_f32_16x16x32_bf16 v[40:43], v[60:63], v[52:55], v[40:43]
    v_and_b32_dpp v56, v23, v8 quad_perm:[0,0,0,0] row_mask:0xf bank_mask:0xf
    v_and_b32_dpp v57, v23, v9 quad_perm:[0,0,0,0] row_mask:0xf bank_mask:0xf
    v_and_b32_dpp v58, v23, v10 quad_perm:[0,0,0,0] row_mask:0xf bank_mask:0xf
    v_and_b32_dpp v59, v23, v11 quad_perm:[0,0,0,0] row_mask:0xf bank_mask:0xf
    ds_read_b128 v[52:55], v14 offset:20480
    s_nop 0
    v_mfma_f32_16x16x32_bf16 v[36:39], v[56:59], v[216:219], v[36:39]
    v_and_b32_dpp v60, v30, v8 quad_perm:[0,0,0,0] row_mask:0xf bank_mask:0xf
    v_and_b32_dpp v61, v30, v9 quad_perm:[0,0,0,0] row_mask:0xf bank_mask:0xf
    v_and_b32_dpp v62, v30, v10 quad_perm:[0,0,0,0] row_mask:0xf bank_mask:0xf
    v_and_b32_dpp v63, v30, v11 quad_perm:[0,0,0,0] row_mask:0xf bank_mask:0xf
    s_waitcnt lgkmcnt(2)
    s_nop 0
    v_mfma_f32_16x16x32_bf16 v[40:43], v[60:63], v[44:47], v[40:43]
    v_and_b32_dpp v56, v23, v8 quad_perm:[1,1,1,1] row_mask:0xf bank_mask:0xf
    v_and_b32_dpp v57, v23, v9 quad_perm:[1,1,1,1] row_mask:0xf bank_mask:0xf
    v_and_b32_dpp v58, v23, v10 quad_perm:[1,1,1,1] row_mask:0xf bank_mask:0xf
    v_and_b32_dpp v59, v23, v11 quad_perm:[1,1,1,1] row_mask:0xf bank_mask:0xf
    ds_read_b128 v[44:47], v14 offset:21504
    s_nop 0
    v_mfma_f32_16x16x32_bf16 v[36:39], v[56:59], v[220:223], v[36:39]
    v_and_b32_dpp v60, v30, v8 quad_perm:[1,1,1,1] row_mask:0xf bank_mask:0xf
    v_and_b32_dpp v61, v30, v9 quad_perm:[1,1,1,1] row_mask:0xf bank_mask:0xf
    v_and_b32_dpp v62, v30, v10 quad_perm:[1,1,1,1] row_mask:0xf bank_mask:0xf
    v_and_b32_dpp v63, v30, v11 quad_perm:[1,1,1,1] row_mask:0xf bank_mask:0xf
    s_waitcnt lgkmcnt(2)
    s_nop 0
    v_mfma_f32_16x16x32_bf16 v[40:43], v[60:63], v[48:51], v[40:43]
    v_and_b32_dpp v56, v30, v8 quad_perm:[2,2,2,2] row_mask:0xf bank_mask:0xf
    v_and_b32_dpp v57, v30, v9 quad_perm:[2,2,2,2] row_mask:0xf bank_mask:0xf
    v_and_b32_dpp v58, v30, v10 quad_perm:[2,2,2,2] row_mask:0xf bank_mask:0xf
    v_and_b32_dpp v59, v30, v11 quad_perm:[2,2,2,2] row_mask:0xf bank_mask:0xf
    ds_read_b128 v[48:51], v14 offset:22528
    s_waitcnt lgkmcnt(2)
    v_mfma_f32_16x16x32_bf16 v[36:39], v[56:59], v[52:55], v[36:39]
    v_and_b32_dpp v60, v23, v8 quad_perm:[2,2,2,2] row_mask:0xf bank_mask:0xf
    v_and_b32_dpp v61, v23, v9 quad_perm:[2,2,2,2] row_mask:0xf bank_mask:0xf
    v_and_b32_dpp v62, v23, v10 quad_perm:[2,2,2,2] row_mask:0xf bank_mask:0xf
    v_and_b32_dpp v63, v23, v11 quad_perm:[2,2,2,2] row_mask:0xf bank_mask:0xf
    ds_read_b128 v[52:55], v14 offset:23552
    s_nop 0
    v_mfma_f32_16x16x32_bf16 v[40:43], v[60:63], v[224:227], v[40:43]
    v_and_b32_dpp v56, v30, v8 quad_perm:[3,3,3,3] row_mask:0xf bank_mask:0xf
    v_and_b32_dpp v57, v30, v9 quad_perm:[3,3,3,3] row_mask:0xf bank_mask:0xf
    v_and_b32_dpp v58, v30, v10 quad_perm:[3,3,3,3] row_mask:0xf bank_mask:0xf
    v_and_b32_dpp v59, v30, v11 quad_perm:[3,3,3,3] row_mask:0xf bank_mask:0xf
    s_waitcnt lgkmcnt(2)
    s_nop 0
    v_mfma_f32_16x16x32_bf16 v[36:39], v[56:59], v[44:47], v[36:39]
    v_and_b32_dpp v60, v23, v8 quad_perm:[3,3,3,3] row_mask:0xf bank_mask:0xf
    v_and_b32_dpp v61, v23, v9 quad_perm:[3,3,3,3] row_mask:0xf bank_mask:0xf
    v_and_b32_dpp v62, v23, v10 quad_perm:[3,3,3,3] row_mask:0xf bank_mask:0xf
    v_and_b32_dpp v63, v23, v11 quad_perm:[3,3,3,3] row_mask:0xf bank_mask:0xf
    ds_read_b128 v[44:47], v14 offset:24576
    s_nop 0
    v_mfma_f32_16x16x32_bf16 v[40:43], v[60:63], v[228:231], v[40:43]
    v_and_b32_dpp v56, v31, v8 quad_perm:[0,0,0,0] row_mask:0xf bank_mask:0xf
    v_and_b32_dpp v57, v31, v9 quad_perm:[0,0,0,0] row_mask:0xf bank_mask:0xf
    v_and_b32_dpp v58, v31, v10 quad_perm:[0,0,0,0] row_mask:0xf bank_mask:0xf
    v_and_b32_dpp v59, v31, v11 quad_perm:[0,0,0,0] row_mask:0xf bank_mask:0xf
    s_waitcnt lgkmcnt(2)
    s_nop 0
    v_mfma_f32_16x16x32_bf16 v[36:39], v[56:59], v[48:51], v[36:39]
    v_and_b32_dpp v60, v31, v8 quad_perm:[1,1,1,1] row_mask:0xf bank_mask:0xf
    v_and_b32_dpp v61, v31, v9 quad_perm:[1,1,1,1] row_mask:0xf bank_mask:0xf
    v_and_b32_dpp v62, v31, v10 quad_perm:[1,1,1,1] row_mask:0xf bank_mask:0xf
    v_and_b32_dpp v63, v31, v11 quad_perm:[1,1,1,1] row_mask:0xf bank_mask:0xf
    ds_read_b128 v[48:51], v14 offset:25600
    s_waitcnt lgkmcnt(2)
    v_mfma_f32_16x16x32_bf16 v[40:43], v[60:63], v[52:55], v[40:43]
    v_and_b32_dpp v56, v24, v8 quad_perm:[0,0,0,0] row_mask:0xf bank_mask:0xf
    v_and_b32_dpp v57, v24, v9 quad_perm:[0,0,0,0] row_mask:0xf bank_mask:0xf
    v_and_b32_dpp v58, v24, v10 quad_perm:[0,0,0,0] row_mask:0xf bank_mask:0xf
    v_and_b32_dpp v59, v24, v11 quad_perm:[0,0,0,0] row_mask:0xf bank_mask:0xf
    ds_read_b128 v[52:55], v14 offset:26624
    s_nop 0
    v_mfma_f32_16x16x32_bf16 v[36:39], v[56:59], v[232:235], v[36:39]
    v_and_b32_dpp v60, v31, v8 quad_perm:[2,2,2,2] row_mask:0xf bank_mask:0xf
    v_and_b32_dpp v61, v31, v9 quad_perm:[2,2,2,2] row_mask:0xf bank_mask:0xf
    v_and_b32_dpp v62, v31, v10 quad_perm:[2,2,2,2] row_mask:0xf bank_mask:0xf
    v_and_b32_dpp v63, v31, v11 quad_perm:[2,2,2,2] row_mask:0xf bank_mask:0xf
    s_waitcnt lgkmcnt(2)
    s_nop 0
    v_mfma_f32_16x16x32_bf16 v[40:43], v[60:63], v[44:47], v[40:43]
    v_and_b32_dpp v56, v24, v8 quad_perm:[1,1,1,1] row_mask:0xf bank_mask:0xf
    v_and_b32_dpp v57, v24, v9 quad_perm:[1,1,1,1] row_mask:0xf bank_mask:0xf
    v_and_b32_dpp v58, v24, v10 quad_perm:[1,1,1,1] row_mask:0xf bank_mask:0xf
    v_and_b32_dpp v59, v24, v11 quad_perm:[1,1,1,1] row_mask:0xf bank_mask:0xf
    ds_read_b128 v[44:47], v14 offset:27648
    s_nop 0
    v_mfma_f32_16x16x32_bf16 v[36:39], v[56:59], v[236:239], v[36:39]
    v_and_b32_dpp v60, v31, v8 quad_perm:[3,3,3,3] row_mask:0xf bank_mask:0xf
    v_and_b32_dpp v61, v31, v9 quad_perm:[3,3,3,3] row_mask:0xf bank_mask:0xf
    v_and_b32_dpp v62, v31, v10 quad_perm:[3,3,3,3] row_mask:0xf bank_mask:0xf
    v_and_b32_dpp v63, v31, v11 quad_perm:[3,3,3,3] row_mask:0xf bank_mask:0xf
    s_waitcnt lgkmcnt(2)
    s_nop 0
    v_mfma_f32_16x16x32_bf16 v[40:43], v[60:63], v[48:51], v[40:43]
    v_and_b32_dpp v56, v32, v8 quad_perm:[0,0,0,0] row_mask:0xf bank_mask:0xf
    v_and_b32_dpp v57, v32, v9 quad_perm:[0,0,0,0] row_mask:0xf bank_mask:0xf
    v_and_b32_dpp v58, v32, v10 quad_perm:[0,0,0,0] row_mask:0xf bank_mask:0xf
    v_and_b32_dpp v59, v32, v11 quad_perm:[0,0,0,0] row_mask:0xf bank_mask:0xf
    ds_read_b128 v[48:51], v14 offset:28672
    s_waitcnt lgkmcnt(2)
    v_mfma_f32_16x16x32_bf16 v[36:39], v[56:59], v[52:55], v[36:39]
    v_and_b32_dpp v60, v24, v8 quad_perm:[2,2,2,2] row_mask:0xf bank_mask:0xf
    v_and_b32_dpp v61, v24, v9 quad_perm:[2,2,2,2] row_mask:0xf bank_mask:0xf
    v_and_b32_dpp v62, v24, v10 quad_perm:[2,2,2,2] row_mask:0xf bank_mask:0xf
    v_and_b32_dpp v63, v24, v11 quad_perm:[2,2,2,2] row_mask:0xf bank_mask:0xf
    ds_read_b128 v[52:55], v14 offset:29696
    s_nop 0
    v_mfma_f32_16x16x32_bf16 v[40:43], v[60:63], v[240:243], v[40:43]
    v_and_b32_dpp v56, v32, v8 quad_perm:[1,1,1,1] row_mask:0xf bank_mask:0xf
    v_and_b32_dpp v57, v32, v9 quad_perm:[1,1,1,1] row_mask:0xf bank_mask:0xf
    v_and_b32_dpp v58, v32, v10 quad_perm:[1,1,1,1] row_mask:0xf bank_mask:0xf
    v_and_b32_dpp v59, v32, v11 quad_perm:[1,1,1,1] row_mask:0xf bank_mask:0xf
    s_waitcnt lgkmcnt(2)
    s_nop 0
    v_mfma_f32_16x16x32_bf16 v[36:39], v[56:59], v[44:47], v[36:39]
    v_and_b32_dpp v60, v24, v8 quad_perm:[3,3,3,3] row_mask:0xf bank_mask:0xf
    v_and_b32_dpp v61, v24, v9 quad_perm:[3,3,3,3] row_mask:0xf bank_mask:0xf
    v_and_b32_dpp v62, v24, v10 quad_perm:[3,3,3,3] row_mask:0xf bank_mask:0xf
    v_and_b32_dpp v63, v24, v11 quad_perm:[3,3,3,3] row_mask:0xf bank_mask:0xf
    ds_read_b128 v[44:47], v14 offset:30720
    s_nop 0
    v_mfma_f32_16x16x32_bf16 v[40:43], v[60:63], v[244:247], v[40:43]
    v_and_b32_dpp v56, v32, v8 quad_perm:[2,2,2,2] row_mask:0xf bank_mask:0xf
    v_and_b32_dpp v57, v32, v9 quad_perm:[2,2,2,2] row_mask:0xf bank_mask:0xf
    v_and_b32_dpp v58, v32, v10 quad_perm:[2,2,2,2] row_mask:0xf bank_mask:0xf
    v_and_b32_dpp v59, v32, v11 quad_perm:[2,2,2,2] row_mask:0xf bank_mask:0xf
    s_waitcnt lgkmcnt(2)
    s_nop 0
    v_mfma_f32_16x16x32_bf16 v[36:39], v[56:59], v[48:51], v[36:39]
    v_and_b32_dpp v60, v32, v8 quad_perm:[3,3,3,3] row_mask:0xf bank_mask:0xf
    v_and_b32_dpp v61, v32, v9 quad_perm:[3,3,3,3] row_mask:0xf bank_mask:0xf
    v_and_b32_dpp v62, v32, v10 quad_perm:[3,3,3,3] row_mask:0xf bank_mask:0xf
    v_and_b32_dpp v63, v32, v11 quad_perm:[3,3,3,3] row_mask:0xf bank_mask:0xf
    ds_read_b128 v[48:51], v14 offset:31744
    s_waitcnt lgkmcnt(2)
    v_mfma_f32_16x16x32_bf16 v[40:43], v[60:63], v[52:55], v[40:43]
    v_and_b32_dpp v56, v25, v8 quad_perm:[0,0,0,0] row_mask:0xf bank_mask:0xf
    v_and_b32_dpp v57, v25, v9 quad_perm:[0,0,0,0] row_mask:0xf bank_mask:0xf
    v_and_b32_dpp v58, v25, v10 quad_perm:[0,0,0,0] row_mask:0xf bank_mask:0xf
    v_and_b32_dpp v59, v25, v11 quad_perm:[0,0,0,0] row_mask:0xf bank_mask:0xf
    s_nop 1
    v_mfma_f32_16x16x32_bf16 v[36:39], v[56:59], v[248:251], v[36:39]
    v_and_b32_dpp v60, v33, v8 quad_perm:[0,0,0,0] row_mask:0xf bank_mask:0xf
    v_and_b32_dpp v61, v33, v9 quad_perm:[0,0,0,0] row_mask:0xf bank_mask:0xf
    v_and_b32_dpp v62, v33, v10 quad_perm:[0,0,0,0] row_mask:0xf bank_mask:0xf
    v_and_b32_dpp v63, v33, v11 quad_perm:[0,0,0,0] row_mask:0xf bank_mask:0xf
    s_waitcnt lgkmcnt(1)
    s_nop 0
    v_mfma_f32_16x16x32_bf16 v[40:43], v[60:63], v[44:47], v[40:43]
    v_and_b32_dpp v56, v25, v8 quad_perm:[1,1,1,1] row_mask:0xf bank_mask:0xf
    v_and_b32_dpp v57, v25, v9 quad_perm:[1,1,1,1] row_mask:0xf bank_mask:0xf
    v_and_b32_dpp v58, v25, v10 quad_perm:[1,1,1,1] row_mask:0xf bank_mask:0xf
    v_and_b32_dpp v59, v25, v11 quad_perm:[1,1,1,1] row_mask:0xf bank_mask:0xf
    s_nop 1
    v_mfma_f32_16x16x32_bf16 v[36:39], v[56:59], v[252:255], v[36:39]
    v_and_b32_dpp v60, v33, v8 quad_perm:[1,1,1,1] row_mask:0xf bank_mask:0xf
    v_and_b32_dpp v61, v33, v9 quad_perm:[1,1,1,1] row_mask:0xf bank_mask:0xf
    v_and_b32_dpp v62, v33, v10 quad_perm:[1,1,1,1] row_mask:0xf bank_mask:0xf
    v_and_b32_dpp v63, v33, v11 quad_perm:[1,1,1,1] row_mask:0xf bank_mask:0xf
    s_waitcnt lgkmcnt(0)
    s_nop 0
    v_mfma_f32_16x16x32_bf16 v[40:43], v[60:63], v[48:51], v[40:43]
    v_add_u32 v16, s91, v13
    s_nop 6
    v_add_f32 v36, v36, v40
    v_add_f32 v37, v37, v41
    v_add_f32 v38, v38, v42
    v_add_f32 v39, v39, v43
    s_mov_b32 exec_lo, 0xff00ff
    s_mov_b32 exec_hi, 0xff00ff00
    ds_write_b128 v16, v[36:39] offset:15872
    s_mov_b64 exec, -1
    s_waitcnt lgkmcnt(0)
    s_barrier
    s_cmp_lg_u32 s3, 0
    s_cbranch_scc1 L_c_s3_done
    s_add_u32 s74, s91, 15872
    s_mov_b32 exec_lo, 0xffffffff
    s_mov_b32 exec_hi, 0x0
    v_lshlrev_b32 v40, 2, v0
    v_add_u32 v40, s90, v40
    ds_read_b32 v40, v40 offset:5120
    v_lshlrev_b32 v16, 3, v0
    v_add_u32 v16, s74, v16
    ds_read_b64 v[20:21], v16 offset:0
    ds_read_b64 v[22:23], v16 offset:256
    ds_read_b64 v[24:25], v16 offset:512
    ds_read_b64 v[26:27], v16 offset:768
    ds_read_b64 v[28:29], v16 offset:1024
    ds_read_b64 v[30:31], v16 offset:1280
    ds_read_b64 v[32:33], v16 offset:1536
    ds_read_b64 v[34:35], v16 offset:1792
    s_waitcnt lgkmcnt(0)
    v_pk_add_f32 v[20:21], v[20:21], v[22:23]
    v_pk_add_f32 v[24:25], v[24:25], v[26:27]
    v_pk_add_f32 v[28:29], v[28:29], v[30:31]
    v_pk_add_f32 v[32:33], v[32:33], v[34:35]
    v_pk_add_f32 v[20:21], v[20:21], v[24:25]
    v_pk_add_f32 v[28:29], v[28:29], v[32:33]
    v_pk_add_f32 v[36:37], v[20:21], v[28:29]
    v_cvt_pk_bf16_f32 v36, v36, v37
    v_lshlrev_b32 v16, 16, v36
    v_and_b32 v17, 0xffff0000, v36
    v_lshlrev_b32 v18, 16, v40
    v_and_b32 v19, 0xffff0000, v40
    v_add_f32 v16, v16, v18
    v_add_f32 v17, v17, v19
    v_cvt_pk_bf16_f32 v36, v16, v17
    v_lshlrev_b32 v16, 2, v0
    s_mul_i32 s74, s65, 1280
    s_add_u32 s74, s74, s35
    s_cmp_eq_u32 s66, 1
    s_cbranch_scc1 L_c_s3_out
    s_add_u32 s74, s74, 2247680
    buffer_store_dword v36, v16, s[24:27], s74 offen sc1
    s_branch L_c_s3_st
L_c_s3_out:
    s_mov_b32 s8, s56
    s_mov_b32 s9, s57
    s_mov_b32 s10, 2560
    s_mov_b32 s11, 0x20000
    buffer_store_dword v36, v16, s[8:11], s74 offen
L_c_s3_st:
    s_mov_b64 exec, -1
L_c_s3_done:
    s_cmp_eq_u32 s72, 1
    s_cbranch_scc0 L_c_s3_fin
    s_mov_b32 s72, 0
    s_mov_b32 s64, 1
    s_mov_b32 s65, 1
    s_mov_b32 s66, 0
    s_mov_b32 s90, 0
    s_mov_b32 s91, 0
    s_branch L_c_s3_body
L_c_s3_fin:
    s_cmp_eq_u32 s66, 1
    s_cbranch_scc1 L_c_next
    s_mul_i32 s74, s65, 1280
    s_add_u32 s74, s74, 2247680
    s_mov_b32 s37, s74
    v_and_b32 v24, 0xf0, v15
    v_mov_b32 v160, -1
    v_mov_b32 v161, -1
    v_mov_b32 v162, -1
    v_mov_b32 v163, -1
    v_mov_b32 v164, -1
    v_mov_b32 v165, -1
    v_mov_b32 v166, -1
    v_mov_b32 v167, -1
    s_mov_b32 s73, 0
    s_nop 0
L_pl_25:
    buffer_load_dwordx4 v[160:163], v15, s[24:27], s37 offen sc1
    buffer_load_dwordx4 v[164:167], v24, s[24:27], s37 offen offset:1024 sc1
    s_waitcnt vmcnt(0)
    v_max3_u32 v25, v160, v161, v162
    v_max3_u32 v25, v25, v163, v164
    v_max3_u32 v25, v25, v165, v166
    v_max_u32 v25, v25, v167
    v_cmp_eq_u32 vcc, -1, v25
    s_add_u32 s73, s73, 1
    s_cmp_gt_u32 s73, 60000
    s_nop 1
    s_cbranch_scc1 L_pd_26
    s_cbranch_vccnz L_pl_25
L_pd_26:
    s_mov_b32 s28, 2
L_c_s4:
    s_cmp_lg_u32 s3, 0
    s_cbranch_scc1 L_c_noraw
    s_mul_i32 s74, s65, 1280
    v_add_u32 v24, s74, v15
    ds_write_b128 v24, v[160:163] offset:24064
    s_mov_b32 exec_lo, 0xffff
    s_mov_b32 exec_hi, 0x0
    ds_write_b128 v24, v[164:167] offset:25088
    s_mov_b64 exec, -1
L_c_noraw:
    v_lshlrev_b32 v24, 16, v160
    v_and_b32 v25, 0xffff0000, v160
    v_lshlrev_b32 v26, 16, v161
    v_and_b32 v27, 0xffff0000, v161
    v_lshlrev_b32 v28, 16, v162
    v_and_b32 v29, 0xffff0000, v162
    v_lshlrev_b32 v30, 16, v163
    v_and_b32 v31, 0xffff0000, v163
    v_mov_b32 v32, 0
    v_mov_b32 v33, 0
    v_mov_b32 v34, 0
    v_mov_b32 v35, 0
    v_mov_b32 v36, 0
    v_mov_b32 v37, 0
    v_mov_b32 v38, 0
    v_mov_b32 v39, 0
    s_mov_b32 exec_lo, 0xffff
    s_mov_b32 exec_hi, 0x0
    v_lshlrev_b32 v32, 16, v164
    v_and_b32 v33, 0xffff0000, v164
    v_lshlrev_b32 v34, 16, v165
    v_and_b32 v35, 0xffff0000, v165
    v_lshlrev_b32 v36, 16, v166
    v_and_b32 v37, 0xffff0000, v166
    v_lshlrev_b32 v38, 16, v167
    v_and_b32 v39, 0xffff0000, v167
    s_mov_b64 exec, -1
    v_pk_add_f32 v[40:41], v[24:25], v[26:27]
    v_pk_add_f32 v[42:43], v[28:29], v[30:31]
    v_pk_add_f32 v[40:41], v[40:41], v[32:33]
    v_pk_add_f32 v[42:43], v[42:43], v[34:35]
    v_pk_add_f32 v[40:41], v[40:41], v[36:37]
    v_pk_add_f32 v[42:43], v[42:43], v[38:39]
    v_pk_add_f32 v[40:41], v[40:41], v[42:43]
    v_add_f32 v44, v40, v41
    s_nop 1
    v_add_f32_dpp v44, v44, v44 quad_perm:[1,0,3,2] row_mask:0xf bank_mask:0xf
    s_nop 1
    v_add_f32_dpp v44, v44, v44 quad_perm:[2,3,0,1] row_mask:0xf bank_mask:0xf
    s_nop 1
    v_add_f32_dpp v44, v44, v44 row_ror:4 row_mask:0xf bank_mask:0xf
    s_nop 1
    v_add_f32_dpp v44, v44, v44 row_ror:8 row_mask:0xf bank_mask:0xf
    v_mov_b32 v40, v44
    s_nop 1
    v_permlane16_swap_b32 v44, v40
    v_add_f32 v44, v44, v40
    v_mov_b32 v40, v44
    s_nop 1
    v_permlane32_swap_b32 v44, v40
    v_add_f32 v44, v44, v40
    v_mul_f32 v44, 0x3acccccd, v44
    v_sub_f32 v46, 0, v44
    v_sub_f32 v47, 0, v44
    v_mov_b32 v40, 0
    v_mov_b32 v41, 0
    v_mov_b32 v42, 0
    v_mov_b32 v43, 0
    v_pk_add_f32 v[48:49], v[24:25], v[46:47]
    v_pk_fma_f32 v[40:41], v[48:49], v[48:49], v[40:41]
    v_pk_add_f32 v[50:51], v[26:27], v[46:47]
    v_pk_fma_f32 v[42:43], v[50:51], v[50:51], v[42:43]
    v_pk_add_f32 v[48:49], v[28:29], v[46:47]
    v_pk_fma_f32 v[40:41], v[48:49], v[48:49], v[40:41]
    v_pk_add_f32 v[50:51], v[30:31], v[46:47]
    v_pk_fma_f32 v[42:43], v[50:51], v[50:51], v[42:43]
    s_mov_b32 exec_lo, 0xffff
    s_mov_b32 exec_hi, 0x0
    v_pk_add_f32 v[48:49], v[32:33], v[46:47]
    v_pk_fma_f32 v[40:41], v[48:49], v[48:49], v[40:41]
    v_pk_add_f32 v[50:51], v[34:35], v[46:47]
    v_pk_fma_f32 v[42:43], v[50:51], v[50:51], v[42:43]
    v_pk_add_f32 v[48:49], v[36:37], v[46:47]
    v_pk_fma_f32 v[40:41], v[48:49], v[48:49], v[40:41]
    v_pk_add_f32 v[50:51], v[38:39], v[46:47]
    v_pk_fma_f32 v[42:43], v[50:51], v[50:51], v[42:43]
    s_mov_b64 exec, -1
    v_pk_add_f32 v[40:41], v[40:41], v[42:43]
    v_add_f32 v45, v40, v41
    s_nop 1
    v_add_f32_dpp v45, v45, v45 quad_perm:[1,0,3,2] row_mask:0xf bank_mask:0xf
    s_nop 1
    v_add_f32_dpp v45, v45, v45 quad_perm:[2,3,0,1] row_mask:0xf bank_mask:0xf
    s_nop 1
    v_add_f32_dpp v45, v45, v45 row_ror:4 row_mask:0xf bank_mask:0xf
    s_nop 1
    v_add_f32_dpp v45, v45, v45 row_ror:8 row_mask:0xf bank_mask:0xf
    v_mov_b32 v40, v45
    s_nop 1
    v_permlane16_swap_b32 v45, v40
    v_add_f32 v45, v45, v40
    v_mov_b32 v40, v45
    s_nop 1
    v_permlane32_swap_b32 v45, v40
    v_add_f32 v45, v45, v40
    v_mul_f32 v45, 0x3acccccd, v45
    v_cvt_pk_bf16_f32 v45, v45, v45
    v_and_b32 v45, 0xffff0000, v45
    v_add_f32 v45, 0x3727c5ac, v45
    v_cvt_pk_bf16_f32 v45, v45, v45
    v_and_b32 v45, 0xffff0000, v45
    v_sqrt_f32 v45, v45
    s_nop 0
    v_cvt_pk_bf16_f32 v45, v45, v45
    v_and_b32 v45, 0xffff0000, v45
    v_rcp_f32 v40, v45
    v_cvt_pk_bf16_f32 v44, v44, v44
    v_and_b32 v44, 0xffff0000, v44
    v_mov_b32 v41, v40
    v_sub_f32 v46, 0, v44
    v_sub_f32 v47, 0, v44
    v_pk_add_f32 v[24:25], v[24:25], v[46:47]
    v_pk_add_f32 v[26:27], v[26:27], v[46:47]
    v_pk_add_f32 v[28:29], v[28:29], v[46:47]
    v_pk_add_f32 v[30:31], v[30:31], v[46:47]
    v_pk_add_f32 v[32:33], v[32:33], v[46:47]
    v_pk_add_f32 v[34:35], v[34:35], v[46:47]
    v_pk_add_f32 v[36:37], v[36:37], v[46:47]
    v_pk_add_f32 v[38:39], v[38:39], v[46:47]
    v_cvt_pk_bf16_f32 v16, v24, v25
    v_cvt_pk_bf16_f32 v17, v26, v27
    v_cvt_pk_bf16_f32 v18, v28, v29
    v_cvt_pk_bf16_f32 v19, v30, v31
    v_cvt_pk_bf16_f32 v20, v32, v33
    v_cvt_pk_bf16_f32 v21, v34, v35
    v_cvt_pk_bf16_f32 v22, v36, v37
    v_cvt_pk_bf16_f32 v23, v38, v39
    v_lshlrev_b32 v24, 16, v16
    v_and_b32 v25, 0xffff0000, v16
    v_lshlrev_b32 v26, 16, v17
    v_and_b32 v27, 0xffff0000, v17
    v_lshlrev_b32 v28, 16, v18
    v_and_b32 v29, 0xffff0000, v18
    v_lshlrev_b32 v30, 16, v19
    v_and_b32 v31, 0xffff0000, v19
    v_lshlrev_b32 v32, 16, v20
    v_and_b32 v33, 0xffff0000, v20
    v_lshlrev_b32 v34, 16, v21
    v_and_b32 v35, 0xffff0000, v21
    v_lshlrev_b32 v36, 16, v22
    v_and_b32 v37, 0xffff0000, v22
    v_lshlrev_b32 v38, 16, v23
    v_and_b32 v39, 0xffff0000, v23
    v_pk_mul_f32 v[24:25], v[24:25], v[40:41]
    v_pk_mul_f32 v[26:27], v[26:27], v[40:41]
    v_pk_mul_f32 v[28:29], v[28:29], v[40:41]
    v_pk_mul_f32 v[30:31], v[30:31], v[40:41]
    v_pk_mul_f32 v[32:33], v[32:33], v[40:41]
    v_pk_mul_f32 v[34:35], v[34:35], v[40:41]
    v_pk_mul_f32 v[36:37], v[36:37], v[40:41]
    v_pk_mul_f32 v[38:39], v[38:39], v[40:41]
    v_cvt_pk_bf16_f32 v16, v24, v25
    v_cvt_pk_bf16_f32 v17, v26, v27
    v_cvt_pk_bf16_f32 v18, v28, v29
    v_cvt_pk_bf16_f32 v19, v30, v31
    v_cvt_pk_bf16_f32 v20, v32, v33
    v_cvt_pk_bf16_f32 v21, v34, v35
    v_cvt_pk_bf16_f32 v22, v36, v37
    v_cvt_pk_bf16_f32 v23, v38, v39
    v_add_u32 v40, s68, v15
    ds_write_b128 v40, v[16:19]
    s_mov_b32 exec_lo, 0xffff
    s_mov_b32 exec_hi, 0x0
    ds_write_b128 v40, v[20:23] offset:1024
    s_mov_b64 exec, -1
    v_and_b32 v16, 15, v0
    v_lshlrev_b32 v16, 3, v16
    v_lshrrev_b32 v17, 4, v0
    v_lshlrev_b32 v17, 1, v17
    v_add_u32 v16, v16, v17
    s_mul_i32 s74, s3, 320
    s_add_u32 s74, s74, s68
    v_add_u32 v16, s74, v16
    s_waitcnt lgkmcnt(0)
    ds_read_u16 v20, v16 offset:0
    ds_read_u16 v21, v16 offset:128
    ds_read_u16 v22, v16 offset:256
    s_waitcnt lgkmcnt(2)
    v_lshl_or_b32 v20, v20, 16, v20
    s_waitcnt lgkmcnt(1)
    v_lshl_or_b32 v21, v21, 16, v21
    s_waitcnt lgkmcnt(0)
    v_lshl_or_b32 v22, v22, 16, v22
    s_cmp_lg_u32 s63, 0
    s_cbranch_scc1 L_c_wqok
    s_waitcnt vmcnt(9)
L_c_wqok:
    s_cmp_lg_u32 s63, 1
    s_cbranch_scc1 L_c_clrok
    s_waitcnt vmcnt(32)
L_c_clrok:
    v_and_b32_dpp v56, v20, v4 row_newbcast:0 row_mask:0xf bank_mask:0xf
    v_and_b32_dpp v57, v20, v5 row_newbcast:0 row_mask:0xf bank_mask:0xf
    v_and_b32_dpp v58, v20, v6 row_newbcast:0 row_mask:0xf bank_mask:0xf
    v_and_b32_dpp v59, v20, v7 row_newbcast:0 row_mask:0xf bank_mask:0xf
    s_nop 1
    v_mfma_f32_16x16x32_bf16 v[28:31], v[56:59], a[0:3], 0
    v_and_b32_dpp v60, v20, v4 row_newbcast:1 row_mask:0xf bank_mask:0xf
    v_and_b32_dpp v61, v20, v5 row_newbcast:1 row_mask:0xf bank_mask:0xf
    v_and_b32_dpp v62, v20, v6 row_newbcast:1 row_mask:0xf bank_mask:0xf
    v_and_b32_dpp v63, v20, v7 row_newbcast:1 row_mask:0xf bank_mask:0xf
    s_nop 1
    v_mfma_f32_16x16x32_bf16 v[32:35], v[60:63], a[4:7], 0
    v_and_b32_dpp v56, v20, v4 row_newbcast:2 row_mask:0xf bank_mask:0xf
    v_and_b32_dpp v57, v20, v5 row_newbcast:2 row_mask:0xf bank_mask:0xf
    v_and_b32_dpp v58, v20, v6 row_newbcast:2 row_mask:0xf bank_mask:0xf
    v_and_b32_dpp v59, v20, v7 row_newbcast:2 row_mask:0xf bank_mask:0xf
    s_nop 1
    v_mfma_f32_16x16x32_bf16 v[28:31], v[56:59], a[8:11], v[28:31]
    v_and_b32_dpp v60, v20, v4 row_newbcast:3 row_mask:0xf bank_mask:0xf
    v_and_b32_dpp v61, v20, v5 row_newbcast:3 row_mask:0xf bank_mask:0xf
    v_and_b32_dpp v62, v20, v6 row_newbcast:3 row_mask:0xf bank_mask:0xf
    v_and_b32_dpp v63, v20, v7 row_newbcast:3 row_mask:0xf bank_mask:0xf
    s_nop 1
    v_mfma_f32_16x16x32_bf16 v[32:35], v[60:63], a[12:15], v[32:35]
    v_and_b32_dpp v56, v20, v4 row_newbcast:4 row_mask:0xf bank_mask:0xf
    v_and_b32_dpp v57, v20, v5 row_newbcast:4 row_mask:0xf bank_mask:0xf
    v_and_b32_dpp v58, v20, v6 row_newbcast:4 row_mask:0xf bank_mask:0xf
    v_and_b32_dpp v59, v20, v7 row_newbcast:4 row_mask:0xf bank_mask:0xf
    s_nop 1
    v_mfma_f32_16x16x32_bf16 v[28:31], v[56:59], a[16:19], v[28:31]
    v_and_b32_dpp v60, v20, v4 row_newbcast:5 row_mask:0xf bank_mask:0xf
    v_and_b32_dpp v61, v20, v5 row_newbcast:5 row_mask:0xf bank_mask:0xf
    v_and_b32_dpp v62, v20, v6 row_newbcast:5 row_mask:0xf bank_mask:0xf
    v_and_b32_dpp v63, v20, v7 row_newbcast:5 row_mask:0xf bank_mask:0xf
    s_nop 1
    v_mfma_f32_16x16x32_bf16 v[32:35], v[60:63], a[20:23], v[32:35]
    v_and_b32_dpp v56, v20, v4 row_newbcast:6 row_mask:0xf bank_mask:0xf
    v_and_b32_dpp v57, v20, v5 row_newbcast:6 row_mask:0xf bank_mask:0xf
    v_and_b32_dpp v58, v20, v6 row_newbcast:6 row_mask:0xf bank_mask:0xf
    v_and_b32_dpp v59, v20, v7 row_newbcast:6 row_mask:0xf bank_mask:0xf
    s_nop 1
    v_mfma_f32_16x16x32_bf16 v[28:31], v[56:59], a[24:27], v[28:31]
    v_and_b32_dpp v60, v20, v4 row_newbcast:7 row_mask:0xf bank_mask:0xf
    v_and_b32_dpp v61, v20, v5 row_newbcast:7 row_mask:0xf bank_mask:0xf
    v_and_b32_dpp v62, v20, v6 row_newbcast:7 row_mask:0xf bank_mask:0xf
    v_and_b32_dpp v63, v20, v7 row_newbcast:7 row_mask:0xf bank_mask:0xf
    s_nop 1
    v_mfma_f32_16x16x32_bf16 v[32:35], v[60:63], a[28:31], v[32:35]
    v_and_b32_dpp v56, v20, v4 row_newbcast:8 row_mask:0xf bank_mask:0xf
    v_and_b32_dpp v57, v20, v5 row_newbcast:8 row_mask:0xf bank_mask:0xf
    v_and_b32_dpp v58, v20, v6 row_newbcast:8 row_mask:0xf bank_mask:0xf
    v_and_b32_dpp v59, v20, v7 row_newbcast:8 row_mask:0xf bank_mask:0xf
    s_nop 1
    v_mfma_f32_16x16x32_bf16 v[28:31], v[56:59], a[32:35], v[28:31]
    v_and_b32_dpp v60, v20, v4 row_newbcast:9 row_mask:0xf bank_mask:0xf
    v_and_b32_dpp v61, v20, v5 row_newbcast:9 row_mask:0xf bank_mask:0xf
    v_and_b32_dpp v62, v20, v6 row_newbcast:9 row_mask:0xf bank_mask:0xf
    v_and_b32_dpp v63, v20, v7 row_newbcast:9 row_mask:0xf bank_mask:0xf
    s_nop 1
    v_mfma_f32_16x16x32_bf16 v[32:35], v[60:63], a[36:39], v[32:35]
    v_and_b32_dpp v56, v20, v4 row_newbcast:10 row_mask:0xf bank_mask:0xf
    v_and_b32_dpp v57, v20, v5 row_newbcast:10 row_mask:0xf bank_mask:0xf
    v_and_b32_dpp v58, v20, v6 row_newbcast:10 row_mask:0xf bank_mask:0xf
    v_and_b32_dpp v59, v20, v7 row_newbcast:10 row_mask:0xf bank_mask:0xf
    s_nop 1
    v_mfma_f32_16x16x32_bf16 v[28:31], v[56:59], a[40:43], v[28:31]
    v_and_b32_dpp v60, v20, v4 row_newbcast:11 row_mask:0xf bank_mask:0xf
    v_and_b32_dpp v61, v20, v5 row_newbcast:11 row_mask:0xf bank_mask:0xf
    v_and_b32_dpp v62, v20, v6 row_newbcast:11 row_mask:0xf bank_mask:0xf
    v_and_b32_dpp v63, v20, v7 row_newbcast:11 row_mask:0xf bank_mask:0xf
    s_nop 1
    v_mfma_f32_16x16x32_bf16 v[32:35], v[60:63], a[44:47], v[32:35]
    v_and_b32_dpp v56, v20, v4 row_newbcast:12 row_mask:0xf bank_mask:0xf
    v_and_b32_dpp v57, v20, v5 row_newbcast:12 row_mask:0xf bank_mask:0xf
    v_and_b32_dpp v58, v20, v6 row_newbcast:12 row_mask:0xf bank_mask:0xf
    v_and_b32_dpp v59, v20, v7 row_newbcast:12 row_mask:0xf bank_mask:0xf
    s_nop 1
    v_mfma_f32_16x16x32_bf16 v[28:31], v[56:59], a[48:51], v[28:31]
    v_and_b32_dpp v60, v20, v4 row_newbcast:13 row_mask:0xf bank_mask:0xf
    v_and_b32_dpp v61, v20, v5 row_newbcast:13 row_mask:0xf bank_mask:0xf
    v_and_b32_dpp v62, v20, v6 row_newbcast:13 row_mask:0xf bank_mask:0xf
    v_and_b32_dpp v63, v20, v7 row_newbcast:13 row_mask:0xf bank_mask:0xf
    s_nop 1
    v_mfma_f32_16x16x32_bf16 v[32:35], v[60:63], a[52:55], v[32:35]
    v_and_b32_dpp v56, v20, v4 row_newbcast:14 row_mask:0xf bank_mask:0xf
    v_and_b32_dpp v57, v20, v5 row_newbcast:14 row_mask:0xf bank_mask:0xf
    v_and_b32_dpp v58, v20, v6 row_newbcast:14 row_mask:0xf bank_mask:0xf
    v_and_b32_dpp v59, v20, v7 row_newbcast:14 row_mask:0xf bank_mask:0xf
    s_nop 1
    v_mfma_f32_16x16x32_bf16 v[28:31], v[56:59], a[56:59], v[28:31]
    v_and_b32_dpp v60, v20, v4 row_newbcast:15 row_mask:0xf bank_mask:0xf
    v_and_b32_dpp v61, v20, v5 row_newbcast:15 row_mask:0xf bank_mask:0xf
    v_and_b32_dpp v62, v20, v6 row_newbcast:15 row_mask:0xf bank_mask:0xf
    v_and_b32_dpp v63, v20, v7 row_newbcast:15 row_mask:0xf bank_mask:0xf
    s_nop 1
    v_mfma_f32_16x16x32_bf16 v[32:35], v[60:63], a[60:63], v[32:35]
    v_and_b32_dpp v56, v21, v4 row_newbcast:0 row_mask:0xf bank_mask:0xf
    v_and_b32_dpp v57, v21, v5 row_newbcast:0 row_mask:0xf bank_mask:0xf
    v_and_b32_dpp v58, v21, v6 row_newbcast:0 row_mask:0xf bank_mask:0xf
    v_and_b32_dpp v59, v21, v7 row_newbcast:0 row_mask:0xf bank_mask:0xf
    s_nop 1
    v_mfma_f32_16x16x32_bf16 v[28:31], v[56:59], a[64:67], v[28:31]
    v_and_b32_dpp v60, v21, v4 row_newbcast:1 row_mask:0xf bank_mask:0xf
    v_and_b32_dpp v61, v21, v5 row_newbcast:1 row_mask:0xf bank_mask:0xf
    v_and_b32_dpp v62, v21, v6 row_newbcast:1 row_mask:0xf bank_mask:0xf
    v_and_b32_dpp v63, v21, v7 row_newbcast:1 row_mask:0xf bank_mask:0xf
    s_nop 1
    v_mfma_f32_16x16x32_bf16 v[32:35], v[60:63], a[68:71], v[32:35]
    v_and_b32_dpp v56, v21, v4 row_newbcast:2 row_mask:0xf bank_mask:0xf
    v_and_b32_dpp v57, v21, v5 row_newbcast:2 row_mask:0xf bank_mask:0xf
    v_and_b32_dpp v58, v21, v6 row_newbcast:2 row_mask:0xf bank_mask:0xf
    v_and_b32_dpp v59, v21, v7 row_newbcast:2 row_mask:0xf bank_mask:0xf
    s_nop 1
    v_mfma_f32_16x16x32_bf16 v[28:31], v[56:59], a[72:75], v[28:31]
    v_and_b32_dpp v60, v21, v4 row_newbcast:3 row_mask:0xf bank_mask:0xf
    v_and_b32_dpp v61, v21, v5 row_newbcast:3 row_mask:0xf bank_mask:0xf
    v_and_b32_dpp v62, v21, v6 row_newbcast:3 row_mask:0xf bank_mask:0xf
    v_and_b32_dpp v63, v21, v7 row_newbcast:3 row_mask:0xf bank_mask:0xf
    s_nop 1
    v_mfma_f32_16x16x32_bf16 v[32:35], v[60:63], a[76:79], v[32:35]
    v_and_b32_dpp v56, v21, v4 row_newbcast:4 row_mask:0xf bank_mask:0xf
    v_and_b32_dpp v57, v21, v5 row_newbcast:4 row_mask:0xf bank_mask:0xf
    v_and_b32_dpp v58, v21, v6 row_newbcast:4 row_mask:0xf bank_mask:0xf
    v_and_b32_dpp v59, v21, v7 row_newbcast:4 row_mask:0xf bank_mask:0xf
    s_nop 1
    v_mfma_f32_16x16x32_bf16 v[28:31], v[56:59], a[80:83], v[28:31]
    v_and_b32_dpp v60, v21, v4 row_newbcast:5 row_mask:0xf bank_mask:0xf
    v_and_b32_dpp v61, v21, v5 row_newbcast:5 row_mask:0xf bank_mask:0xf
    v_and_b32_dpp v62, v21, v6 row_newbcast:5 row_mask:0xf bank_mask:0xf
    v_and_b32_dpp v63, v21, v7 row_newbcast:5 row_mask:0xf bank_mask:0xf
    s_nop 1
    v_mfma_f32_16x16x32_bf16 v[32:35], v[60:63], a[84:87], v[32:35]
    v_and_b32_dpp v56, v21, v4 row_newbcast:6 row_mask:0xf bank_mask:0xf
    v_and_b32_dpp v57, v21, v5 row_newbcast:6 row_mask:0xf bank_mask:0xf
    v_and_b32_dpp v58, v21, v6 row_newbcast:6 row_mask:0xf bank_mask:0xf
    v_and_b32_dpp v59, v21, v7 row_newbcast:6 row_mask:0xf bank_mask:0xf
    s_nop 1
    v_mfma_f32_16x16x32_bf16 v[28:31], v[56:59], a[88:91], v[28:31]
    v_and_b32_dpp v60, v21, v4 row_newbcast:7 row_mask:0xf bank_mask:0xf
    v_and_b32_dpp v61, v21, v5 row_newbcast:7 row_mask:0xf bank_mask:0xf
    v_and_b32_dpp v62, v21, v6 row_newbcast:7 row_mask:0xf bank_mask:0xf
    v_and_b32_dpp v63, v21, v7 row_newbcast:7 row_mask:0xf bank_mask:0xf
    s_nop 1
    v_mfma_f32_16x16x32_bf16 v[32:35], v[60:63], a[92:95], v[32:35]
    v_and_b32_dpp v56, v21, v4 row_newbcast:8 row_mask:0xf bank_mask:0xf
    v_and_b32_dpp v57, v21, v5 row_newbcast:8 row_mask:0xf bank_mask:0xf
    v_and_b32_dpp v58, v21, v6 row_newbcast:8 row_mask:0xf bank_mask:0xf
    v_and_b32_dpp v59, v21, v7 row_newbcast:8 row_mask:0xf bank_mask:0xf
    s_nop 1
    v_mfma_f32_16x16x32_bf16 v[28:31], v[56:59], a[96:99], v[28:31]
    v_and_b32_dpp v60, v21, v4 row_newbcast:9 row_mask:0xf bank_mask:0xf
    v_and_b32_dpp v61, v21, v5 row_newbcast:9 row_mask:0xf bank_mask:0xf
    v_and_b32_dpp v62, v21, v6 row_newbcast:9 row_mask:0xf bank_mask:0xf
    v_and_b32_dpp v63, v21, v7 row_newbcast:9 row_mask:0xf bank_mask:0xf
    s_nop 1
    v_mfma_f32_16x16x32_bf16 v[32:35], v[60:63], a[100:103], v[32:35]
    v_and_b32_dpp v56, v21, v4 row_newbcast:10 row_mask:0xf bank_mask:0xf
    v_and_b32_dpp v57, v21, v5 row_newbcast:10 row_mask:0xf bank_mask:0xf
    v_and_b32_dpp v58, v21, v6 row_newbcast:10 row_mask:0xf bank_mask:0xf
    v_and_b32_dpp v59, v21, v7 row_newbcast:10 row_mask:0xf bank_mask:0xf
    s_nop 1
    v_mfma_f32_16x16x32_bf16 v[28:31], v[56:59], a[104:107], v[28:31]
    v_and_b32_dpp v60, v21, v4 row_newbcast:11 row_mask:0xf bank_mask:0xf
    v_and_b32_dpp v61, v21, v5 row_newbcast:11 row_mask:0xf bank_mask:0xf
    v_and_b32_dpp v62, v21, v6 row_newbcast:11 row_mask:0xf bank_mask:0xf
    v_and_b32_dpp v63, v21, v7 row_newbcast:11 row_mask:0xf bank_mask:0xf
    s_nop 1
    v_mfma_f32_16x16x32_bf16 v[32:35], v[60:63], a[108:111], v[32:35]
    v_and_b32_dpp v56, v21, v4 row_newbcast:12 row_mask:0xf bank_mask:0xf
    v_and_b32_dpp v57, v21, v5 row_newbcast:12 row_mask:0xf bank_mask:0xf
    v_and_b32_dpp v58, v21, v6 row_newbcast:12 row_mask:0xf bank_mask:0xf
    v_and_b32_dpp v59, v21, v7 row_newbcast:12 row_mask:0xf bank_mask:0xf
    s_nop 1
    v_mfma_f32_16x16x32_bf16 v[28:31], v[56:59], a[112:115], v[28:31]
    v_and_b32_dpp v60, v21, v4 row_newbcast:13 row_mask:0xf bank_mask:0xf
    v_and_b32_dpp v61, v21, v5 row_newbcast:13 row_mask:0xf bank_mask:0xf
    v_and_b32_dpp v62, v21, v6 row_newbcast:13 row_mask:0xf bank_mask:0xf
    v_and_b32_dpp v63, v21, v7 row_newbcast:13 row_mask:0xf bank_mask:0xf
    s_nop 1
    v_mfma_f32_16x16x32_bf16 v[32:35], v[60:63], a[116:119], v[32:35]
    v_and_b32_dpp v56, v21, v4 row_newbcast:14 row_mask:0xf bank_mask:0xf
    v_and_b32_dpp v57, v21, v5 row_newbcast:14 row_mask:0xf bank_mask:0xf
    v_and_b32_dpp v58, v21, v6 row_newbcast:14 row_mask:0xf bank_mask:0xf
    v_and_b32_dpp v59, v21, v7 row_newbcast:14 row_mask:0xf bank_mask:0xf
    s_nop 1
    v_mfma_f32_16x16x32_bf16 v[28:31], v[56:59], a[120:123], v[28:31]
    v_and_b32_dpp v60, v21, v4 row_newbcast:15 row_mask:0xf bank_mask:0xf
    v_and_b32_dpp v61, v21, v5 row_newbcast:15 row_mask:0xf bank_mask:0xf
    v_and_b32_dpp v62, v21, v6 row_newbcast:15 row_mask:0xf bank_mask:0xf
    v_and_b32_dpp v63, v21, v7 row_newbcast:15 row_mask:0xf bank_mask:0xf
    s_nop 1
    v_mfma_f32_16x16x32_bf16 v[32:35], v[60:63], a[124:127], v[32:35]
    v_and_b32_dpp v56, v22, v4 row_newbcast:0 row_mask:0xf bank_mask:0xf
    v_and_b32_dpp v57, v22, v5 row_newbcast:0 row_mask:0xf bank_mask:0xf
    v_and_b32_dpp v58, v22, v6 row_newbcast:0 row_mask:0xf bank_mask:0xf
    v_and_b32_dpp v59, v22, v7 row_newbcast:0 row_mask:0xf bank_mask:0xf
    s_nop 1
    v_mfma_f32_16x16x32_bf16 v[28:31], v[56:59], a[128:131], v[28:31]
    v_and_b32_dpp v60, v22, v4 row_newbcast:1 row_mask:0xf bank_mask:0xf
    v_and_b32_dpp v61, v22, v5 row_newbcast:1 row_mask:0xf bank_mask:0xf
    v_and_b32_dpp v62, v22, v6 row_newbcast:1 row_mask:0xf bank_mask:0xf
    v_and_b32_dpp v63, v22, v7 row_newbcast:1 row_mask:0xf bank_mask:0xf
    s_nop 1
    v_mfma_f32_16x16x32_bf16 v[32:35], v[60:63], a[132:135], v[32:35]
    v_and_b32_dpp v56, v22, v4 row_newbcast:2 row_mask:0xf bank_mask:0xf
    v_and_b32_dpp v57, v22, v5 row_newbcast:2 row_mask:0xf bank_mask:0xf
    v_and_b32_dpp v58, v22, v6 row_newbcast:2 row_mask:0xf bank_mask:0xf
    v_and_b32_dpp v59, v22, v7 row_newbcast:2 row_mask:0xf bank_mask:0xf
    s_nop 1
    v_mfma_f32_16x16x32_bf16 v[28:31], v[56:59], a[136:139], v[28:31]
    v_and_b32_dpp v60, v22, v4 row_newbcast:3 row_mask:0xf bank_mask:0xf
    v_and_b32_dpp v61, v22, v5 row_newbcast:3 row_mask:0xf bank_mask:0xf
    v_and_b32_dpp v62, v22, v6 row_newbcast:3 row_mask:0xf bank_mask:0xf
    v_and_b32_dpp v63, v22, v7 row_newbcast:3 row_mask:0xf bank_mask:0xf
    s_nop 1
    v_mfma_f32_16x16x32_bf16 v[32:35], v[60:63], a[140:143], v[32:35]
    v_and_b32_dpp v56, v22, v4 row_newbcast:4 row_mask:0xf bank_mask:0xf
    v_and_b32_dpp v57, v22, v5 row_newbcast:4 row_mask:0xf bank_mask:0xf
    v_and_b32_dpp v58, v22, v6 row_newbcast:4 row_mask:0xf bank_mask:0xf
    v_and_b32_dpp v59, v22, v7 row_newbcast:4 row_mask:0xf bank_mask:0xf
    s_nop 1
    v_mfma_f32_16x16x32_bf16 v[28:31], v[56:59], a[144:147], v[28:31]
    v_and_b32_dpp v60, v22, v4 row_newbcast:5 row_mask:0xf bank_mask:0xf
    v_and_b32_dpp v61, v22, v5 row_newbcast:5 row_mask:0xf bank_mask:0xf
    v_and_b32_dpp v62, v22, v6 row_newbcast:5 row_mask:0xf bank_mask:0xf
    v_and_b32_dpp v63, v22, v7 row_newbcast:5 row_mask:0xf bank_mask:0xf
    s_nop 1
    v_mfma_f32_16x16x32_bf16 v[32:35], v[60:63], a[148:151], v[32:35]
    v_and_b32_dpp v56, v22, v4 row_newbcast:6 row_mask:0xf bank_mask:0xf
    v_and_b32_dpp v57, v22, v5 row_newbcast:6 row_mask:0xf bank_mask:0xf
    v_and_b32_dpp v58, v22, v6 row_newbcast:6 row_mask:0xf bank_mask:0xf
    v_and_b32_dpp v59, v22, v7 row_newbcast:6 row_mask:0xf bank_mask:0xf
    s_nop 1
    v_mfma_f32_16x16x32_bf16 v[28:31], v[56:59], a[152:155], v[28:31]
    v_and_b32_dpp v60, v22, v4 row_newbcast:7 row_mask:0xf bank_mask:0xf
    v_and_b32_dpp v61, v22, v5 row_newbcast:7 row_mask:0xf bank_mask:0xf
    v_and_b32_dpp v62, v22, v6 row_newbcast:7 row_mask:0xf bank_mask:0xf
    v_and_b32_dpp v63, v22, v7 row_newbcast:7 row_mask:0xf bank_mask:0xf
    s_nop 1
    v_mfma_f32_16x16x32_bf16 v[32:35], v[60:63], a[156:159], v[32:35]
    s_nop 7
    v_add_f32 v28, v28, v32
    v_add_f32 v29, v29, v33
    v_add_f32 v30, v30, v34
    v_add_f32 v31, v31, v35
    v_and_b32 v16, 0xf0, v15
    v_lshlrev_b32 v16, 1, v16
    v_and_b32 v17, 16, v0
    v_add_u32 v16, v16, v17
    s_and_b32 s74, s63, 1
    s_lshl_b32 s74, s74, 11
    s_lshl_b32 s75, s3, 9
    s_add_u32 s75, s75, s74
    v_add_u32 v16, s75, v16
    s_mov_b32 exec_lo, 0xffffffff
    s_mov_b32 exec_hi, 0x0
    ds_write_b128 v16, v[28:31] offset:19968
    s_mov_b64 exec, -1
    s_waitcnt lgkmcnt(0)
    s_barrier
    s_cmp_lg_u32 s3, 0
    s_cbranch_scc1 L_c_s4_done
    v_lshlrev_b32 v16, 3, v0
    v_add_u32 v16, s74, v16
    ds_read_b64 v[18:19], v16 offset:19968
    ds_read_b64 v[20:21], v16 offset:20480
    ds_read_b64 v[22:23], v16 offset:20992
    ds_read_b64 v[24:25], v16 offset:21504
    s_cmp_lg_u32 s63, 0
    s_cbranch_scc1 L_c_nocnt
    s_waitcnt vmcnt(8)
    v_cmp_gt_u32 vcc, 32, v12
    s_nop 3
    s_cbranch_vccz L_c_nocnt
    s_mov_b32 s73, 0
L_cw_27:
    v_mov_b32 v28, 0
    global_load_dword v28, v28, s[58:59] offset:0 sc1
    s_waitcnt vmcnt(0)
    v_cmp_gt_u32 vcc, 32, v28
    s_add_u32 s73, s73, 1
    s_cmp_gt_u32 s73, 60000
    s_nop 1
    s_cbranch_scc1 L_cwd_28
    s_cbranch_vccnz L_cw_27
L_cwd_28:
L_c_nocnt:
    s_waitcnt lgkmcnt(0)
    v_pk_add_f32 v[18:19], v[18:19], v[20:21]
    v_pk_add_f32 v[22:23], v[22:23], v[24:25]
    v_pk_add_f32 v[18:19], v[18:19], v[22:23]
    v_cvt_pk_bf16_f32 v18, v18, v19
    s_add_u32 s74, s28, s65
    s_mul_i32 s74, s74, 8192
    s_lshl_b32 s75, s62, 8
    s_add_u32 s74, s74, s75
    s_add_u32 s74, s74, 2195456
    v_lshlrev_b32 v16, 2, v0
    buffer_store_dword v18, v16, s[24:27], s74 offen sc1
    s_nop 0
L_c_s4_done:
    s_cmp_ge_u32 s63, 2
    s_cbranch_scc1 L_c_next
    s_cmp_eq_u32 s63, 1
    s_cbranch_scc1 L_c_ld2
    v_mov_b32 v20, -1
    v_mov_b32 v21, -1
    v_mov_b32 v22, -1
    v_mov_b32 v23, -1
    s_mul_i32 s74, s3, 81920
    s_mul_i32 s75, s62, 2560
    s_add_u32 s74, s74, s75
    s_add_u32 s74, s74, 1867776
    buffer_store_dwordx4 v[20:23], v15, s[24:27], s74 offen sc1
    buffer_store_dwordx4 v[20:23], v15, s[24:27], s74 offen offset:1024 sc1
    s_mov_b32 exec_lo, 0xffffffff
    s_mov_b32 exec_hi, 0x0
    buffer_store_dwordx4 v[20:23], v15, s[24:27], s74 offen offset:2048 sc1
    s_mov_b64 exec, -1
    s_cmp_ge_u32 s62, 22
    s_cbranch_scc1 L_c_clr_skip
    s_cmp_lt_u32 s62, 5
    s_cbranch_scc1 L_c_clr_skip
    s_mul_i32 s74, s3, 458752
    s_mul_i32 s75, s62, 14336
    s_add_u32 s74, s74, s75
    buffer_store_dwordx4 v[20:23], v15, s[24:27], s74 offen offset:0 sc1
    buffer_store_dwordx4 v[20:23], v15, s[24:27], s74 offen offset:1024 sc1
    buffer_store_dwordx4 v[20:23], v15, s[24:27], s74 offen offset:2048 sc1
    buffer_store_dwordx4 v[20:23], v15, s[24:27], s74 offen offset:3072 sc1
    s_add_u32 s74, s74, 4096
    buffer_store_dwordx4 v[20:23], v15, s[24:27], s74 offen offset:0 sc1
    buffer_store_dwordx4 v[20:23], v15, s[24:27], s74 offen offset:1024 sc1
    buffer_store_dwordx4 v[20:23], v15, s[24:27], s74 offen offset:2048 sc1
    buffer_store_dwordx4 v[20:23], v15, s[24:27], s74 offen offset:3072 sc1
    s_add_u32 s74, s74, 4096
    buffer_store_dwordx4 v[20:23], v15, s[24:27], s74 offen offset:0 sc1
    buffer_store_dwordx4 v[20:23], v15, s[24:27], s74 offen offset:1024 sc1
    buffer_store_dwordx4 v[20:23], v15, s[24:27], s74 offen offset:2048 sc1
    buffer_store_dwordx4 v[20:23], v15, s[24:27], s74 offen offset:3072 sc1
    s_add_u32 s74, s74, 4096
    buffer_store_dwordx4 v[20:23], v15, s[24:27], s74 offen offset:0 sc1
    buffer_store_dwordx4 v[20:23], v15, s[24:27], s74 offen offset:1024 sc1
    s_add_u32 s76, s62, 10
    s_cmp_ge_u32 s62, 12
    s_cbranch_scc1 L_c_clr_two
    s_sub_u32 s76, s62, 5
    s_cmp_lt_u32 s62, 10
    s_cbranch_scc1 L_c_clr_two
    s_branch L_c_clr_skip
L_c_clr_two:
    s_mul_i32 s74, s3, 458752
    s_mul_i32 s75, s76, 14336
    s_add_u32 s74, s74, s75
    buffer_store_dwordx4 v[20:23], v15, s[24:27], s74 offen offset:0 sc1
    buffer_store_dwordx4 v[20:23], v15, s[24:27], s74 offen offset:1024 sc1
    buffer_store_dwordx4 v[20:23], v15, s[24:27], s74 offen offset:2048 sc1
    buffer_store_dwordx4 v[20:23], v15, s[24:27], s74 offen offset:3072 sc1
    s_add_u32 s74, s74, 4096
    buffer_store_dwordx4 v[20:23], v15, s[24:27], s74 offen offset:0 sc1
    buffer_store_dwordx4 v[20:23], v15, s[24:27], s74 offen offset:1024 sc1
    buffer_store_dwordx4 v[20:23], v15, s[24:27], s74 offen offset:2048 sc1
    buffer_store_dwordx4 v[20:23], v15, s[24:27], s74 offen offset:3072 sc1
    s_add_u32 s74, s74, 4096
    buffer_store_dwordx4 v[20:23], v15, s[24:27], s74 offen offset:0 sc1
    buffer_store_dwordx4 v[20:23], v15, s[24:27], s74 offen offset:1024 sc1
    buffer_store_dwordx4 v[20:23], v15, s[24:27], s74 offen offset:2048 sc1
    buffer_store_dwordx4 v[20:23], v15, s[24:27], s74 offen offset:3072 sc1
    s_add_u32 s74, s74, 4096
    buffer_store_dwordx4 v[20:23], v15, s[24:27], s74 offen offset:0 sc1
    buffer_store_dwordx4 v[20:23], v15, s[24:27], s74 offen offset:1024 sc1
    s_nop 1
L_c_clr_skip:
    s_lshl_b32 s74, s62, 10
    s_lshl_b32 s75, s3, 8
    s_add_u32 s74, s74, s75
    s_add_u32 s74, s74, 2228224
    s_mov_b32 exec_lo, 0xffff
    s_mov_b32 exec_hi, 0x0
    buffer_store_dwordx4 v[20:23], v15, s[24:27], s74 offen sc1
    s_mov_b64 exec, -1
    buffer_load_dwordx4 a[192:195], v3, s[8:11], s36 offen offset:768 nt
    buffer_load_dwordx4 a[196:199], v3, s[8:11], s36 offen offset:1024 nt
    s_add_u32 s36, s36, 5120
    buffer_load_dwordx4 a[200:203], v3, s[8:11], s36 offen offset:0 nt
    buffer_load_dwordx4 a[204:207], v3, s[8:11], s36 offen offset:256 nt
    buffer_load_dwordx4 a[208:211], v3, s[8:11], s36 offen offset:512 nt
    buffer_load_dwordx4 a[212:215], v3, s[8:11], s36 offen offset:768 nt
    buffer_load_dwordx4 a[216:219], v3, s[8:11], s36 offen offset:1024 nt
    s_add_u32 s36, s36, 5120
    buffer_load_dwordx4 a[220:223], v3, s[8:11], s36 offen offset:0 nt
    buffer_load_dwordx4 a[224:227], v3, s[8:11], s36 offen offset:256 nt
    buffer_load_dwordx4 a[228:231], v3, s[8:11], s36 offen offset:512 nt
    buffer_load_dwordx4 a[232:235], v3, s[8:11], s36 offen offset:768 nt
    buffer_load_dwordx4 a[236:239], v3, s[8:11], s36 offen offset:1024 nt
    s_add_u32 s36, s36, 5120
    buffer_load_dwordx4 a[240:243], v3, s[8:11], s36 offen offset:0 nt
    buffer_load_dwordx4 a[244:247], v3, s[8:11], s36 offen offset:256 nt
    buffer_load_dwordx4 a[248:251], v3, s[8:11], s36 offen offset:512 nt
    buffer_load_dwordx4 a[252:255], v3, s[8:11], s36 offen offset:768 nt
    buffer_load_dwordx4 v[64:67], v3, s[8:11], s36 offen offset:1024 nt
    s_add_u32 s36, s36, 5120
    buffer_load_dwordx4 v[68:71], v3, s[8:11], s36 offen offset:0 nt
    buffer_load_dwordx4 v[72:75], v3, s[8:11], s36 offen offset:256 nt
    buffer_load_dwordx4 v[76:79], v3, s[8:11], s36 offen offset:512 nt
    buffer_load_dwordx4 v[80:83], v3, s[8:11], s36 offen offset:768 nt
    buffer_load_dwordx4 v[84:87], v3, s[8:11], s36 offen offset:1024 nt
    s_add_u32 s36, s36, 5120
    buffer_load_dwordx4 v[88:91], v3, s[8:11], s36 offen offset:0 nt
    buffer_load_dwordx4 v[92:95], v3, s[8:11], s36 offen offset:256 nt
    buffer_load_dwordx4 v[96:99], v3, s[8:11], s36 offen offset:512 nt
    buffer_load_dwordx4 v[100:103], v3, s[8:11], s36 offen offset:768 nt
    buffer_load_dwordx4 v[104:107], v3, s[8:11], s36 offen offset:1024 nt
    s_add_u32 s36, s36, 5120
    buffer_load_dwordx4 v[108:111], v3, s[8:11], s36 offen offset:0 nt
    buffer_load_dwordx4 v[112:115], v3, s[8:11], s36 offen offset:256 nt
    buffer_load_dwordx4 v[116:119], v3, s[8:11], s36 offen offset:512 nt
    buffer_load_dwordx4 v[120:123], v3, s[8:11], s36 offen offset:768 nt
    buffer_load_dwordx4 v[124:127], v3, s[8:11], s36 offen offset:1024 nt
    s_branch L_c_next
L_c_ld2:
    s_cmp_lg_u32 s3, 0
    s_cbranch_scc1 L_c_noarrB
    s_mov_b64 exec, 1
    v_mov_b32 v16, 0
    v_mov_b32 v17, 1
    global_atomic_add v16, v17, s[58:59] offset:128 sc1
    s_mov_b64 exec, -1
L_c_noarrB:
    s_cmp_eq_u32 s69, 1
    s_cbranch_scc1 L_c_ldw2
    s_mov_b32 s8, s52
    s_mov_b32 s9, s53
    s_mov_b32 s10, 2211840
    s_mov_b32 s11, 0x20000
    v_lshrrev_b32 v12, 3, v2
    v_lshlrev_b32 v12, 2, v12
    v_add_u32 v12, v12, v1
    v_mul_u32_u24 v12, 3456, v12
    v_and_b32 v16, 7, v2
    v_lshlrev_b32 v16, 4, v16
    v_add_u32 v12, v12, v16
    s_mul_i32 s74, s3, 552960
    s_lshl_b32 s75, s62, 7
    s_add_u32 s74, s74, s75
    s_add_u32 s75, s74, 2816
    buffer_load_dwordx4 v[168:171], v12, s[8:11], s74 offen offset:0 nt
    s_add_u32 s74, s74, 27648
    buffer_load_dwordx4 v[172:175], v12, s[8:11], s74 offen offset:0 nt
    s_add_u32 s74, s74, 27648
    buffer_load_dwordx4 v[176:179], v12, s[8:11], s74 offen offset:0 nt
    s_add_u32 s74, s74, 27648
    buffer_load_dwordx4 v[180:183], v12, s[8:11], s74 offen offset:0 nt
    s_add_u32 s74, s74, 27648
    buffer_load_dwordx4 v[184:187], v12, s[8:11], s74 offen offset:0 nt
    s_add_u32 s74, s74, 27648
    buffer_load_dwordx4 v[188:191], v12, s[8:11], s74 offen offset:0 nt
    s_add_u32 s74, s74, 27648
    buffer_load_dwordx4 v[192:195], v12, s[8:11], s74 offen offset:0 nt
    s_add_u32 s74, s74, 27648
    buffer_load_dwordx4 v[196:199], v12, s[8:11], s74 offen offset:0 nt
    s_add_u32 s74, s74, 27648
    buffer_load_dwordx4 v[200:203], v12, s[8:11], s74 offen offset:0 nt
    s_add_u32 s74, s74, 27648
    buffer_load_dwordx4 v[204:207], v12, s[8:11], s74 offen offset:0 nt
    s_add_u32 s74, s74, 27648
    buffer_load_dwordx4 v[208:211], v12, s[8:11], s74 offen offset:0 nt
    s_add_u32 s74, s74, 27648
    buffer_load_dwordx4 v[212:215], v12, s[8:11], s74 offen offset:0 nt
    s_add_u32 s74, s74, 27648
    buffer_load_dwordx4 v[216:219], v12, s[8:11], s74 offen offset:0 nt
    s_add_u32 s74, s74, 27648
    buffer_load_dwordx4 v[220:223], v12, s[8:11], s74 offen offset:0 nt
    s_add_u32 s74, s74, 27648
    buffer_load_dwordx4 v[224:227], v12, s[8:11], s74 offen offset:0 nt
    s_add_u32 s74, s74, 27648
    buffer_load_dwordx4 v[228:231], v12, s[8:11], s74 offen offset:0 nt
    s_add_u32 s74, s74, 27648
    buffer_load_dwordx4 v[232:235], v12, s[8:11], s74 offen offset:0 nt
    s_add_u32 s74, s74, 27648
    buffer_load_dwordx4 v[236:239], v12, s[8:11], s74 offen offset:0 nt
    s_add_u32 s74, s74, 27648
    buffer_load_dwordx4 v[240:243], v12, s[8:11], s74 offen offset:0 nt
    s_add_u32 s74, s74, 27648
    buffer_load_dwordx4 v[244:247], v12, s[8:11], s74 offen offset:0 nt
    s_cmp_lt_u32 s62, 5
    s_cbranch_scc0 L_c_ldone
    buffer_load_dwordx4 v[248:251], v12, s[8:11], s75 offen offset:0 nt
    s_add_u32 s75, s75, 27648
    buffer_load_dwordx4 v[252:255], v12, s[8:11], s75 offen offset:0 nt
    s_add_u32 s75, s75, 27648
    s_add_u32 m0, s39, 0
    s_nop 0
    buffer_load_dwordx4 v12, s[8:11], s75 offen offset:0 nt lds
    s_add_u32 s75, s75, 27648
    s_add_u32 m0, s39, 1024
    s_nop 0
    buffer_load_dwordx4 v12, s[8:11], s75 offen offset:0 nt lds
    s_add_u32 s75, s75, 27648
    s_add_u32 m0, s39, 2048
    s_nop 0
    buffer_load_dwordx4 v12, s[8:11], s75 offen offset:0 nt lds
    s_add_u32 s75, s75, 27648
    s_add_u32 m0, s39, 3072
    s_nop 0
    buffer_load_dwordx4 v12, s[8:11], s75 offen offset:0 nt lds
    s_add_u32 s75, s75, 27648
    s_add_u32 m0, s39, 4096
    s_nop 0
    buffer_load_dwordx4 v12, s[8:11], s75 offen offset:0 nt lds
    s_add_u32 s75, s75, 27648
    s_add_u32 m0, s39, 5120
    s_nop 0
    buffer_load_dwordx4 v12, s[8:11], s75 offen offset:0 nt lds
    s_add_u32 s75, s75, 27648
    s_add_u32 m0, s39, 6144
    s_nop 0
    buffer_load_dwordx4 v12, s[8:11], s75 offen offset:0 nt lds
    s_add_u32 s75, s75, 27648
    s_add_u32 m0, s39, 7168
    s_nop 0
    buffer_load_dwordx4 v12, s[8:11], s75 offen offset:0 nt lds
    s_add_u32 s75, s75, 27648
    s_add_u32 m0, s39, 8192
    s_nop 0
    buffer_load_dwordx4 v12, s[8:11], s75 offen offset:0 nt lds
    s_add_u32 s75, s75, 27648
    s_add_u32 m0, s39, 9216
    s_nop 0
    buffer_load_dwordx4 v12, s[8:11], s75 offen offset:0 nt lds
    s_add_u32 s75, s75, 27648
    s_add_u32 m0, s39, 10240
    s_nop 0
    buffer_load_dwordx4 v12, s[8:11], s75 offen offset:0 nt lds
    s_add_u32 s75, s75, 27648
    s_add_u32 m0, s39, 11264
    s_nop 0
    buffer_load_dwordx4 v12, s[8:11], s75 offen offset:0 nt lds
    s_add_u32 s75, s75, 27648
    s_add_u32 m0, s39, 12288
    s_nop 0
    buffer_load_dwordx4 v12, s[8:11], s75 offen offset:0 nt lds
    s_add_u32 s75, s75, 27648
    s_add_u32 m0, s39, 13312
    s_nop 0
    buffer_load_dwordx4 v12, s[8:11], s75 offen offset:0 nt lds
    s_add_u32 s75, s75, 27648
    s_add_u32 m0, s39, 14336
    s_nop 0
    buffer_load_dwordx4 v12, s[8:11], s75 offen offset:0 nt lds
    s_add_u32 s75, s75, 27648
    s_add_u32 m0, s39, 15360
    s_nop 0
    buffer_load_dwordx4 v12, s[8:11], s75 offen offset:0 nt lds
    s_add_u32 s75, s75, 27648
    s_add_u32 m0, s39, 16384
    s_nop 0
    buffer_load_dwordx4 v12, s[8:11], s75 offen offset:0 nt lds
    s_add_u32 s75, s75, 27648
    s_add_u32 m0, s39, 17408
    s_nop 0
    buffer_load_dwordx4 v12, s[8:11], s75 offen offset:0 nt lds
    s_branch L_c_ldone
L_c_ldw2:
    s_mov_b32 s8, s54
    s_mov_b32 s9, s55
    s_mov_b32 s10, 2211840
    s_mov_b32 s11, 0x20000
    v_lshrrev_b32 v12, 3, v2
    v_lshlrev_b32 v12, 2, v12
    v_add_u32 v12, v12, v1
    v_mul_u32_u24 v12, 1280, v12
    v_and_b32 v16, 7, v2
    v_lshlrev_b32 v16, 4, v16
    v_add_u32 v12, v12, v16
    s_mul_i32 s74, s3, 552960
    s_sub_u32 s75, s62, 22
    s_lshl_b32 s75, s75, 7
    s_add_u32 s74, s74, s75
    buffer_load_dwordx4 v[168:171], v12, s[8:11], s74 offen offset:0 nt
    s_add_u32 s74, s74, 10240
    buffer_load_dwordx4 v[172:175], v12, s[8:11], s74 offen offset:0 nt
    s_add_u32 s74, s74, 10240
    buffer_load_dwordx4 v[176:179], v12, s[8:11], s74 offen offset:0 nt
    s_add_u32 s74, s74, 10240
    buffer_load_dwordx4 v[180:183], v12, s[8:11], s74 offen offset:0 nt
    s_add_u32 s74, s74, 10240
    buffer_load_dwordx4 v[184:187], v12, s[8:11], s74 offen offset:0 nt
    s_add_u32 s74, s74, 10240
    buffer_load_dwordx4 v[188:191], v12, s[8:11], s74 offen offset:0 nt
    s_add_u32 s74, s74, 10240
    buffer_load_dwordx4 v[192:195], v12, s[8:11], s74 offen offset:0 nt
    s_add_u32 s74, s74, 10240
    buffer_load_dwordx4 v[196:199], v12, s[8:11], s74 offen offset:0 nt
    s_add_u32 s74, s74, 10240
    buffer_load_dwordx4 v[200:203], v12, s[8:11], s74 offen offset:0 nt
    s_add_u32 s74, s74, 10240
    buffer_load_dwordx4 v[204:207], v12, s[8:11], s74 offen offset:0 nt
    s_add_u32 s74, s74, 10240
    buffer_load_dwordx4 v[208:211], v12, s[8:11], s74 offen offset:0 nt
    s_add_u32 s74, s74, 10240
    buffer_load_dwordx4 v[212:215], v12, s[8:11], s74 offen offset:0 nt
    s_add_u32 s74, s74, 10240
    buffer_load_dwordx4 v[216:219], v12, s[8:11], s74 offen offset:0 nt
    s_add_u32 s74, s74, 10240
    buffer_load_dwordx4 v[220:223], v12, s[8:11], s74 offen offset:0 nt
    s_add_u32 s74, s74, 10240
    buffer_load_dwordx4 v[224:227], v12, s[8:11], s74 offen offset:0 nt
    s_add_u32 s74, s74, 10240
    buffer_load_dwordx4 v[228:231], v12, s[8:11], s74 offen offset:0 nt
    s_add_u32 s74, s74, 10240
    buffer_load_dwordx4 v[232:235], v12, s[8:11], s74 offen offset:0 nt
    s_add_u32 s74, s74, 10240
    buffer_load_dwordx4 v[236:239], v12, s[8:11], s74 offen offset:0 nt
    s_add_u32 s74, s74, 10240
    buffer_load_dwordx4 v[240:243], v12, s[8:11], s74 offen offset:0 nt
    s_add_u32 s74, s74, 10240
    buffer_load_dwordx4 v[244:247], v12, s[8:11], s74 offen offset:0 nt
    s_add_u32 s74, s74, 10240
    buffer_load_dwordx4 v[248:251], v12, s[8:11], s74 offen offset:0 nt
    s_add_u32 s74, s74, 10240
    buffer_load_dwordx4 v[252:255], v12, s[8:11], s74 offen offset:0 nt
    s_add_u32 s74, s74, 10240
    s_add_u32 m0, s39, 0
    s_nop 0
    buffer_load_dwordx4 v12, s[8:11], s74 offen offset:0 nt lds
    s_add_u32 s74, s74, 10240
    s_add_u32 m0, s39, 1024
    s_nop 0
    buffer_load_dwordx4 v12, s[8:11], s74 offen offset:0 nt lds
    s_add_u32 s74, s74, 10240
    s_add_u32 m0, s39, 2048
    s_nop 0
    buffer_load_dwordx4 v12, s[8:11], s74 offen offset:0 nt lds
    s_add_u32 s74, s74, 10240
    s_add_u32 m0, s39, 3072
    s_nop 0
    buffer_load_dwordx4 v12, s[8:11], s74 offen offset:0 nt lds
    s_add_u32 s74, s74, 10240
    s_add_u32 m0, s39, 4096
    s_nop 0
    buffer_load_dwordx4 v12, s[8:11], s74 offen offset:0 nt lds
    s_add_u32 s74, s74, 10240
    s_add_u32 m0, s39, 5120
    s_nop 0
    buffer_load_dwordx4 v12, s[8:11], s74 offen offset:0 nt lds
    s_add_u32 s74, s74, 10240
    s_add_u32 m0, s39, 6144
    s_nop 0
    buffer_load_dwordx4 v12, s[8:11], s74 offen offset:0 nt lds
    s_add_u32 s74, s74, 10240
    s_add_u32 m0, s39, 7168
    s_nop 0
    buffer_load_dwordx4 v12, s[8:11], s74 offen offset:0 nt lds
    s_add_u32 s74, s74, 10240
    s_add_u32 m0, s39, 8192
    s_nop 0
    buffer_load_dwordx4 v12, s[8:11], s74 offen offset:0 nt lds
    s_add_u32 s74, s74, 10240
    s_add_u32 m0, s39, 9216
    s_nop 0
    buffer_load_dwordx4 v12, s[8:11], s74 offen offset:0 nt lds
    s_add_u32 s74, s74, 10240
    s_add_u32 m0, s39, 10240
    s_nop 0
    buffer_load_dwordx4 v12, s[8:11], s74 offen offset:0 nt lds
    s_add_u32 s74, s74, 10240
    s_add_u32 m0, s39, 11264
    s_nop 0
    buffer_load_dwordx4 v12, s[8:11], s74 offen offset:0 nt lds
    s_add_u32 s74, s74, 10240
    s_add_u32 m0, s39, 12288
    s_nop 0
    buffer_load_dwordx4 v12, s[8:11], s74 offen offset:0 nt lds
    s_add_u32 s74, s74, 10240
    s_add_u32 m0, s39, 13312
    s_nop 0
    buffer_load_dwordx4 v12, s[8:11], s74 offen offset:0 nt lds
    s_add_u32 s74, s74, 10240
    s_add_u32 m0, s39, 14336
    s_nop 0
    buffer_load_dwordx4 v12, s[8:11], s74 offen offset:0 nt lds
    s_add_u32 s74, s74, 10240
    s_add_u32 m0, s39, 15360
    s_nop 0
    buffer_load_dwordx4 v12, s[8:11], s74 offen offset:0 nt lds
    s_add_u32 s74, s74, 10240
    s_add_u32 m0, s39, 16384
    s_nop 0
    buffer_load_dwordx4 v12, s[8:11], s74 offen offset:0 nt lds
    s_add_u32 s74, s74, 10240
    s_add_u32 m0, s39, 17408
    s_nop 0
    buffer_load_dwordx4 v12, s[8:11], s74 offen offset:0 nt lds
    s_add_u32 s74, s74, 10240
    s_add_u32 m0, s39, 18432
    s_nop 0
    buffer_load_dwordx4 v12, s[8:11], s74 offen offset:0 nt lds
    s_add_u32 s74, s74, 10240
    s_add_u32 m0, s39, 19456
    s_nop 0
    buffer_load_dwordx4 v12, s[8:11], s74 offen offset:0 nt lds
    s_add_u32 s74, s74, 10240
    s_add_u32 m0, s39, 20480
    s_nop 0
    buffer_load_dwordx4 v12, s[8:11], s74 offen offset:0 nt lds
    s_add_u32 s74, s74, 10240
    s_add_u32 m0, s39, 21504
    s_nop 0
    buffer_load_dwordx4 v12, s[8:11], s74 offen offset:0 nt lds
    s_add_u32 s74, s74, 10240
    s_add_u32 m0, s39, 22528
    s_nop 0
    buffer_load_dwordx4 v12, s[8:11], s74 offen offset:0 nt lds
    s_add_u32 s74, s74, 10240
    s_add_u32 m0, s39, 23552
    s_nop 0
    buffer_load_dwordx4 v12, s[8:11], s74 offen offset:0 nt lds
    s_add_u32 s74, s74, 10240
    s_add_u32 m0, s39, 24576
    s_nop 0
    buffer_load_dwordx4 v12, s[8:11], s74 offen offset:0 nt lds
    s_add_u32 s74, s74, 10240
    s_add_u32 m0, s39, 25600
    s_nop 0
    buffer_load_dwordx4 v12, s[8:11], s74 offen offset:0 nt lds
    s_add_u32 s74, s74, 10240
    s_add_u32 m0, s39, 26624
    s_nop 0
    buffer_load_dwordx4 v12, s[8:11], s74 offen offset:0 nt lds
    s_add_u32 s74, s74, 10240
    s_add_u32 m0, s39, 27648
    s_nop 0
    buffer_load_dwordx4 v12, s[8:11], s74 offen offset:0 nt lds
    s_add_u32 s74, s74, 10240
    s_add_u32 m0, s39, 28672
    s_nop 0
    buffer_load_dwordx4 v12, s[8:11], s74 offen offset:0 nt lds
    s_add_u32 s74, s74, 10240
    s_add_u32 m0, s39, 29696
    s_nop 0
    buffer_load_dwordx4 v12, s[8:11], s74 offen offset:0 nt lds
    s_add_u32 s74, s74, 10240
    s_add_u32 m0, s39, 30720
    s_nop 0
    buffer_load_dwordx4 v12, s[8:11], s74 offen offset:0 nt lds
    s_add_u32 s74, s74, 10240
    s_add_u32 m0, s39, 31744
    s_nop 0
    buffer_load_dwordx4 v12, s[8:11], s74 offen offset:0 nt lds
L_c_ldone:
    s_mov_b32 s73, 0
L_cw_29:
    v_mov_b32 v29, 0
    global_load_dword v29, v29, s[58:59] offset:128 sc1
    s_waitcnt vmcnt(0)
    v_cmp_gt_u32 vcc, 32, v29
    s_add_u32 s73, s73, 1
    s_cmp_gt_u32 s73, 60000
    s_nop 1
    s_cbranch_scc1 L_cwd_30
    s_cbranch_vccnz L_cw_29
L_cwd_30:
L_c_next:
    s_add_u32 s63, s63, 1
    s_cmp_lt_u32 s63, 6
    s_cbranch_scc1 L_c_loop
    s_branch L_fin
L_fin:
L_end:
    s_endpgm
.section .rodata,"a"
.p2align 6
.amdhsa_kernel interleave_layers__gqa_block_cached__dense_activation_silu__decode_kernel
.amdhsa_next_free_vgpr 512
.amdhsa_next_free_sgpr 102
.amdhsa_accum_offset 256
.amdhsa_group_segment_fixed_size 0
.amdhsa_kernarg_size 88
.amdhsa_user_sgpr_count 2
.amdhsa_user_sgpr_kernarg_segment_ptr 1
.amdhsa_system_sgpr_workgroup_id_x 1
.end_amdhsa_kernel
```
